```python
import torch

def _softmax(x, axis=-1):
    return torch.softmax(x, dim=axis)
def _gelu(x):
    return torch.nn.functional.gelu(x, approximate="tanh")
def _silu(x):
    return torch.nn.functional.silu(x)
def _sigmoid(x):
    return torch.sigmoid(x)
def _layernorm(x, axis=-1, eps=1e-5):
    m = x.mean(dim=axis, keepdim=True)
    v = x.var(dim=axis, keepdim=True, unbiased=False)
    return (x - m) / torch.sqrt(v + eps)
def _scatter_add(tgt, idx, src, axis=0):
    return tgt.clone().index_add_(axis, idx, src)
def _segment_sum(src, seg, n):
    out = torch.zeros((n,) + src.shape[1:], dtype=src.dtype)
    return out.index_add_(0, seg, src)
def _pad(x, pw):
    flat = tuple(v for pair in reversed(pw) for v in pair)
    return torch.nn.functional.pad(x, flat)

kernel_name = 'parallel_sum__spectral_fnet__dense_activation_relu__prompt'

def setup_inputs():

    _w = (lambda a: (lambda t: t.to(torch.bfloat16) if t.is_floating_point() else t)(torch.as_tensor(a)))
    def _A_setup():
        B, S, D = 1, 2048, 1024
        ns = torch.arange(S)[:, None] * torch.arange(S)[None, :]
        nd = torch.arange(D)[:, None] * torch.arange(D)[None, :]
        Ws_re = torch.cos(-2.0 * torch.pi * ns / S).to(float)
        Ws_im = torch.sin(-2.0 * torch.pi * ns / S).to(float)
        Wd_re = torch.cos(-2.0 * torch.pi * nd / D).to(float)
        Wd_im = torch.sin(-2.0 * torch.pi * nd / D).to(float)
        return {
            "x": _w((lambda *s: torch.randn(*s, dtype=torch.bfloat16) * 0.05)(B, S, D)),
            "dft_seq_re": _w(Ws_re),
            "dft_seq_im": _w(Ws_im),
            "dft_hid_re": _w(Wd_re),
            "dft_hid_im": _w(Wd_im),
        }
    _A_in = _A_setup()

    def _B_setup():
        B, S, D, Dff = 1, 2048, 1024, 3584
        return {
            "x": _w((lambda *s: torch.randn(*s, dtype=torch.bfloat16) * 0.05)(B, S, D)),
            "w1": _w((lambda *s: torch.randn(*s, dtype=torch.bfloat16) * 0.4)(D, Dff)),
            "w2": _w((lambda *s: torch.randn(*s, dtype=torch.bfloat16) * 0.4)(Dff, D)),
        }
    _B_in = _B_setup()

    return {
        "A_x": _A_in["x"],
        "A_dft_seq_re": _A_in["dft_seq_re"],
        "A_dft_seq_im": _A_in["dft_seq_im"],
        "A_dft_hid_re": _A_in["dft_hid_re"],
        "A_dft_hid_im": _A_in["dft_hid_im"],
        "B_x": _B_in["x"],
        "B_w1": _B_in["w1"],
        "B_w2": _B_in["w2"],
    }

def reference(A_x, A_dft_seq_re, A_dft_seq_im, A_dft_hid_re, A_dft_hid_im, B_x, B_w1, B_w2):
    def _A_ref(x, dft_seq_re, dft_seq_im, dft_hid_re, dft_hid_im):
        a = torch.einsum("bsd,ed->bse", x, dft_hid_re)
        b = torch.einsum("bsd,ed->bse", x, dft_hid_im)
        y = torch.einsum("ts,bse->bte", dft_seq_re, a) - torch.einsum("ts,bse->bte", dft_seq_im, b)
        return y

    def _B_ref(x, w1, w2):
        h = torch.einsum("bsd,df->bsf", x, w1)
        zero = torch.zeros_like(h)
        h = torch.maximum(h, zero)
        return torch.einsum("bsf,fd->bsd", h, w2)

    x = A_x
    xn = _layernorm(x, axis=-1)
    return x + _A_ref(xn, A_dft_seq_re, A_dft_seq_im, A_dft_hid_re, A_dft_hid_im) + _B_ref(xn, B_w1, B_w2)
```

```asm
; @launch grid=(256,1,1) block=(512,1,1) lds=163840
.amdgcn_target "amdgcn-amd-amdhsa--gfx950"
.text
.globl parallel_sum__spectral_fnet__dense_activation_relu__prompt_kernel
.p2align 8
.type parallel_sum__spectral_fnet__dense_activation_relu__prompt_kernel,@function
parallel_sum__spectral_fnet__dense_activation_relu__prompt_kernel:
s_cmp_ge_u32 s2, 256
s_cbranch_scc1 L_end
s_load_dwordx2 s[4:5], s[0:1], 0
s_load_dwordx2 s[12:13], s[0:1], 80
v_lshrrev_b32 v20, 6, v0
v_and_b32 v1, 63, v0
v_readfirstlane_b32 s28, v20
s_bfe_u32 s30, s2, 0x10000
s_lshl_b32 s36, s30, 3
s_add_u32 s37, s36, 24
s_cmp_eq_u32 s28, 7
s_cselect_b32 s37, s37, 48
s_load_dwordx2 s[8:9], s[0:1], s37
s_mov_b32 s10, 7340032
s_mov_b32 s46, 458752
s_cselect_b32 s10, 2097152, s10
s_cselect_b32 s46, 131072, s46
s_cmp_lt_u32 s28, 4
s_cbranch_scc1 L_pp
s_setprio 1
L_pp:
s_and_b32 s29, s2, 6
s_lshl_b32 s29, s29, 1
s_bfe_u32 s37, s2, 0x20003
s_add_u32 s29, s29, s37
s_lshr_b32 s31, s2, 5
s_add_u32 s99, s37, s31
s_and_b32 s99, s99, 3
s_and_b32 s98, s29, 12
s_add_u32 s98, s98, s99
s_lshl_b32 s40, s98, 7
s_mul_i32 s41, s98, s46
s_and_b32 s29, s29, 8
s_lshl_b32 s37, s37, 1
s_add_u32 s29, s29, s37
s_bfe_u32 s37, s2, 0x10001
s_add_u32 s29, s29, s37
s_add_u32 s34, s36, s31
s_lshr_b32 s35, s29, 1
s_lshl_b32 s35, s35, 6
s_and_b32 s37, s29, 1
s_add_u32 s35, s35, s37
s_mov_b32 s6, 0x400000
s_mov_b32 s7, 0x00020000
s_mov_b32 s11, 0x00020000
s_lshl_b32 s43, s28, 12
s_lshl_b32 s42, s28, 11
s_add_u32 s42, s42, 98304
s_lshr_b32 s36, s28, 2
s_lshl_b32 s36, s36, 1
s_add_u32 s36, s36, s35
s_and_b32 s37, s28, 3
s_add_u32 s38, s37, 1
s_lshr_b32 s38, s38, 1
s_lshl_b32 s38, s38, 10
s_bitcmp1_b32 s37, 0
s_cselect_b32 s39, -1, 1
s_lshr_b32 s37, s37, 1
s_lshl_b32 s37, s37, 9
s_sub_u32 s37, s38, s37
v_lshrrev_b32 v20, 3, v1
v_lshl_add_u32 v21, v20, 2, s36
v_cmp_eq_u32 vcc, 0, v21
v_mul_lo_u32 v22, v21, s39
v_add_u32 v22, s38, v22
s_lshl_b32 s39, s39, 5
v_add_u32 v23, s39, v22
v_mov_b32 v24, s37
v_cndmask_b32 v22, v22, v24, vcc
v_lshrrev_b32 v24, 1, v20
v_xor_b32 v24, v24, v1
v_and_b32 v24, 7, v24
v_lshlrev_b32 v24, 4, v24
v_lshl_add_u32 v2, v22, 11, v24
v_xor_b32 v24, 64, v24
v_lshl_add_u32 v3, v23, 11, v24
v_subrev_u32 v3, 1024, v3
s_cmp_eq_u32 s28, 7
s_cbranch_scc1 L_wd7
s_lshl_b32 s36, s28, 8
s_mul_i32 s37, s34, 448
s_add_u32 s37, s37, s43
v_add_u32 v20, s36, v1
v_mul_u32_u24 v20, 2341, v20
v_lshl_add_u32 v25, v1, 4, s37
s_movk_i32 s38, 6720
v_lshrrev_b32 v21, 16, v20
v_bfe_u32 v23, v20, 19, 1
v_mad_u32_u24 v22, v21, s38, v25
v_lshlrev_b32 v23, 5, v23
v_xor_b32 v4, v22, v23
v_add_u32 v20, 149824, v20
v_lshrrev_b32 v21, 16, v20
v_bfe_u32 v23, v20, 19, 1
v_mad_u32_u24 v22, v21, s38, v25
v_lshlrev_b32 v23, 5, v23
v_xor_b32 v5, v22, v23
v_add_u32 v20, 149824, v20
v_lshrrev_b32 v21, 16, v20
v_bfe_u32 v23, v20, 19, 1
v_mad_u32_u24 v22, v21, s38, v25
v_lshlrev_b32 v23, 5, v23
v_xor_b32 v6, v22, v23
v_add_u32 v20, 149824, v20
v_lshrrev_b32 v21, 16, v20
v_bfe_u32 v23, v20, 19, 1
v_mad_u32_u24 v22, v21, s38, v25
v_lshlrev_b32 v23, 5, v23
v_xor_b32 v7, v22, v23
s_branch L_wdj
L_wd7:
v_lshrrev_b32 v20, 2, v1
v_lshrrev_b32 v21, 3, v1
v_xor_b32 v21, v21, v1
v_and_b32 v21, 2, v21
v_lshlrev_b32 v20, 12, v20
v_and_or_b32 v21, v1, 1, v21
v_lshl_add_u32 v20, v21, 4, v20
s_lshl_b32 s36, s31, 6
v_add_u32 v4, s36, v20
v_add_u32 v5, 64512, v4
v_add_u32 v6, 0, v4
v_add_u32 v7, 64512, v4
L_wdj:
s_lshl_b32 s47, s46, 4
s_mov_b32 s36, 34637824
s_waitcnt lgkmcnt(0)
s_add_u32 m0, s42, 0
s_nop 0
buffer_load_dwordx4 v2, s[4:7], s40 offen offset:0 lds
buffer_load_dwordx4 v3, s[4:7], s40 offen offset:1024 lds
s_add_u32 m0, s43, 0
s_nop 0
buffer_load_dwordx4 v4, s[8:11], s41 offen offset:0 lds
buffer_load_dwordx4 v5, s[8:11], s41 offen offset:1024 lds
buffer_load_dwordx4 v6, s[8:11], s41 offen offset:2048 lds
buffer_load_dwordx4 v7, s[8:11], s41 offen offset:3072 lds
s_mov_b32 s96, 3058987809
s_mov_b32 s97, 249363096
s_cmp_eq_u32 s99, 1
s_cselect_b32 s96, 1985479460, s96
s_cselect_b32 s97, 267238044, s97
s_cmp_eq_u32 s99, 2
s_cselect_b32 s96, 1989414995, s96
s_cselect_b32 s97, 267172568, s97
s_cmp_eq_u32 s99, 3
s_cselect_b32 s96, 2052335120, s96
s_cselect_b32 s97, 266124952, s97
s_lshr_b32 s98, s98, 2
s_mul_i32 s98, s98, 0x44444444
s_xor_b32 s96, s96, s98
s_xor_b32 s97, s97, s98
s_and_b32 s98, s96, 15
s_lshr_b64 s[96:97], s[96:97], 4
s_lshl_b32 s40, s98, 7
s_mul_i32 s41, s98, s46
s_load_dword s24, s[12:13], s36
s_load_dwordx2 s[16:17], s[0:1], 56
s_load_dwordx2 s[20:21], s[0:1], 64
s_and_b32 s32, s28, 1
s_lshr_b32 s33, s28, 1
v_bfe_u32 v20, v1, 2, 2
v_lshrrev_b32 v21, 4, v1
v_lshl_add_u32 v22, v21, 3, v20
v_mul_u32_u24 v22, 448, v22
v_and_b32 v23, 3, v1
v_lshlrev_b32 v23, 3, v23
v_add_u32 v22, v22, v23
v_and_b32 v24, 1, v21
s_lshl_b32 s36, s28, 1
s_cmp_eq_u32 s33, 3
s_cselect_b32 s36, 12, s36
s_cselect_b64 s[58:59], -1, 0
v_xor_b32 v25, s36, v24
v_bfe_u32 v26, v1, 2, 4
v_lshl_add_u32 v26, v26, 6, v23
v_add_u32 v26, 28672, v26
v_lshl_add_u32 v26, v24, 5, v26
v_xor_b32 v27, 32, v26
v_xor_b32 v23, 0, v25
v_lshl_add_u32 v8, v23, 5, v22
v_xor_b32 v23, 1, v25
v_lshl_add_u32 v9, v23, 5, v22
v_xor_b32 v23, 2, v25
v_lshl_add_u32 v10, v23, 5, v22
v_cndmask_b32 v10, v10, v26, s[58:59]
v_xor_b32 v23, 3, v25
v_lshl_add_u32 v11, v23, 5, v22
v_cndmask_b32 v11, v11, v27, s[58:59]
v_and_b32 v20, 15, v1
v_lshlrev_b32 v22, 7, v20
s_lshl_b32 s36, s32, 13
s_add_u32 s36, s36, 98304
v_add_u32 v22, s36, v22
v_lshrrev_b32 v20, 1, v20
v_xor_b32 v20, v20, v21
v_lshl_add_u32 v16, v20, 4, v22
v_xor_b32 v17, 64, v16
s_add_u32 m0, s42, 16384
s_nop 0
buffer_load_dwordx4 v2, s[4:7], s40 offen offset:0 lds
v_mov_b32 v124, 0x3f803f80
v_mov_b32 v125, 0x3f803f80
v_mov_b32 v126, 0x3f803f80
v_mov_b32 v127, 0x3f803f80
v_add_u32 v12, 0x10000, v8
v_add_u32 v13, 0x10000, v9
v_add_u32 v14, 0x10000, v10
v_add_u32 v15, 0x10000, v11
s_mov_b32 s14, 268435456
s_mov_b32 s15, 0x00020000
s_mov_b32 s18, 7340032
s_mov_b32 s19, 0x00020000
s_mov_b32 s22, 4194304
s_mov_b32 s23, 0x00020000
buffer_load_dwordx4 v3, s[4:7], s40 offen offset:1024 lds
s_lshl_b32 s36, s29, 4
s_add_u32 s36, s36, s34
s_lshl_b32 s36, s36, 5
s_add_u32 s36, s36, s28
s_lshl_b32 s48, s36, 2
s_add_u32 s48, s48, 34603008
s_and_b32 s36, s29, 1
s_lshl_b32 s36, s36, 1
s_add_u32 s36, s36, s32
s_lshl_b32 s36, s36, 3
s_lshr_b32 s37, s29, 1
s_add_u32 s36, s36, s37
s_lshl_b32 s36, s36, 4
s_add_u32 s36, s36, s34
s_getreg_b32 s3, hwreg(HW_REG_XCC_ID, 0, 4)
s_lshl_b32 s49, s36, 2
s_add_u32 s49, s49, 34635776
v_lshrrev_b32 v21, 4, v1
s_lshl_b32 s36, s32, 4
v_add_u32 v20, s36, v21
s_add_u32 m0, s43, 32768
s_nop 0
buffer_load_dwordx4 v4, s[8:11], s41 offen offset:0 lds
v_bfe_u32 v22, v1, 1, 3
v_xor_b32 v22, v22, v21
s_xor_b32 s36, s31, 0
s_lshl_b32 s36, s36, 7
s_sub_u32 s37, 1792, s36
v_mov_b32 v23, s36
v_mov_b32 v24, s37
v_and_b32 v25, 1, v1
v_lshlrev_b32 v25, 4, v25
v_lshl_add_u32 v25, v20, 11, v25
v_cmp_lt_u32 vcc, 3, v22
v_lshl_add_u32 v27, v22, 5, v25
s_nop 0
v_cndmask_b32 v26, v23, v24, vcc
v_add_u32 v120, v26, v27
buffer_load_dwordx4 v5, s[8:11], s41 offen offset:1024 lds
v_xor_b32 v22, 4, v22
v_cmp_lt_u32 vcc, 3, v22
v_lshl_add_u32 v27, v22, 5, v25
s_nop 0
v_cndmask_b32 v26, v23, v24, vcc
v_add_u32 v121, v26, v27
v_add_u32 v121, 7168, v121
v_add_u32 v122, 14336, v120
v_add_u32 v123, 14336, v121
s_and_b32 s52, s28, 3
s_lshl_b32 s52, s52, 12
s_mul_i32 s36, s30, 56
s_add_u32 s51, s36, 56
s_lshl_b32 s51, s51, 16
s_mul_i32 s37, s31, 7
s_add_u32 s36, s36, s37
s_bfe_u32 s37, s28, 0x10001
s_add_u32 s36, s36, s37
s_lshl_b32 s50, s36, 16
buffer_load_dwordx4 v6, s[8:11], s41 offen offset:2048 lds
s_cmp_eq_u32 s28, 0
s_cselect_b32 s45, 3, 60
s_cselect_b32 s25, 1, 60
v_and_b32 v21, 15, v1
s_lshl_b32 s36, s29, 4
v_add_u32 v22, s36, v21
v_lshlrev_b32 v20, 4, v21
v_add_u32 v21, s34, v20
v_and_b32 v23, 16, v1
v_cmp_eq_u32 vcc, 0, v23
s_mov_b32 s26, 34603072
s_nop 0
v_cndmask_b32 v21, v21, v22, vcc
v_lshlrev_b32 v21, 7, v21
s_lshl_b32 s36, s28, 1
s_min_u32 s36, s36, 12
s_lshl_b32 s36, s36, 8
s_lshl_b32 s37, s34, 14
s_add_u32 s36, s36, s37
s_add_u32 s72, s37, 33619968
s_lshr_b32 s37, s29, 2
s_lshl_b32 s37, s37, 12
s_add_u32 s36, s36, s37
s_and_b32 s37, s29, 3
s_lshl_b32 s37, s37, 2
s_add_u32 s36, s36, s37
s_add_u32 s73, s36, 33619968
buffer_load_dwordx4 v7, s[8:11], s41 offen offset:3072 lds
v_lshrrev_b32 v23, 5, v1
v_lshl_add_u32 v20, v23, 8, v20
v_cmp_gt_u32 vcc, 32, v1
v_mov_b32 v28, 0
v_mov_b32 v29, 0
v_mov_b32 v19, 0
s_mov_b32 s62, 1197814288
s_mov_b32 s63, 3488451497
s_cmp_eq_u32 s99, 1
s_cselect_b32 s62, 2271293956, s62
s_cselect_b32 s63, 4275686309, s63
s_cmp_eq_u32 s99, 2
s_cselect_b32 s62, 2267353155, s62
s_cselect_b32 s63, 4272802665, s63
s_cmp_eq_u32 s99, 3
s_cselect_b32 s62, 2204435489, s62
s_cselect_b32 s63, 4226664361, s63
v_and_b32 v194, 15, v1
v_lshrrev_b32 v195, 5, v1
v_lshrrev_b32 v192, 1, v194
v_xor_b32 v195, v195, v192
v_mov_b32 v88, 0
s_and_b32 s36, s2, 6
s_lshl_b32 s36, s36, 1
s_xor_b32 s36, s36, s31
s_lshl_b32 s36, s36, 2
s_xor_b32 s37, s36, 60
s_lshr_b64 s[38:39], s[62:63], s36
s_and_b32 s38, s38, 15
s_lshr_b64 s[62:63], s[62:63], s37
s_and_b32 s62, s62, 15
s_cmp_lt_u32 s38, s62
s_cselect_b32 s65, 0, 1
s_lshr_b32 s36, 0x80000000, s38
s_lshr_b32 s37, 0x80000000, s62
s_or_b32 s64, s36, s37
s_cmp_lt_u32 s28, 4
s_cselect_b32 s64, 0, s64
s_lshl_b32 s36, s30, 1
s_add_u32 s36, s36, s32
s_lshl_b32 s36, s36, 1
v_xor_b32 v195, s36, v195
v_lshlrev_b32 v192, 7, v194
v_lshl_add_u32 v192, v195, 4, v192
v_bfe_u32 v194, v1, 4, 1
v_lshl_add_u32 v192, v194, 13, v192
v_xor_b32 v193, 64, v192
s_lshl_b32 s38, s38, 1
s_lshr_b32 s38, 613566756, s38
s_and_b32 s38, s38, 3
s_lshl_b32 s38, s38, 14
s_add_u32 s38, s38, 98304
v_add_u32 v192, s38, v192
s_lshl_b32 s62, s62, 1
s_lshr_b32 s62, 613566756, s62
s_and_b32 s62, s62, 3
s_lshl_b32 s62, s62, 14
s_add_u32 s62, s62, 98304
v_add_u32 v193, s62, v193
s_and_b32 s98, s96, 15
s_lshr_b64 s[96:97], s[96:97], 4
s_lshl_b32 s40, s98, 7
s_mul_i32 s41, s98, s46
v_lshlrev_b32 v18, 4, v1
s_lshl_b32 s70, s34, 3
s_add_u32 s70, s70, s28
s_and_b32 s36, s70, 15
s_lshl_b32 s36, s36, 2
s_add_u32 s36, s36, s35
s_lshl_b32 s37, s30, 1
s_add_u32 s36, s36, s37
s_bfe_u32 s37, s70, 0x20004
s_add_u32 s38, s37, 1
s_lshr_b32 s38, s38, 1
s_lshl_b32 s38, s38, 10
s_add_u32 s39, s38, s36
s_sub_u32 s71, s38, s36
s_bitcmp1_b32 s37, 0
s_cselect_b32 s39, s71, s39
s_lshr_b32 s37, s37, 1
s_lshl_b32 s37, s37, 9
s_sub_u32 s37, s38, s37
s_cmp_eq_u32 s36, 0
s_cselect_b32 s39, s37, s39
s_lshl_b32 s39, s39, 11
buffer_load_dwordx4 v[232:235], v18, s[4:7], s39 offen
buffer_load_dwordx4 v[236:239], v18, s[4:7], s39 offen offset:1024
s_and_b32 s37, s70, 15
s_lshl_b32 s37, s37, 4
s_bfe_u32 s38, s70, 0x20004
s_lshl2_add_u32 s37, s38, s37
s_lshl_b32 s36, s29, 7
s_add_u32 s70, s70, s36
s_lshr_b32 s36, s70, 6
s_lshl_b32 s36, s36, 8
s_add_u32 s36, s36, s37
s_add_u32 s36, s36, 33554432
s_lshl_b32 s37, s70, 2
s_add_u32 s37, s37, 33587200
s_add_u32 s38, s37, 8192
s_cmp_ge_u32 s28, 6
s_cbranch_scc1 L_spec
s_movk_i32 s63, 0
s_cmp_lg_u32 s64, 0
s_cbranch_scc1 L_xs
L_xr0:
s_movk_i32 s63, 1
s_cmp_lg_u32 s64, 0
s_cbranch_scc1 L_xs
L_xr1:
s_waitcnt vmcnt(8)
s_barrier
s_add_u32 m0, s42, 32768
ds_read_b128 v[56:59], v16 offset:0
buffer_load_dwordx4 v2, s[4:7], s40 offen offset:0 lds
ds_read_b128 v[60:63], v16 offset:2048
ds_read_b64_tr_b16 v[40:41], v8 offset:0
s_movk_i32 s63, 2
s_add_u32 s64, s64, s64
s_cbranch_scc1 L_xs
L_xr2:
ds_read_b64_tr_b16 v[42:43], v8 offset:1792
ds_read_b128 v[64:67], v16 offset:4096
buffer_load_dwordx4 v3, s[4:7], s40 offen offset:1024 lds
ds_read_b128 v[68:71], v16 offset:6144
ds_read_b64_tr_b16 v[44:45], v9 offset:0
ds_read_b64_tr_b16 v[46:47], v9 offset:1792
s_add_u32 m0, s43, 65536
ds_read_b64_tr_b16 v[48:49], v10 offset:0
buffer_load_dwordx4 v4, s[8:11], s41 offen offset:0 lds
ds_read_b64_tr_b16 v[50:51], v10 offset:1792
ds_read_b64_tr_b16 v[52:53], v11 offset:0
ds_read_b64_tr_b16 v[54:55], v11 offset:1792
s_waitcnt lgkmcnt(6)
v_mfma_f32_16x16x32_bf16 v[128:131], v[40:43], v[56:59], 0
v_mfma_f32_16x16x32_bf16 v[132:135], v[40:43], v[60:63], 0
v_mfma_f32_16x16x32_bf16 v[224:227], v[124:127], v[40:43], 0
ds_read_b128 v[72:75], v17 offset:0
buffer_load_dwordx4 v5, s[8:11], s41 offen offset:1024 lds
v_mfma_f32_16x16x32_bf16 v[136:139], v[40:43], v[64:67], 0
v_mfma_f32_16x16x32_bf16 v[140:143], v[40:43], v[68:71], 0
ds_read_b128 v[76:79], v17 offset:2048
ds_read_b64_tr_b16 v[40:41], v8 offset:14336
s_waitcnt lgkmcnt(7)
v_mfma_f32_16x16x32_bf16 v[156:159], v[44:47], v[68:71], 0
ds_read_b64_tr_b16 v[42:43], v8 offset:16128
v_mfma_f32_16x16x32_bf16 v[152:155], v[44:47], v[64:67], 0
v_mfma_f32_16x16x32_bf16 v[228:231], v[124:127], v[44:47], 0
ds_read_b128 v[80:83], v17 offset:4096
v_mfma_f32_16x16x32_bf16 v[148:151], v[44:47], v[60:63], 0
buffer_load_dwordx4 v6, s[8:11], s41 offen offset:2048 lds
v_mfma_f32_16x16x32_bf16 v[144:147], v[44:47], v[56:59], 0
ds_read_b128 v[84:87], v17 offset:6144
ds_read_b64_tr_b16 v[44:45], v9 offset:14336
s_waitcnt lgkmcnt(9)
v_mfma_f32_16x16x32_bf16 v[160:163], v[48:51], v[56:59], 0
ds_read_b64_tr_b16 v[46:47], v9 offset:16128
v_mfma_f32_16x16x32_bf16 v[164:167], v[48:51], v[60:63], 0
v_mfma_f32_16x16x32_bf16 v[168:171], v[48:51], v[64:67], 0
v_mfma_f32_16x16x32_bf16 v[172:175], v[48:51], v[68:71], 0
ds_read_b64_tr_b16 v[48:49], v10 offset:14336
buffer_load_dwordx4 v7, s[8:11], s41 offen offset:3072 lds
s_waitcnt lgkmcnt(9)
v_mfma_f32_16x16x32_bf16 v[188:191], v[52:55], v[68:71], 0
ds_read_b64_tr_b16 v[50:51], v10 offset:16128
s_and_b32 s98, s96, 15
s_lshr_b64 s[96:97], s[96:97], 4
s_lshl_b32 s40, s98, 7
s_mul_i32 s41, s98, s46
v_mfma_f32_16x16x32_bf16 v[184:187], v[52:55], v[64:67], 0
v_mfma_f32_16x16x32_bf16 v[180:183], v[52:55], v[60:63], 0
v_mfma_f32_16x16x32_bf16 v[176:179], v[52:55], v[56:59], 0
ds_read_b64_tr_b16 v[52:53], v11 offset:14336
ds_read_b64_tr_b16 v[54:55], v11 offset:16128
s_waitcnt vmcnt(6)
s_waitcnt lgkmcnt(0)
s_barrier
v_mfma_f32_16x16x32_bf16 v[128:131], v[40:43], v[72:75], v[128:131]
s_add_u32 m0, s42, 0
s_add_u32 s24, s24, 1
v_mov_b32 v0, s24
v_mfma_f32_16x16x32_bf16 v[132:135], v[40:43], v[76:79], v[132:135]
v_mfma_f32_16x16x32_bf16 v[224:227], v[124:127], v[40:43], v[224:227]
ds_read_b128 v[56:59], v16 offset:16384
buffer_load_dwordx4 v2, s[4:7], s40 offen offset:0 lds
v_dot2c_f32_bf16 v28, v232, v124
v_mfma_f32_16x16x32_bf16 v[136:139], v[40:43], v[80:83], v[136:139]
v_mfma_f32_16x16x32_bf16 v[140:143], v[40:43], v[84:87], v[140:143]
ds_read_b128 v[60:63], v16 offset:18432
ds_read_b64_tr_b16 v[40:41], v8 offset:32768
v_dot2c_f32_bf16 v29, v232, v232
s_movk_i32 s63, 3
s_add_u32 s64, s64, s64
s_cbranch_scc1 L_xs
L_xr3:
v_mfma_f32_16x16x32_bf16 v[156:159], v[44:47], v[84:87], v[156:159]
ds_read_b64_tr_b16 v[42:43], v8 offset:34560
v_dot2c_f32_bf16 v28, v233, v124
v_mfma_f32_16x16x32_bf16 v[152:155], v[44:47], v[80:83], v[152:155]
v_mfma_f32_16x16x32_bf16 v[228:231], v[124:127], v[44:47], v[228:231]
ds_read_b128 v[64:67], v16 offset:20480
v_mfma_f32_16x16x32_bf16 v[148:151], v[44:47], v[76:79], v[148:151]
buffer_load_dwordx4 v3, s[4:7], s40 offen offset:1024 lds
v_dot2c_f32_bf16 v29, v233, v233
v_mfma_f32_16x16x32_bf16 v[144:147], v[44:47], v[72:75], v[144:147]
ds_read_b128 v[68:71], v16 offset:22528
ds_read_b64_tr_b16 v[44:45], v9 offset:32768
v_mfma_f32_16x16x32_bf16 v[160:163], v[48:51], v[72:75], v[160:163]
ds_read_b64_tr_b16 v[46:47], v9 offset:34560
v_dot2c_f32_bf16 v28, v234, v124
v_mfma_f32_16x16x32_bf16 v[164:167], v[48:51], v[76:79], v[164:167]
v_dot2c_f32_bf16 v29, v234, v234
v_mfma_f32_16x16x32_bf16 v[168:171], v[48:51], v[80:83], v[168:171]
s_add_u32 m0, s43, 0
v_mfma_f32_16x16x32_bf16 v[172:175], v[48:51], v[84:87], v[172:175]
ds_read_b64_tr_b16 v[48:49], v10 offset:32768
buffer_load_dwordx4 v4, s[8:11], s41 offen offset:0 lds
v_dot2c_f32_bf16 v28, v235, v124
v_mfma_f32_16x16x32_bf16 v[188:191], v[52:55], v[84:87], v[188:191]
ds_read_b64_tr_b16 v[50:51], v10 offset:34560
v_dot2c_f32_bf16 v29, v235, v235
v_mfma_f32_16x16x32_bf16 v[184:187], v[52:55], v[80:83], v[184:187]
v_mfma_f32_16x16x32_bf16 v[180:183], v[52:55], v[76:79], v[180:183]
v_dot2c_f32_bf16 v28, v236, v124
v_mfma_f32_16x16x32_bf16 v[176:179], v[52:55], v[72:75], v[176:179]
ds_read_b64_tr_b16 v[52:53], v11 offset:32768
ds_read_b64_tr_b16 v[54:55], v11 offset:34560
s_waitcnt lgkmcnt(6)
v_mfma_f32_16x16x32_bf16 v[128:131], v[40:43], v[56:59], v[128:131]
v_dot2c_f32_bf16 v29, v236, v236
v_mfma_f32_16x16x32_bf16 v[132:135], v[40:43], v[60:63], v[132:135]
ds_read_b128 v[72:75], v17 offset:16384
buffer_load_dwordx4 v5, s[8:11], s41 offen offset:1024 lds
v_dot2c_f32_bf16 v28, v237, v124
v_mfma_f32_16x16x32_bf16 v[136:139], v[40:43], v[64:67], v[136:139]
v_mfma_f32_16x16x32_bf16 v[140:143], v[40:43], v[68:71], v[140:143]
ds_read_b128 v[76:79], v17 offset:18432
ds_read_b64_tr_b16 v[40:41], v8 offset:47104
v_dot2c_f32_bf16 v29, v237, v237
s_waitcnt lgkmcnt(7)
v_mfma_f32_16x16x32_bf16 v[156:159], v[44:47], v[68:71], v[156:159]
ds_read_b64_tr_b16 v[42:43], v8 offset:48896
v_dot2c_f32_bf16 v28, v238, v124
v_mfma_f32_16x16x32_bf16 v[152:155], v[44:47], v[64:67], v[152:155]
ds_read_b128 v[80:83], v17 offset:20480
v_mfma_f32_16x16x32_bf16 v[148:151], v[44:47], v[60:63], v[148:151]
buffer_load_dwordx4 v6, s[8:11], s41 offen offset:2048 lds
v_dot2c_f32_bf16 v29, v238, v238
v_mfma_f32_16x16x32_bf16 v[144:147], v[44:47], v[56:59], v[144:147]
ds_read_b128 v[84:87], v17 offset:22528
ds_read_b64_tr_b16 v[44:45], v9 offset:47104
s_waitcnt lgkmcnt(9)
v_mfma_f32_16x16x32_bf16 v[160:163], v[48:51], v[56:59], v[160:163]
ds_read_b64_tr_b16 v[46:47], v9 offset:48896
v_dot2c_f32_bf16 v28, v239, v124
v_mfma_f32_16x16x32_bf16 v[164:167], v[48:51], v[60:63], v[164:167]
v_dot2c_f32_bf16 v29, v239, v239
v_mfma_f32_16x16x32_bf16 v[168:171], v[48:51], v[64:67], v[168:171]
v_mfma_f32_16x16x32_bf16 v[172:175], v[48:51], v[68:71], v[172:175]
ds_read_b64_tr_b16 v[48:49], v10 offset:47104
buffer_load_dwordx4 v7, s[8:11], s41 offen offset:3072 lds
v_cndmask_b32 v224, v228, v224, vcc
s_waitcnt lgkmcnt(9)
v_mfma_f32_16x16x32_bf16 v[188:191], v[52:55], v[68:71], v[188:191]
ds_read_b64_tr_b16 v[50:51], v10 offset:48896
s_and_b32 s98, s96, 15
s_lshr_b64 s[96:97], s[96:97], 4
s_lshl_b32 s40, s98, 7
s_mul_i32 s41, s98, s46
v_cvt_pk_bf16_f32 v225, v224, v224
v_mfma_f32_16x16x32_bf16 v[184:187], v[52:55], v[64:67], v[184:187]
v_mfma_f32_16x16x32_bf16 v[180:183], v[52:55], v[60:63], v[180:183]
v_lshlrev_b32 v225, 16, v225
v_mfma_f32_16x16x32_bf16 v[176:179], v[52:55], v[56:59], v[176:179]
ds_read_b64_tr_b16 v[52:53], v11 offset:47104
ds_read_b64_tr_b16 v[54:55], v11 offset:48896
s_waitcnt vmcnt(6)
s_barrier
s_waitcnt lgkmcnt(6)
v_mfma_f32_16x16x32_bf16 v[128:131], v[40:43], v[72:75], v[128:131]
s_add_u32 m0, s42, 16384
v_sub_f32 v225, v224, v225
v_mfma_f32_16x16x32_bf16 v[132:135], v[40:43], v[76:79], v[132:135]
ds_read_b128 v[56:59], v16 offset:32768
buffer_load_dwordx4 v2, s[4:7], s40 offen offset:0 lds
v_cvt_pk_bf16_f32 v225, v224, v225
v_mfma_f32_16x16x32_bf16 v[136:139], v[40:43], v[80:83], v[136:139]
v_mfma_f32_16x16x32_bf16 v[140:143], v[40:43], v[84:87], v[140:143]
ds_read_b128 v[60:63], v16 offset:34816
ds_read_b64_tr_b16 v[40:41], v12 offset:0
buffer_store_dword v225, v20, s[12:15], s73 offen sc0 sc1
s_movk_i32 s63, 4
s_add_u32 s64, s64, s64
s_cbranch_scc1 L_xs
L_xr4:
s_waitcnt lgkmcnt(7)
v_mfma_f32_16x16x32_bf16 v[156:159], v[44:47], v[84:87], v[156:159]
ds_read_b64_tr_b16 v[42:43], v12 offset:1792
s_nop 0
v_add_f32_dpp v28, v28, v28 quad_perm:[1,0,3,2] row_mask:0xf bank_mask:0xf
v_mfma_f32_16x16x32_bf16 v[152:155], v[44:47], v[80:83], v[152:155]
ds_read_b128 v[64:67], v16 offset:36864
v_mfma_f32_16x16x32_bf16 v[148:151], v[44:47], v[76:79], v[148:151]
buffer_load_dwordx4 v3, s[4:7], s40 offen offset:1024 lds
s_nop 0
v_add_f32_dpp v29, v29, v29 quad_perm:[1,0,3,2] row_mask:0xf bank_mask:0xf
v_mfma_f32_16x16x32_bf16 v[144:147], v[44:47], v[72:75], v[144:147]
ds_read_b128 v[68:71], v16 offset:38912
ds_read_b64_tr_b16 v[44:45], v13 offset:0
s_waitcnt lgkmcnt(9)
v_mfma_f32_16x16x32_bf16 v[160:163], v[48:51], v[72:75], v[160:163]
ds_read_b64_tr_b16 v[46:47], v13 offset:1792
s_nop 0
v_add_f32_dpp v28, v28, v28 quad_perm:[2,3,0,1] row_mask:0xf bank_mask:0xf
v_mfma_f32_16x16x32_bf16 v[164:167], v[48:51], v[76:79], v[164:167]
s_nop 0
v_add_f32_dpp v29, v29, v29 quad_perm:[2,3,0,1] row_mask:0xf bank_mask:0xf
v_mfma_f32_16x16x32_bf16 v[168:171], v[48:51], v[80:83], v[168:171]
s_add_u32 m0, s43, 32768
v_mfma_f32_16x16x32_bf16 v[172:175], v[48:51], v[84:87], v[172:175]
ds_read_b64_tr_b16 v[48:49], v14 offset:0
buffer_load_dwordx4 v4, s[8:11], s41 offen offset:0 lds
s_nop 0
v_add_f32_dpp v28, v28, v28 row_half_mirror row_mask:0xf bank_mask:0xf
s_waitcnt lgkmcnt(9)
v_mfma_f32_16x16x32_bf16 v[188:191], v[52:55], v[84:87], v[188:191]
ds_read_b64_tr_b16 v[50:51], v14 offset:1792
v_mfma_f32_16x16x32_bf16 v[184:187], v[52:55], v[80:83], v[184:187]
s_nop 0
v_add_f32_dpp v29, v29, v29 row_half_mirror row_mask:0xf bank_mask:0xf
v_mfma_f32_16x16x32_bf16 v[180:183], v[52:55], v[76:79], v[180:183]
s_nop 0
v_add_f32_dpp v28, v28, v28 row_mirror row_mask:0xf bank_mask:0xf
v_mfma_f32_16x16x32_bf16 v[176:179], v[52:55], v[72:75], v[176:179]
ds_read_b64_tr_b16 v[52:53], v15 offset:0
ds_read_b64_tr_b16 v[54:55], v15 offset:1792
s_waitcnt lgkmcnt(6)
v_mfma_f32_16x16x32_bf16 v[128:131], v[40:43], v[56:59], v[128:131]
s_nop 0
v_add_f32_dpp v29, v29, v29 row_mirror row_mask:0xf bank_mask:0xf
v_mfma_f32_16x16x32_bf16 v[132:135], v[40:43], v[60:63], v[132:135]
ds_read_b128 v[72:75], v17 offset:32768
buffer_load_dwordx4 v5, s[8:11], s41 offen offset:1024 lds
s_nop 0
v_add_f32_dpp v28, v28, v28 row_bcast:15 row_mask:0xa bank_mask:0xf
v_mfma_f32_16x16x32_bf16 v[136:139], v[40:43], v[64:67], v[136:139]
v_mfma_f32_16x16x32_bf16 v[140:143], v[40:43], v[68:71], v[140:143]
ds_read_b128 v[76:79], v17 offset:34816
ds_read_b64_tr_b16 v[40:41], v12 offset:14336
s_nop 0
v_add_f32_dpp v29, v29, v29 row_bcast:15 row_mask:0xa bank_mask:0xf
s_waitcnt lgkmcnt(7)
v_mfma_f32_16x16x32_bf16 v[156:159], v[44:47], v[68:71], v[156:159]
ds_read_b64_tr_b16 v[42:43], v12 offset:16128
v_mfma_f32_16x16x32_bf16 v[152:155], v[44:47], v[64:67], v[152:155]
ds_read_b128 v[80:83], v17 offset:36864
s_nop 0
v_add_f32_dpp v28, v28, v28 row_bcast:31 row_mask:0xc bank_mask:0xf
v_mfma_f32_16x16x32_bf16 v[148:151], v[44:47], v[60:63], v[148:151]
buffer_load_dwordx4 v6, s[8:11], s41 offen offset:2048 lds
s_nop 0
v_add_f32_dpp v29, v29, v29 row_bcast:31 row_mask:0xc bank_mask:0xf
v_mfma_f32_16x16x32_bf16 v[144:147], v[44:47], v[56:59], v[144:147]
ds_read_b128 v[84:87], v17 offset:38912
ds_read_b64_tr_b16 v[44:45], v13 offset:14336
s_waitcnt lgkmcnt(9)
v_mfma_f32_16x16x32_bf16 v[160:163], v[48:51], v[56:59], v[160:163]
ds_read_b64_tr_b16 v[46:47], v13 offset:16128
v_mul_f32 v28, 0x3a800000, v28
v_mfma_f32_16x16x32_bf16 v[164:167], v[48:51], v[60:63], v[164:167]
v_mul_f32 v29, 0x3a800000, v29
v_mfma_f32_16x16x32_bf16 v[168:171], v[48:51], v[64:67], v[168:171]
v_mfma_f32_16x16x32_bf16 v[172:175], v[48:51], v[68:71], v[172:175]
ds_read_b64_tr_b16 v[48:49], v14 offset:14336
buffer_load_dwordx4 v7, s[8:11], s41 offen offset:3072 lds
v_fma_f32 v29, -v28, v28, v29
s_waitcnt lgkmcnt(9)
v_mfma_f32_16x16x32_bf16 v[188:191], v[52:55], v[68:71], v[188:191]
ds_read_b64_tr_b16 v[50:51], v14 offset:16128
s_and_b32 s98, s96, 15
s_lshr_b64 s[96:97], s[96:97], 4
s_lshl_b32 s40, s98, 7
s_mul_i32 s41, s98, s46
v_mfma_f32_16x16x32_bf16 v[184:187], v[52:55], v[64:67], v[184:187]
v_cvt_pk_bf16_f32 v29, v29, v29
v_mfma_f32_16x16x32_bf16 v[180:183], v[52:55], v[60:63], v[180:183]
v_lshlrev_b32 v29, 16, v29
v_mfma_f32_16x16x32_bf16 v[176:179], v[52:55], v[56:59], v[176:179]
ds_read_b64_tr_b16 v[52:53], v15 offset:14336
ds_read_b64_tr_b16 v[54:55], v15 offset:16128
s_waitcnt vmcnt(7)
s_barrier
s_waitcnt lgkmcnt(6)
v_mfma_f32_16x16x32_bf16 v[128:131], v[40:43], v[72:75], v[128:131]
s_add_u32 m0, s42, 32768
v_add_f32 v29, 0x3727c5ac, v29
v_mfma_f32_16x16x32_bf16 v[132:135], v[40:43], v[76:79], v[132:135]
ds_read_b128 v[56:59], v16 offset:0
buffer_load_dwordx4 v2, s[4:7], s40 offen offset:0 lds
v_cvt_pk_bf16_f32 v29, v29, v29
v_mfma_f32_16x16x32_bf16 v[136:139], v[40:43], v[80:83], v[136:139]
v_mfma_f32_16x16x32_bf16 v[140:143], v[40:43], v[84:87], v[140:143]
ds_read_b128 v[60:63], v16 offset:2048
ds_read_b64_tr_b16 v[40:41], v8 offset:0
v_lshlrev_b32 v29, 16, v29
s_movk_i32 s63, 5
s_add_u32 s64, s64, s64
s_cbranch_scc1 L_xs
L_xr5:
s_waitcnt lgkmcnt(7)
v_mfma_f32_16x16x32_bf16 v[156:159], v[44:47], v[84:87], v[156:159]
ds_read_b64_tr_b16 v[42:43], v8 offset:1792
v_mfma_f32_16x16x32_bf16 v[152:155], v[44:47], v[80:83], v[152:155]
ds_read_b128 v[64:67], v16 offset:4096
v_sqrt_f32 v29, v29
v_mfma_f32_16x16x32_bf16 v[148:151], v[44:47], v[76:79], v[148:151]
buffer_load_dwordx4 v3, s[4:7], s40 offen offset:1024 lds
v_cvt_pk_bf16_f32 v32, -v28, -v28
v_mfma_f32_16x16x32_bf16 v[144:147], v[44:47], v[72:75], v[144:147]
ds_read_b128 v[68:71], v16 offset:6144
ds_read_b64_tr_b16 v[44:45], v9 offset:0
s_waitcnt lgkmcnt(9)
v_mfma_f32_16x16x32_bf16 v[160:163], v[48:51], v[72:75], v[160:163]
ds_read_b64_tr_b16 v[46:47], v9 offset:1792
v_cvt_pk_bf16_f32 v28, v28, v28
v_mfma_f32_16x16x32_bf16 v[164:167], v[48:51], v[76:79], v[164:167]
v_lshlrev_b32 v28, 16, v28
v_mfma_f32_16x16x32_bf16 v[168:171], v[48:51], v[80:83], v[168:171]
s_add_u32 m0, s43, 65536
v_mfma_f32_16x16x32_bf16 v[172:175], v[48:51], v[84:87], v[172:175]
ds_read_b64_tr_b16 v[48:49], v10 offset:0
buffer_load_dwordx4 v4, s[8:11], s41 offen offset:0 lds
v_cvt_pk_bf16_f32 v29, v29, v29
s_waitcnt lgkmcnt(9)
v_mfma_f32_16x16x32_bf16 v[188:191], v[52:55], v[84:87], v[188:191]
ds_read_b64_tr_b16 v[50:51], v10 offset:1792
v_mfma_f32_16x16x32_bf16 v[184:187], v[52:55], v[80:83], v[184:187]
v_lshlrev_b32 v29, 16, v29
v_mfma_f32_16x16x32_bf16 v[180:183], v[52:55], v[76:79], v[180:183]
v_rcp_f32 v29, v29
v_mfma_f32_16x16x32_bf16 v[176:179], v[52:55], v[72:75], v[176:179]
ds_read_b64_tr_b16 v[52:53], v11 offset:0
ds_read_b64_tr_b16 v[54:55], v11 offset:1792
s_waitcnt lgkmcnt(6)
v_mfma_f32_16x16x32_bf16 v[128:131], v[40:43], v[56:59], v[128:131]
s_lshl_b32 s39, s29, 3
s_add_u32 s39, s39, s31
s_mul_i32 s39, s39, 6
s_add_u32 s39, s39, s28
s_mul_i32 s39, s39, 1600
s_mul_i32 s78, s30, 3653632
s_add_u32 s78, s78, s39
v_mfma_f32_16x16x32_bf16 v[132:135], v[40:43], v[60:63], v[132:135]
ds_read_b128 v[72:75], v17 offset:0
buffer_load_dwordx4 v5, s[8:11], s41 offen offset:1024 lds
v_lshlrev_b32 v88, 6, v1
v_mfma_f32_16x16x32_bf16 v[136:139], v[40:43], v[64:67], v[136:139]
v_mfma_f32_16x16x32_bf16 v[140:143], v[40:43], v[68:71], v[140:143]
ds_read_b128 v[76:79], v17 offset:2048
ds_read_b64_tr_b16 v[40:41], v8 offset:14336
v_cmp_gt_u32 s[58:59], 25, v1
v_bfrev_b32 v89, 2
s_waitcnt lgkmcnt(7)
v_mfma_f32_16x16x32_bf16 v[156:159], v[44:47], v[68:71], v[156:159]
ds_read_b64_tr_b16 v[42:43], v8 offset:16128
v_mfma_f32_16x16x32_bf16 v[152:155], v[44:47], v[64:67], v[152:155]
ds_read_b128 v[80:83], v17 offset:4096
v_cndmask_b32 v88, v89, v88, s[58:59]
v_mfma_f32_16x16x32_bf16 v[148:151], v[44:47], v[60:63], v[148:151]
buffer_load_dwordx4 v6, s[8:11], s41 offen offset:2048 lds
v_mov_b32 v30, s3
v_mfma_f32_16x16x32_bf16 v[144:147], v[44:47], v[56:59], v[144:147]
ds_read_b128 v[84:87], v17 offset:6144
ds_read_b64_tr_b16 v[44:45], v9 offset:14336
s_waitcnt lgkmcnt(9)
v_mfma_f32_16x16x32_bf16 v[160:163], v[48:51], v[56:59], v[160:163]
ds_read_b64_tr_b16 v[46:47], v9 offset:16128
s_mov_b32 exec_lo, 0
s_brev_b32 exec_hi, 1
buffer_store_dword v32, v19, s[12:15], s36 offen sc0 sc1
buffer_store_dword v28, v19, s[12:15], s38 offen sc0 sc1
buffer_store_dword v29, v19, s[12:15], s37 offen sc0 sc1
buffer_store_dword v30, v19, s[12:15], s48 offen offset:96 sc0 sc1
s_add_u32 s36, s36, 0x4000
buffer_store_dword v29, v19, s[12:15], s36 offen sc0 sc1
s_mov_b64 exec, -1
v_mfma_f32_16x16x32_bf16 v[164:167], v[48:51], v[60:63], v[164:167]
v_mfma_f32_16x16x32_bf16 v[168:171], v[48:51], v[64:67], v[168:171]
v_mfma_f32_16x16x32_bf16 v[172:175], v[48:51], v[68:71], v[172:175]
ds_read_b64_tr_b16 v[48:49], v10 offset:14336
buffer_load_dwordx4 v7, s[8:11], s41 offen offset:3072 lds
s_waitcnt lgkmcnt(9)
v_mfma_f32_16x16x32_bf16 v[188:191], v[52:55], v[68:71], v[188:191]
ds_read_b64_tr_b16 v[50:51], v10 offset:16128
s_and_b32 s98, s96, 15
s_lshr_b64 s[96:97], s[96:97], 4
s_lshl_b32 s40, s98, 7
s_mul_i32 s41, s98, s46
v_mfma_f32_16x16x32_bf16 v[184:187], v[52:55], v[64:67], v[184:187]
v_mfma_f32_16x16x32_bf16 v[180:183], v[52:55], v[60:63], v[180:183]
v_mfma_f32_16x16x32_bf16 v[176:179], v[52:55], v[56:59], v[176:179]
ds_read_b64_tr_b16 v[52:53], v11 offset:14336
ds_read_b64_tr_b16 v[54:55], v11 offset:16128
s_mov_b32 s44, 3
.p2align 3
LN_loop:
s_waitcnt vmcnt(6)
s_barrier
s_waitcnt lgkmcnt(6)
v_mfma_f32_16x16x32_bf16 v[128:131], v[40:43], v[72:75], v[128:131]
s_add_u32 m0, s42, 0
v_mfma_f32_16x16x32_bf16 v[132:135], v[40:43], v[76:79], v[132:135]
ds_read_b128 v[56:59], v16 offset:16384
buffer_load_dwordx4 v2, s[4:7], s40 offen offset:0 lds
v_mfma_f32_16x16x32_bf16 v[136:139], v[40:43], v[80:83], v[136:139]
v_mfma_f32_16x16x32_bf16 v[140:143], v[40:43], v[84:87], v[140:143]
ds_read_b128 v[60:63], v16 offset:18432
ds_read_b64_tr_b16 v[40:41], v8 offset:32768
s_movk_i32 s63, 6
s_add_u32 s64, s64, s64
s_cbranch_scc1 L_xs
L_xr6:
s_waitcnt lgkmcnt(7)
v_mfma_f32_16x16x32_bf16 v[156:159], v[44:47], v[84:87], v[156:159]
ds_read_b64_tr_b16 v[42:43], v8 offset:34560
v_mfma_f32_16x16x32_bf16 v[152:155], v[44:47], v[80:83], v[152:155]
ds_read_b128 v[64:67], v16 offset:20480
v_mfma_f32_16x16x32_bf16 v[148:151], v[44:47], v[76:79], v[148:151]
buffer_load_dwordx4 v3, s[4:7], s40 offen offset:1024 lds
v_mfma_f32_16x16x32_bf16 v[144:147], v[44:47], v[72:75], v[144:147]
ds_read_b128 v[68:71], v16 offset:22528
ds_read_b64_tr_b16 v[44:45], v9 offset:32768
s_waitcnt lgkmcnt(9)
v_mfma_f32_16x16x32_bf16 v[160:163], v[48:51], v[72:75], v[160:163]
ds_read_b64_tr_b16 v[46:47], v9 offset:34560
v_mfma_f32_16x16x32_bf16 v[164:167], v[48:51], v[76:79], v[164:167]
v_mfma_f32_16x16x32_bf16 v[168:171], v[48:51], v[80:83], v[168:171]
s_add_u32 m0, s43, 0
v_mfma_f32_16x16x32_bf16 v[172:175], v[48:51], v[84:87], v[172:175]
ds_read_b64_tr_b16 v[48:49], v10 offset:32768
buffer_load_dwordx4 v4, s[8:11], s41 offen offset:0 lds
s_waitcnt lgkmcnt(9)
v_mfma_f32_16x16x32_bf16 v[188:191], v[52:55], v[84:87], v[188:191]
ds_read_b64_tr_b16 v[50:51], v10 offset:34560
v_mfma_f32_16x16x32_bf16 v[184:187], v[52:55], v[80:83], v[184:187]
v_mfma_f32_16x16x32_bf16 v[180:183], v[52:55], v[76:79], v[180:183]
v_mfma_f32_16x16x32_bf16 v[176:179], v[52:55], v[72:75], v[176:179]
ds_read_b64_tr_b16 v[52:53], v11 offset:32768
ds_read_b64_tr_b16 v[54:55], v11 offset:34560
s_waitcnt lgkmcnt(6)
v_mfma_f32_16x16x32_bf16 v[128:131], v[40:43], v[56:59], v[128:131]
v_mfma_f32_16x16x32_bf16 v[132:135], v[40:43], v[60:63], v[132:135]
ds_read_b128 v[72:75], v17 offset:16384
buffer_load_dwordx4 v5, s[8:11], s41 offen offset:1024 lds
v_mfma_f32_16x16x32_bf16 v[136:139], v[40:43], v[64:67], v[136:139]
v_mfma_f32_16x16x32_bf16 v[140:143], v[40:43], v[68:71], v[140:143]
ds_read_b128 v[76:79], v17 offset:18432
ds_read_b64_tr_b16 v[40:41], v8 offset:47104
s_waitcnt lgkmcnt(7)
v_mfma_f32_16x16x32_bf16 v[156:159], v[44:47], v[68:71], v[156:159]
ds_read_b64_tr_b16 v[42:43], v8 offset:48896
v_mfma_f32_16x16x32_bf16 v[152:155], v[44:47], v[64:67], v[152:155]
ds_read_b128 v[80:83], v17 offset:20480
v_mfma_f32_16x16x32_bf16 v[148:151], v[44:47], v[60:63], v[148:151]
buffer_load_dwordx4 v6, s[8:11], s41 offen offset:2048 lds
v_mfma_f32_16x16x32_bf16 v[144:147], v[44:47], v[56:59], v[144:147]
ds_read_b128 v[84:87], v17 offset:22528
ds_read_b64_tr_b16 v[44:45], v9 offset:47104
s_waitcnt lgkmcnt(9)
v_mfma_f32_16x16x32_bf16 v[160:163], v[48:51], v[56:59], v[160:163]
ds_read_b64_tr_b16 v[46:47], v9 offset:48896
v_mfma_f32_16x16x32_bf16 v[164:167], v[48:51], v[60:63], v[164:167]
v_mfma_f32_16x16x32_bf16 v[168:171], v[48:51], v[64:67], v[168:171]
v_mfma_f32_16x16x32_bf16 v[172:175], v[48:51], v[68:71], v[172:175]
ds_read_b64_tr_b16 v[48:49], v10 offset:47104
buffer_load_dwordx4 v7, s[8:11], s41 offen offset:3072 lds
s_waitcnt lgkmcnt(9)
v_mfma_f32_16x16x32_bf16 v[188:191], v[52:55], v[68:71], v[188:191]
ds_read_b64_tr_b16 v[50:51], v10 offset:48896
s_and_b32 s98, s96, 15
s_lshr_b64 s[96:97], s[96:97], 4
s_lshl_b32 s40, s98, 7
s_mul_i32 s41, s98, s46
v_mfma_f32_16x16x32_bf16 v[184:187], v[52:55], v[64:67], v[184:187]
v_mfma_f32_16x16x32_bf16 v[180:183], v[52:55], v[60:63], v[180:183]
v_mfma_f32_16x16x32_bf16 v[176:179], v[52:55], v[56:59], v[176:179]
ds_read_b64_tr_b16 v[52:53], v11 offset:47104
ds_read_b64_tr_b16 v[54:55], v11 offset:48896
s_waitcnt vmcnt(6)
s_barrier
s_cmp_lg_u32 s44, s45
s_cbranch_scc1 LN_nf
s_mov_b64 exec, 1
buffer_store_dword v0, v19, s[12:15], s48 offen offset:64 sc0 sc1
s_mov_b64 exec, -1
LN_nf:
s_waitcnt lgkmcnt(6)
v_mfma_f32_16x16x32_bf16 v[128:131], v[40:43], v[72:75], v[128:131]
s_add_u32 m0, s42, 16384
v_mfma_f32_16x16x32_bf16 v[132:135], v[40:43], v[76:79], v[132:135]
ds_read_b128 v[56:59], v16 offset:32768
buffer_load_dwordx4 v2, s[4:7], s40 offen offset:0 lds
v_mfma_f32_16x16x32_bf16 v[136:139], v[40:43], v[80:83], v[136:139]
buffer_load_dword v89, v88, s[16:19], s78 offen
v_mfma_f32_16x16x32_bf16 v[140:143], v[40:43], v[84:87], v[140:143]
ds_read_b128 v[60:63], v16 offset:34816
ds_read_b64_tr_b16 v[40:41], v12 offset:0
s_add_u32 s78, s78, 1228800
s_movk_i32 s63, 7
s_add_u32 s64, s64, s64
s_cbranch_scc1 L_xs
L_xr7:
s_waitcnt lgkmcnt(7)
v_mfma_f32_16x16x32_bf16 v[156:159], v[44:47], v[84:87], v[156:159]
ds_read_b64_tr_b16 v[42:43], v12 offset:1792
v_mfma_f32_16x16x32_bf16 v[152:155], v[44:47], v[80:83], v[152:155]
ds_read_b128 v[64:67], v16 offset:36864
v_mfma_f32_16x16x32_bf16 v[148:151], v[44:47], v[76:79], v[148:151]
buffer_load_dwordx4 v3, s[4:7], s40 offen offset:1024 lds
v_mfma_f32_16x16x32_bf16 v[144:147], v[44:47], v[72:75], v[144:147]
ds_read_b128 v[68:71], v16 offset:38912
ds_read_b64_tr_b16 v[44:45], v13 offset:0
s_waitcnt lgkmcnt(9)
v_mfma_f32_16x16x32_bf16 v[160:163], v[48:51], v[72:75], v[160:163]
ds_read_b64_tr_b16 v[46:47], v13 offset:1792
v_mfma_f32_16x16x32_bf16 v[164:167], v[48:51], v[76:79], v[164:167]
v_mfma_f32_16x16x32_bf16 v[168:171], v[48:51], v[80:83], v[168:171]
s_add_u32 m0, s43, 32768
v_mfma_f32_16x16x32_bf16 v[172:175], v[48:51], v[84:87], v[172:175]
ds_read_b64_tr_b16 v[48:49], v14 offset:0
buffer_load_dwordx4 v4, s[8:11], s41 offen offset:0 lds
s_waitcnt lgkmcnt(9)
v_mfma_f32_16x16x32_bf16 v[188:191], v[52:55], v[84:87], v[188:191]
ds_read_b64_tr_b16 v[50:51], v14 offset:1792
v_mfma_f32_16x16x32_bf16 v[184:187], v[52:55], v[80:83], v[184:187]
v_mfma_f32_16x16x32_bf16 v[180:183], v[52:55], v[76:79], v[180:183]
v_mfma_f32_16x16x32_bf16 v[176:179], v[52:55], v[72:75], v[176:179]
ds_read_b64_tr_b16 v[52:53], v15 offset:0
ds_read_b64_tr_b16 v[54:55], v15 offset:1792
s_waitcnt lgkmcnt(6)
v_mfma_f32_16x16x32_bf16 v[128:131], v[40:43], v[56:59], v[128:131]
v_mfma_f32_16x16x32_bf16 v[132:135], v[40:43], v[60:63], v[132:135]
ds_read_b128 v[72:75], v17 offset:32768
buffer_load_dwordx4 v5, s[8:11], s41 offen offset:1024 lds
v_mfma_f32_16x16x32_bf16 v[136:139], v[40:43], v[64:67], v[136:139]
v_mfma_f32_16x16x32_bf16 v[140:143], v[40:43], v[68:71], v[140:143]
ds_read_b128 v[76:79], v17 offset:34816
ds_read_b64_tr_b16 v[40:41], v12 offset:14336
s_waitcnt lgkmcnt(7)
v_mfma_f32_16x16x32_bf16 v[156:159], v[44:47], v[68:71], v[156:159]
ds_read_b64_tr_b16 v[42:43], v12 offset:16128
v_mfma_f32_16x16x32_bf16 v[152:155], v[44:47], v[64:67], v[152:155]
ds_read_b128 v[80:83], v17 offset:36864
v_mfma_f32_16x16x32_bf16 v[148:151], v[44:47], v[60:63], v[148:151]
buffer_load_dwordx4 v6, s[8:11], s41 offen offset:2048 lds
v_mfma_f32_16x16x32_bf16 v[144:147], v[44:47], v[56:59], v[144:147]
ds_read_b128 v[84:87], v17 offset:38912
ds_read_b64_tr_b16 v[44:45], v13 offset:14336
s_waitcnt lgkmcnt(9)
v_mfma_f32_16x16x32_bf16 v[160:163], v[48:51], v[56:59], v[160:163]
ds_read_b64_tr_b16 v[46:47], v13 offset:16128
v_mfma_f32_16x16x32_bf16 v[164:167], v[48:51], v[60:63], v[164:167]
v_mfma_f32_16x16x32_bf16 v[168:171], v[48:51], v[64:67], v[168:171]
v_mfma_f32_16x16x32_bf16 v[172:175], v[48:51], v[68:71], v[172:175]
ds_read_b64_tr_b16 v[48:49], v14 offset:14336
buffer_load_dwordx4 v7, s[8:11], s41 offen offset:3072 lds
s_waitcnt lgkmcnt(9)
v_mfma_f32_16x16x32_bf16 v[188:191], v[52:55], v[68:71], v[188:191]
ds_read_b64_tr_b16 v[50:51], v14 offset:16128
s_and_b32 s98, s96, 15
s_lshr_b64 s[96:97], s[96:97], 4
s_lshl_b32 s40, s98, 7
s_mul_i32 s41, s98, s46
v_mfma_f32_16x16x32_bf16 v[184:187], v[52:55], v[64:67], v[184:187]
v_mfma_f32_16x16x32_bf16 v[180:183], v[52:55], v[60:63], v[180:183]
v_mfma_f32_16x16x32_bf16 v[176:179], v[52:55], v[56:59], v[176:179]
ds_read_b64_tr_b16 v[52:53], v15 offset:14336
ds_read_b64_tr_b16 v[54:55], v15 offset:16128
s_waitcnt vmcnt(7)
s_barrier
s_cmp_lg_u32 s44, s25
s_cbranch_scc1 LN_np
buffer_load_dword v22, v21, s[12:15], s26 offen sc0 sc1
LN_np:
s_waitcnt lgkmcnt(6)
v_mfma_f32_16x16x32_bf16 v[128:131], v[40:43], v[72:75], v[128:131]
s_add_u32 m0, s42, 32768
v_mfma_f32_16x16x32_bf16 v[132:135], v[40:43], v[76:79], v[132:135]
ds_read_b128 v[56:59], v16 offset:0
buffer_load_dwordx4 v2, s[4:7], s40 offen offset:0 lds
v_mfma_f32_16x16x32_bf16 v[136:139], v[40:43], v[80:83], v[136:139]
v_mfma_f32_16x16x32_bf16 v[140:143], v[40:43], v[84:87], v[140:143]
ds_read_b128 v[60:63], v16 offset:2048
ds_read_b64_tr_b16 v[40:41], v8 offset:0
s_movk_i32 s63, 8
s_add_u32 s64, s64, s64
s_cbranch_scc1 L_xs
L_xr8:
s_waitcnt lgkmcnt(7)
v_mfma_f32_16x16x32_bf16 v[156:159], v[44:47], v[84:87], v[156:159]
ds_read_b64_tr_b16 v[42:43], v8 offset:1792
v_mfma_f32_16x16x32_bf16 v[152:155], v[44:47], v[80:83], v[152:155]
ds_read_b128 v[64:67], v16 offset:4096
v_mfma_f32_16x16x32_bf16 v[148:151], v[44:47], v[76:79], v[148:151]
buffer_load_dwordx4 v3, s[4:7], s40 offen offset:1024 lds
v_mfma_f32_16x16x32_bf16 v[144:147], v[44:47], v[72:75], v[144:147]
ds_read_b128 v[68:71], v16 offset:6144
ds_read_b64_tr_b16 v[44:45], v9 offset:0
s_waitcnt lgkmcnt(9)
v_mfma_f32_16x16x32_bf16 v[160:163], v[48:51], v[72:75], v[160:163]
ds_read_b64_tr_b16 v[46:47], v9 offset:1792
v_mfma_f32_16x16x32_bf16 v[164:167], v[48:51], v[76:79], v[164:167]
v_mfma_f32_16x16x32_bf16 v[168:171], v[48:51], v[80:83], v[168:171]
s_add_u32 m0, s43, 65536
v_mfma_f32_16x16x32_bf16 v[172:175], v[48:51], v[84:87], v[172:175]
ds_read_b64_tr_b16 v[48:49], v10 offset:0
buffer_load_dwordx4 v4, s[8:11], s41 offen offset:0 lds
s_waitcnt lgkmcnt(9)
v_mfma_f32_16x16x32_bf16 v[188:191], v[52:55], v[84:87], v[188:191]
ds_read_b64_tr_b16 v[50:51], v10 offset:1792
v_mfma_f32_16x16x32_bf16 v[184:187], v[52:55], v[80:83], v[184:187]
v_mfma_f32_16x16x32_bf16 v[180:183], v[52:55], v[76:79], v[180:183]
v_mfma_f32_16x16x32_bf16 v[176:179], v[52:55], v[72:75], v[176:179]
ds_read_b64_tr_b16 v[52:53], v11 offset:0
ds_read_b64_tr_b16 v[54:55], v11 offset:1792
s_waitcnt lgkmcnt(6)
v_mfma_f32_16x16x32_bf16 v[128:131], v[40:43], v[56:59], v[128:131]
v_mfma_f32_16x16x32_bf16 v[132:135], v[40:43], v[60:63], v[132:135]
ds_read_b128 v[72:75], v17 offset:0
buffer_load_dwordx4 v5, s[8:11], s41 offen offset:1024 lds
v_mfma_f32_16x16x32_bf16 v[136:139], v[40:43], v[64:67], v[136:139]
v_mfma_f32_16x16x32_bf16 v[140:143], v[40:43], v[68:71], v[140:143]
ds_read_b128 v[76:79], v17 offset:2048
ds_read_b64_tr_b16 v[40:41], v8 offset:14336
s_waitcnt lgkmcnt(7)
v_mfma_f32_16x16x32_bf16 v[156:159], v[44:47], v[68:71], v[156:159]
ds_read_b64_tr_b16 v[42:43], v8 offset:16128
v_mfma_f32_16x16x32_bf16 v[152:155], v[44:47], v[64:67], v[152:155]
ds_read_b128 v[80:83], v17 offset:4096
v_mfma_f32_16x16x32_bf16 v[148:151], v[44:47], v[60:63], v[148:151]
buffer_load_dwordx4 v6, s[8:11], s41 offen offset:2048 lds
v_mfma_f32_16x16x32_bf16 v[144:147], v[44:47], v[56:59], v[144:147]
ds_read_b128 v[84:87], v17 offset:6144
ds_read_b64_tr_b16 v[44:45], v9 offset:14336
s_waitcnt lgkmcnt(9)
v_mfma_f32_16x16x32_bf16 v[160:163], v[48:51], v[56:59], v[160:163]
ds_read_b64_tr_b16 v[46:47], v9 offset:16128
v_mfma_f32_16x16x32_bf16 v[164:167], v[48:51], v[60:63], v[164:167]
v_mfma_f32_16x16x32_bf16 v[168:171], v[48:51], v[64:67], v[168:171]
v_mfma_f32_16x16x32_bf16 v[172:175], v[48:51], v[68:71], v[172:175]
ds_read_b64_tr_b16 v[48:49], v10 offset:14336
buffer_load_dwordx4 v7, s[8:11], s41 offen offset:3072 lds
s_waitcnt lgkmcnt(9)
v_mfma_f32_16x16x32_bf16 v[188:191], v[52:55], v[68:71], v[188:191]
ds_read_b64_tr_b16 v[50:51], v10 offset:16128
s_and_b32 s98, s96, 15
s_lshr_b64 s[96:97], s[96:97], 4
s_lshl_b32 s40, s98, 7
s_mul_i32 s41, s98, s46
v_mfma_f32_16x16x32_bf16 v[184:187], v[52:55], v[64:67], v[184:187]
v_mfma_f32_16x16x32_bf16 v[180:183], v[52:55], v[60:63], v[180:183]
v_mfma_f32_16x16x32_bf16 v[176:179], v[52:55], v[56:59], v[176:179]
ds_read_b64_tr_b16 v[52:53], v11 offset:14336
ds_read_b64_tr_b16 v[54:55], v11 offset:16128
s_sub_u32 s44, s44, 1
s_cmp_gt_i32 s44, 0
s_cbranch_scc1 LN_loop
s_waitcnt vmcnt(6)
s_cmp_lg_u32 s28, 0
s_cbranch_scc1 LN_ck2
s_mov_b32 s69, 4000
LN_ck0:
v_cmp_ne_u32 vcc, v0, v22
s_cmp_eq_u64 vcc, 0
s_cbranch_scc1 LN_ck2
s_sub_u32 s69, s69, 1
s_cmp_eq_u32 s69, 0
s_cbranch_scc1 LN_ck2
buffer_load_dword v22, v21, s[12:15], s26 offen sc0 sc1
s_waitcnt vmcnt(0)
s_branch LN_ck0
LN_ck2:
s_barrier
s_waitcnt lgkmcnt(6)
v_mfma_f32_16x16x32_bf16 v[128:131], v[40:43], v[72:75], v[128:131]
s_add_u32 m0, s42, 0
v_lshrrev_b32 v25, 4, v1
v_mfma_f32_16x16x32_bf16 v[132:135], v[40:43], v[76:79], v[132:135]
ds_read_b128 v[56:59], v16 offset:16384
buffer_load_dwordx4 v2, s[4:7], s40 offen offset:0 lds
v_and_b32 v24, 15, v1
v_mfma_f32_16x16x32_bf16 v[136:139], v[40:43], v[80:83], v[136:139]
v_lshlrev_b32 v24, 4, v24
s_lshr_b32 s98, s28, 2
s_lshl_b32 s99, s98, 14
s_add_u32 s99, s99, s50
s_lshl_b32 s98, s98, 11
s_add_u32 s98, s98, s52
v_mfma_f32_16x16x32_bf16 v[140:143], v[40:43], v[84:87], v[140:143]
ds_read_b128 v[60:63], v16 offset:18432
ds_read_b64_tr_b16 v[40:41], v8 offset:32768
buffer_load_dwordx4 v3, s[4:7], s40 offen offset:1024 lds
v_lshl_add_u32 v23, v25, 12, v24
s_movk_i32 s63, 9
s_add_u32 s64, s64, s64
s_cbranch_scc1 L_xs
L_xr9:
s_waitcnt lgkmcnt(7)
v_mfma_f32_16x16x32_bf16 v[156:159], v[44:47], v[84:87], v[156:159]
ds_read_b64_tr_b16 v[42:43], v8 offset:34560
s_add_u32 m0, s43, 0
s_lshl_b32 s36, s28, 1
v_mfma_f32_16x16x32_bf16 v[152:155], v[44:47], v[80:83], v[152:155]
ds_read_b128 v[64:67], v16 offset:20480
buffer_load_dwordx4 v4, s[8:11], s41 offen offset:0 lds
s_min_u32 s36, s36, 12
v_mfma_f32_16x16x32_bf16 v[148:151], v[44:47], v[76:79], v[148:151]
s_lshl_b32 s36, s36, 8
v_mfma_f32_16x16x32_bf16 v[144:147], v[44:47], v[72:75], v[144:147]
ds_read_b128 v[68:71], v16 offset:22528
ds_read_b64_tr_b16 v[44:45], v9 offset:32768
s_add_u32 s73, s72, s36
s_waitcnt lgkmcnt(9)
v_mfma_f32_16x16x32_bf16 v[160:163], v[48:51], v[72:75], v[160:163]
ds_read_b64_tr_b16 v[46:47], v9 offset:34560
buffer_load_dwordx4 v5, s[8:11], s41 offen offset:1024 lds
s_xor_b32 s74, s73, 512
v_mfma_f32_16x16x32_bf16 v[164:167], v[48:51], v[76:79], v[164:167]
s_lshl_b32 s36, s29, 1
v_mfma_f32_16x16x32_bf16 v[168:171], v[48:51], v[80:83], v[168:171]
buffer_load_dwordx4 v6, s[8:11], s41 offen offset:2048 lds
s_add_u32 s36, s36, s32
v_mfma_f32_16x16x32_bf16 v[172:175], v[48:51], v[84:87], v[172:175]
ds_read_b64_tr_b16 v[48:49], v10 offset:32768
s_lshl_b32 s75, s36, 8
s_waitcnt lgkmcnt(9)
v_mfma_f32_16x16x32_bf16 v[188:191], v[52:55], v[84:87], v[188:191]
ds_read_b64_tr_b16 v[50:51], v10 offset:34560
s_add_u32 s75, s75, 33554432
v_mfma_f32_16x16x32_bf16 v[184:187], v[52:55], v[80:83], v[184:187]
buffer_load_dwordx4 v7, s[8:11], s41 offen offset:3072 lds
s_lshl_b32 s76, s36, 8
v_mfma_f32_16x16x32_bf16 v[180:183], v[52:55], v[76:79], v[180:183]
s_add_u32 s76, s76, 33587200
v_mfma_f32_16x16x32_bf16 v[176:179], v[52:55], v[72:75], v[176:179]
ds_read_b64_tr_b16 v[52:53], v11 offset:32768
ds_read_b64_tr_b16 v[54:55], v11 offset:34560
buffer_load_dwordx4 v[224:227], v23, s[12:15], s73 offen offset:0 sc0 sc1
v_lshlrev_b32 v25, 4, v25
s_waitcnt lgkmcnt(6)
v_mfma_f32_16x16x32_bf16 v[128:131], v[40:43], v[56:59], v[128:131]
v_mfma_f32_16x16x32_bf16 v[132:135], v[40:43], v[60:63], v[132:135]
ds_read_b128 v[72:75], v17 offset:16384
v_mfma_f32_16x16x32_bf16 v[136:139], v[40:43], v[64:67], v[136:139]
buffer_load_dwordx4 v[228:231], v23, s[12:15], s73 offen offset:256 sc0 sc1
v_mfma_f32_16x16x32_bf16 v[140:143], v[40:43], v[68:71], v[140:143]
ds_read_b128 v[76:79], v17 offset:18432
ds_read_b64_tr_b16 v[40:41], v8 offset:47104
s_waitcnt lgkmcnt(7)
v_mfma_f32_16x16x32_bf16 v[156:159], v[44:47], v[68:71], v[156:159]
ds_read_b64_tr_b16 v[42:43], v8 offset:48896
buffer_load_dwordx4 v[232:235], v23, s[12:15], s74 offen offset:0 sc0 sc1
v_mfma_f32_16x16x32_bf16 v[152:155], v[44:47], v[64:67], v[152:155]
ds_read_b128 v[80:83], v17 offset:20480
v_mfma_f32_16x16x32_bf16 v[148:151], v[44:47], v[60:63], v[148:151]
v_mfma_f32_16x16x32_bf16 v[144:147], v[44:47], v[56:59], v[144:147]
ds_read_b128 v[84:87], v17 offset:22528
ds_read_b64_tr_b16 v[44:45], v9 offset:47104
buffer_load_dwordx4 v[236:239], v23, s[12:15], s74 offen offset:256 sc0 sc1
s_waitcnt lgkmcnt(9)
v_mfma_f32_16x16x32_bf16 v[160:163], v[48:51], v[56:59], v[160:163]
ds_read_b64_tr_b16 v[46:47], v9 offset:48896
v_mfma_f32_16x16x32_bf16 v[164:167], v[48:51], v[60:63], v[164:167]
buffer_load_dwordx4 v[252:255], v24, s[12:15], s75 offen sc0 sc1
v_mfma_f32_16x16x32_bf16 v[168:171], v[48:51], v[64:67], v[168:171]
v_mfma_f32_16x16x32_bf16 v[172:175], v[48:51], v[68:71], v[172:175]
ds_read_b64_tr_b16 v[48:49], v10 offset:47104
s_add_u32 m0, s98, 147456
s_add_u32 s97, s99, 131072
s_waitcnt lgkmcnt(9)
v_mfma_f32_16x16x32_bf16 v[188:191], v[52:55], v[68:71], v[188:191]
ds_read_b64_tr_b16 v[50:51], v10 offset:48896
buffer_load_dwordx4 v120, s[16:19], s97 offen offset:0 lds
v_mfma_f32_16x16x32_bf16 v[184:187], v[52:55], v[64:67], v[184:187]
v_mfma_f32_16x16x32_bf16 v[180:183], v[52:55], v[60:63], v[180:183]
buffer_load_dwordx4 v121, s[16:19], s97 offen offset:1024 lds
v_mfma_f32_16x16x32_bf16 v[176:179], v[52:55], v[56:59], v[176:179]
ds_read_b64_tr_b16 v[52:53], v11 offset:47104
ds_read_b64_tr_b16 v[54:55], v11 offset:48896
s_cmp_ge_u32 s28, 4
s_cbranch_scc1 L_nh
s_waitcnt vmcnt(13)
s_barrier
s_bfe_u32 s36, s28, 0x10001
s_lshl_b32 s36, s36, 16
s_sub_u32 s54, s51, 3735552
s_add_u32 s54, s54, s36
s_sub_u32 s51, s50, s36
s_cmp_ge_u32 s54, s51
s_cselect_b32 s39, 458752, 0
s_add_u32 s39, s39, s54
s_add_u32 s50, s51, 393216
s_cmp_lg_u32 s36, 0
s_cselect_b32 s50, s39, s50
s_waitcnt lgkmcnt(6)
v_mfma_f32_16x16x32_bf16 v[128:131], v[40:43], v[72:75], v[128:131]
s_add_u32 m0, s98, 114688
s_add_u32 s97, s99, 0
v_bfe_u32 v30, v1, 2, 4
v_mfma_f32_16x16x32_bf16 v[132:135], v[40:43], v[76:79], v[132:135]
ds_read_b128 v[56:59], v16 offset:32768
buffer_load_dwordx4 v120, s[16:19], s97 offen offset:0 lds
v_lshlrev_b32 v31, 8, v30
v_mfma_f32_16x16x32_bf16 v[136:139], v[40:43], v[80:83], v[136:139]
v_mfma_f32_16x16x32_bf16 v[140:143], v[40:43], v[84:87], v[140:143]
ds_read_b128 v[60:63], v16 offset:34816
ds_read_b64_tr_b16 v[40:41], v12 offset:0
buffer_load_dwordx4 v121, s[16:19], s97 offen offset:1024 lds
v_and_b32 v32, 3, v1
s_waitcnt lgkmcnt(7)
v_mfma_f32_16x16x32_bf16 v[156:159], v[44:47], v[84:87], v[156:159]
ds_read_b64_tr_b16 v[42:43], v12 offset:1792
v_mfma_f32_16x16x32_bf16 v[152:155], v[44:47], v[80:83], v[152:155]
ds_read_b128 v[64:67], v16 offset:36864
v_lshl_add_u32 v31, v32, 3, v31
v_mfma_f32_16x16x32_bf16 v[148:151], v[44:47], v[76:79], v[148:151]
buffer_load_dword v22, v21, s[12:15], s26 offen offset:32 sc0 sc1
v_and_b32 v30, 7, v30
v_mfma_f32_16x16x32_bf16 v[144:147], v[44:47], v[72:75], v[144:147]
ds_read_b128 v[68:71], v16 offset:38912
ds_read_b64_tr_b16 v[44:45], v13 offset:0
s_waitcnt lgkmcnt(9)
v_mfma_f32_16x16x32_bf16 v[160:163], v[48:51], v[72:75], v[160:163]
ds_read_b64_tr_b16 v[46:47], v13 offset:1792
s_lshl_b32 s36, s30, 1
v_xor_b32 v30, s36, v30
v_mfma_f32_16x16x32_bf16 v[164:167], v[48:51], v[76:79], v[164:167]
buffer_load_dwordx4 v[88:91], v120, s[16:19], s50 offen offset:0
v_mfma_f32_16x16x32_bf16 v[168:171], v[48:51], v[80:83], v[168:171]
v_xor_b32 v32, 0, v30
v_mfma_f32_16x16x32_bf16 v[172:175], v[48:51], v[84:87], v[172:175]
ds_read_b64_tr_b16 v[48:49], v14 offset:0
v_lshl_add_u32 v104, v32, 5, v31
s_waitcnt lgkmcnt(9)
v_mfma_f32_16x16x32_bf16 v[188:191], v[52:55], v[84:87], v[188:191]
ds_read_b64_tr_b16 v[50:51], v14 offset:1792
buffer_load_dwordx4 v[92:95], v121, s[16:19], s50 offen offset:1024
v_mfma_f32_16x16x32_bf16 v[184:187], v[52:55], v[80:83], v[184:187]
v_add_u32 v112, 98304, v104
v_mfma_f32_16x16x32_bf16 v[180:183], v[52:55], v[76:79], v[180:183]
v_mfma_f32_16x16x32_bf16 v[176:179], v[52:55], v[72:75], v[176:179]
ds_read_b64_tr_b16 v[52:53], v15 offset:0
ds_read_b64_tr_b16 v[54:55], v15 offset:1792
buffer_load_dwordx4 v[96:99], v122, s[16:19], s50 offen offset:2048
v_xor_b32 v32, 1, v30
s_waitcnt lgkmcnt(6)
v_mfma_f32_16x16x32_bf16 v[128:131], v[40:43], v[56:59], v[128:131]
v_lshl_add_u32 v105, v32, 5, v31
v_mfma_f32_16x16x32_bf16 v[132:135], v[40:43], v[60:63], v[132:135]
ds_read_b128 v[72:75], v17 offset:32768
v_mfma_f32_16x16x32_bf16 v[136:139], v[40:43], v[64:67], v[136:139]
buffer_load_dwordx4 v[100:103], v123, s[16:19], s50 offen offset:3072
v_add_u32 v113, 98304, v105
v_mfma_f32_16x16x32_bf16 v[140:143], v[40:43], v[68:71], v[140:143]
ds_read_b128 v[76:79], v17 offset:34816
ds_read_b64_tr_b16 v[40:41], v12 offset:14336
s_add_u32 s54, s54, 131072
s_cmp_ge_u32 s54, s51
s_cselect_b32 s39, 458752, 0
s_add_u32 s50, s54, s39
s_waitcnt lgkmcnt(7)
v_mfma_f32_16x16x32_bf16 v[156:159], v[44:47], v[68:71], v[156:159]
ds_read_b64_tr_b16 v[42:43], v12 offset:16128
v_xor_b32 v32, 6, v30
v_mfma_f32_16x16x32_bf16 v[152:155], v[44:47], v[64:67], v[152:155]
ds_read_b128 v[80:83], v17 offset:36864
buffer_load_dwordx4 v[192:195], v120, s[16:19], s50 offen offset:0
v_lshl_add_u32 v106, v32, 5, v31
v_mfma_f32_16x16x32_bf16 v[148:151], v[44:47], v[60:63], v[148:151]
v_mfma_f32_16x16x32_bf16 v[144:147], v[44:47], v[56:59], v[144:147]
ds_read_b128 v[84:87], v17 offset:38912
ds_read_b64_tr_b16 v[44:45], v13 offset:14336
v_add_u32 v114, 98304, v106
s_waitcnt lgkmcnt(9)
v_mfma_f32_16x16x32_bf16 v[160:163], v[48:51], v[56:59], v[160:163]
ds_read_b64_tr_b16 v[46:47], v13 offset:16128
buffer_load_dwordx4 v[196:199], v121, s[16:19], s50 offen offset:1024
v_mfma_f32_16x16x32_bf16 v[164:167], v[48:51], v[60:63], v[164:167]
v_xor_b32 v32, 7, v30
v_mfma_f32_16x16x32_bf16 v[168:171], v[48:51], v[64:67], v[168:171]
v_lshl_add_u32 v107, v32, 5, v31
v_mfma_f32_16x16x32_bf16 v[172:175], v[48:51], v[68:71], v[172:175]
ds_read_b64_tr_b16 v[48:49], v14 offset:14336
buffer_load_dwordx4 v[200:203], v122, s[16:19], s50 offen offset:2048
s_waitcnt lgkmcnt(9)
v_mfma_f32_16x16x32_bf16 v[188:191], v[52:55], v[68:71], v[188:191]
ds_read_b64_tr_b16 v[50:51], v14 offset:16128
v_add_u32 v115, 98304, v107
v_mfma_f32_16x16x32_bf16 v[184:187], v[52:55], v[64:67], v[184:187]
v_mfma_f32_16x16x32_bf16 v[180:183], v[52:55], v[60:63], v[180:183]
buffer_load_dwordx4 v[204:207], v123, s[16:19], s50 offen offset:3072
v_xor_b32 v32, 2, v30
v_mfma_f32_16x16x32_bf16 v[176:179], v[52:55], v[56:59], v[176:179]
ds_read_b64_tr_b16 v[52:53], v15 offset:14336
ds_read_b64_tr_b16 v[54:55], v15 offset:16128
s_add_u32 s54, s54, 131072
s_cmp_ge_u32 s54, s51
s_cselect_b32 s39, 458752, 0
s_add_u32 s50, s54, s39
v_lshl_add_u32 v108, v32, 5, v31
s_waitcnt vmcnt(18)
s_barrier
s_waitcnt lgkmcnt(6)
v_mfma_f32_16x16x32_bf16 v[128:131], v[40:43], v[72:75], v[128:131]
s_add_u32 m0, s98, 131072
s_add_u32 s97, s99, 262144
v_mfma_f32_16x16x32_bf16 v[132:135], v[40:43], v[76:79], v[132:135]
ds_read_b128 v[56:59], v16 offset:0
buffer_load_dwordx4 v120, s[16:19], s97 offen offset:0 lds
v_add_u32 v116, 98304, v108
v_mfma_f32_16x16x32_bf16 v[136:139], v[40:43], v[80:83], v[136:139]
v_mfma_f32_16x16x32_bf16 v[140:143], v[40:43], v[84:87], v[140:143]
ds_read_b128 v[60:63], v16 offset:2048
ds_read_b64_tr_b16 v[40:41], v8 offset:0
v_xor_b32 v32, 3, v30
s_waitcnt lgkmcnt(7)
v_mfma_f32_16x16x32_bf16 v[156:159], v[44:47], v[84:87], v[156:159]
ds_read_b64_tr_b16 v[42:43], v8 offset:1792
v_lshl_add_u32 v109, v32, 5, v31
v_mfma_f32_16x16x32_bf16 v[152:155], v[44:47], v[80:83], v[152:155]
ds_read_b128 v[64:67], v16 offset:4096
v_mfma_f32_16x16x32_bf16 v[148:151], v[44:47], v[76:79], v[148:151]
buffer_load_dwordx4 v121, s[16:19], s97 offen offset:1024 lds
v_add_u32 v117, 98304, v109
v_mfma_f32_16x16x32_bf16 v[144:147], v[44:47], v[72:75], v[144:147]
ds_read_b128 v[68:71], v16 offset:6144
ds_read_b64_tr_b16 v[44:45], v9 offset:0
s_waitcnt lgkmcnt(9)
v_mfma_f32_16x16x32_bf16 v[160:163], v[48:51], v[72:75], v[160:163]
ds_read_b64_tr_b16 v[46:47], v9 offset:1792
v_xor_b32 v32, 4, v30
s_waitcnt vmcnt(15)
v_mfma_f32_16x16x32_bf16 v[164:167], v[48:51], v[76:79], v[164:167]
v_lshl_add_u32 v110, v32, 5, v31
v_mov_b32 v240, v252
v_mfma_f32_16x16x32_bf16 v[168:171], v[48:51], v[80:83], v[168:171]
v_mov_b32 v241, v252
v_mfma_f32_16x16x32_bf16 v[172:175], v[48:51], v[84:87], v[172:175]
ds_read_b64_tr_b16 v[48:49], v10 offset:0
buffer_load_dwordx4 v[208:211], v120, s[16:19], s50 offen offset:0
v_add_u32 v118, 98304, v110
v_mov_b32 v242, v252
s_waitcnt lgkmcnt(9)
v_mfma_f32_16x16x32_bf16 v[188:191], v[52:55], v[84:87], v[188:191]
ds_read_b64_tr_b16 v[50:51], v10 offset:1792
v_mov_b32 v243, v252
v_mfma_f32_16x16x32_bf16 v[184:187], v[52:55], v[80:83], v[184:187]
v_xor_b32 v32, 5, v30
v_mov_b32 v244, v253
v_mfma_f32_16x16x32_bf16 v[180:183], v[52:55], v[76:79], v[180:183]
v_lshl_add_u32 v111, v32, 5, v31
v_mov_b32 v245, v253
v_mfma_f32_16x16x32_bf16 v[176:179], v[52:55], v[72:75], v[176:179]
ds_read_b64_tr_b16 v[52:53], v11 offset:0
ds_read_b64_tr_b16 v[54:55], v11 offset:1792
v_mov_b32 v246, v253
s_waitcnt lgkmcnt(6)
v_mfma_f32_16x16x32_bf16 v[128:131], v[40:43], v[56:59], v[128:131]
v_add_u32 v119, 98304, v111
v_mov_b32 v247, v253
v_mfma_f32_16x16x32_bf16 v[132:135], v[40:43], v[60:63], v[132:135]
ds_read_b128 v[72:75], v17 offset:0
buffer_load_dwordx4 v[212:215], v121, s[16:19], s50 offen offset:1024
v_mov_b32 v248, v254
v_mfma_f32_16x16x32_bf16 v[136:139], v[40:43], v[64:67], v[136:139]
s_mul_i32 s36, s28, 14336
s_add_u32 s36, s36, 32768
v_add_u32 v124, s36, v18
v_mov_b32 v249, v254
v_mfma_f32_16x16x32_bf16 v[140:143], v[40:43], v[68:71], v[140:143]
ds_read_b128 v[76:79], v17 offset:2048
ds_read_b64_tr_b16 v[40:41], v8 offset:14336
v_lshlrev_b32 v125, 2, v1
v_mov_b32 v250, v254
s_waitcnt lgkmcnt(7)
v_mfma_f32_16x16x32_bf16 v[156:159], v[44:47], v[68:71], v[156:159]
ds_read_b64_tr_b16 v[42:43], v8 offset:16128
v_mov_b32 v251, v254
v_mfma_f32_16x16x32_bf16 v[152:155], v[44:47], v[64:67], v[152:155]
ds_read_b128 v[80:83], v17 offset:4096
v_add_u32 v125, 97792, v125
v_mov_b32 v252, v255
v_mfma_f32_16x16x32_bf16 v[148:151], v[44:47], v[60:63], v[148:151]
buffer_load_dwordx4 v[216:219], v122, s[16:19], s50 offen offset:2048
v_mov_b32 v253, v255
v_mfma_f32_16x16x32_bf16 v[144:147], v[44:47], v[56:59], v[144:147]
ds_read_b128 v[84:87], v17 offset:6144
ds_read_b64_tr_b16 v[44:45], v9 offset:14336
s_lshl_b32 s60, 0x11111111, s28
s_mov_b32 s61, 0
v_mov_b32 v254, v255
s_waitcnt lgkmcnt(9)
v_mfma_f32_16x16x32_bf16 v[160:163], v[48:51], v[56:59], v[160:163]
ds_read_b64_tr_b16 v[46:47], v9 offset:16128
s_lshl_b32 s36, s29, 2
s_add_u32 s36, s36, s28
s_lshl_b32 s36, s36, 1
s_add_u32 s36, s36, s30
s_mul_i32 s36, s36, 114688
s_mul_i32 s37, s31, 14336
s_add_u32 s55, s36, s37
s_cmp_eq_u32 s31, 0
s_cselect_b32 s37, 14336, 0
s_add_u32 s53, s36, s37
v_mfma_f32_16x16x32_bf16 v[164:167], v[48:51], v[60:63], v[164:167]
v_mfma_f32_16x16x32_bf16 v[168:171], v[48:51], v[64:67], v[168:171]
s_lshl_b32 s36, s2, 2
s_add_u32 s36, s36, s28
s_lshl_b32 s67, s36, 13
s_add_u32 s67, s67, 25165824
v_mfma_f32_16x16x32_bf16 v[172:175], v[48:51], v[68:71], v[172:175]
ds_read_b64_tr_b16 v[48:49], v10 offset:14336
buffer_load_dwordx4 v[220:223], v123, s[16:19], s50 offen offset:3072
s_waitcnt lgkmcnt(9)
v_mfma_f32_16x16x32_bf16 v[188:191], v[52:55], v[68:71], v[188:191]
ds_read_b64_tr_b16 v[50:51], v10 offset:16128
s_add_u32 s54, s54, 131072
s_cmp_ge_u32 s54, s51
s_cselect_b32 s39, 458752, 0
s_add_u32 s50, s54, s39
s_mov_b32 s40, 117835008
s_mov_b32 s41, 117835009
s_mov_b32 s42, 117835010
s_mov_b32 s43, 117835011
v_mfma_f32_16x16x32_bf16 v[184:187], v[52:55], v[64:67], v[184:187]
v_mfma_f32_16x16x32_bf16 v[180:183], v[52:55], v[60:63], v[180:183]
v_mfma_f32_16x16x32_bf16 v[176:179], v[52:55], v[56:59], v[176:179]
ds_read_b64_tr_b16 v[52:53], v11 offset:14336
ds_read_b64_tr_b16 v[54:55], v11 offset:16128
s_waitcnt vmcnt(14)
v_cmp_ne_u32 vcc, s3, v22
s_lshl_b32 s39, s30, 3
s_nop 0
s_lshr_b32 s39, vcc_lo, s39
s_and_b32 s39, s39, 0xff
s_cselect_b32 s27, 0, 1
v_mfma_f32_16x16x32_bf16 v[128:131], v[224:227], v[240:243], v[128:131]
s_mul_i32 s36, s29, 917504
v_mfma_f32_16x16x32_bf16 v[132:135], v[224:227], v[244:247], v[132:135]
s_mul_i32 s37, s34, 14336
v_mfma_f32_16x16x32_bf16 v[136:139], v[224:227], v[248:251], v[136:139]
s_add_u32 s36, s36, s37
v_mfma_f32_16x16x32_bf16 v[140:143], v[224:227], v[252:255], v[140:143]
s_min_u32 s37, s28, 6
v_mfma_f32_16x16x32_bf16 v[144:147], v[228:231], v[240:243], v[144:147]
s_lshl_b32 s37, s37, 11
v_mfma_f32_16x16x32_bf16 v[148:151], v[228:231], v[244:247], v[148:151]
s_lshl_b32 s38, s32, 10
v_mfma_f32_16x16x32_bf16 v[152:155], v[228:231], v[248:251], v[152:155]
s_add_u32 s37, s37, s38
v_mfma_f32_16x16x32_bf16 v[156:159], v[228:231], v[252:255], v[156:159]
v_add_u32 v26, s37, v18
v_mfma_f32_16x16x32_bf16 v[160:163], v[232:235], v[240:243], v[160:163]
v_xor_b32 v27, 2048, v26
v_mfma_f32_16x16x32_bf16 v[164:167], v[232:235], v[244:247], v[164:167]
s_add_u32 s78, s36, 229376
v_mfma_f32_16x16x32_bf16 v[168:171], v[232:235], v[248:251], v[168:171]
s_add_u32 s79, s36, 458752
v_mfma_f32_16x16x32_bf16 v[172:175], v[232:235], v[252:255], v[172:175]
s_add_u32 s37, s36, 688128
v_mfma_f32_16x16x32_bf16 v[176:179], v[236:239], v[240:243], v[176:179]
v_add_u32 v28, 32768, v26
v_mfma_f32_16x16x32_bf16 v[180:183], v[236:239], v[244:247], v[180:183]
v_add_u32 v29, 32768, v27
v_mfma_f32_16x16x32_bf16 v[184:187], v[236:239], v[248:251], v[184:187]
v_mfma_f32_16x16x32_bf16 v[188:191], v[236:239], v[252:255], v[188:191]
s_cmp_lg_u32 s27, 0
s_cbranch_scc1 LTC_l
s_waitcnt lgkmcnt(6)
v_mfma_f32_16x16x32_bf16 v[128:131], v[40:43], v[72:75], v[128:131]
v_mfma_f32_16x16x32_bf16 v[132:135], v[40:43], v[76:79], v[132:135]
v_mfma_f32_16x16x32_bf16 v[136:139], v[40:43], v[80:83], v[136:139]
v_mfma_f32_16x16x32_bf16 v[140:143], v[40:43], v[84:87], v[140:143]
s_waitcnt lgkmcnt(4)
v_mfma_f32_16x16x32_bf16 v[156:159], v[44:47], v[84:87], v[156:159]
v_mfma_f32_16x16x32_bf16 v[152:155], v[44:47], v[80:83], v[152:155]
v_mfma_f32_16x16x32_bf16 v[148:151], v[44:47], v[76:79], v[148:151]
v_cvt_pk_bf16_f32 v140, v140, v141
v_cvt_pk_bf16_f32 v141, v142, v143
v_cvt_pk_bf16_f32 v142, v156, v157
v_cvt_pk_bf16_f32 v143, v158, v159
v_pk_max_i16 v140, v140, 0
v_mfma_f32_16x16x32_bf16 v[144:147], v[44:47], v[72:75], v[144:147]
v_pk_max_i16 v141, v141, 0
v_pk_max_i16 v142, v142, 0
v_pk_max_i16 v143, v143, 0
buffer_store_dwordx4 v[140:143], v26, s[12:15], s37 offen sc0 sc1
ds_write_b128 v28, v[140:143] offset:43008
s_waitcnt lgkmcnt(3)
v_mfma_f32_16x16x32_bf16 v[160:163], v[48:51], v[72:75], v[160:163]
v_cvt_pk_bf16_f32 v136, v136, v137
v_cvt_pk_bf16_f32 v137, v138, v139
v_cvt_pk_bf16_f32 v138, v152, v153
v_cvt_pk_bf16_f32 v139, v154, v155
v_pk_max_i16 v136, v136, 0
v_mfma_f32_16x16x32_bf16 v[164:167], v[48:51], v[76:79], v[164:167]
v_pk_max_i16 v137, v137, 0
v_pk_max_i16 v138, v138, 0
v_pk_max_i16 v139, v139, 0
buffer_store_dwordx4 v[136:139], v26, s[12:15], s79 offen sc0 sc1
ds_write_b128 v28, v[136:139] offset:28672
v_mfma_f32_16x16x32_bf16 v[168:171], v[48:51], v[80:83], v[168:171]
v_cvt_pk_bf16_f32 v132, v132, v133
v_cvt_pk_bf16_f32 v133, v134, v135
v_cvt_pk_bf16_f32 v134, v148, v149
v_cvt_pk_bf16_f32 v135, v150, v151
v_pk_max_i16 v132, v132, 0
v_mfma_f32_16x16x32_bf16 v[172:175], v[48:51], v[84:87], v[172:175]
v_pk_max_i16 v133, v133, 0
v_pk_max_i16 v134, v134, 0
v_pk_max_i16 v135, v135, 0
buffer_store_dwordx4 v[132:135], v26, s[12:15], s78 offen sc0 sc1
ds_write_b128 v26, v[132:135] offset:47104
s_waitcnt lgkmcnt(3)
v_mfma_f32_16x16x32_bf16 v[188:191], v[52:55], v[84:87], v[188:191]
v_cvt_pk_bf16_f32 v128, v128, v129
v_cvt_pk_bf16_f32 v129, v130, v131
v_cvt_pk_bf16_f32 v130, v144, v145
v_cvt_pk_bf16_f32 v131, v146, v147
v_pk_max_i16 v128, v128, 0
v_mfma_f32_16x16x32_bf16 v[184:187], v[52:55], v[80:83], v[184:187]
v_pk_max_i16 v129, v129, 0
v_pk_max_i16 v130, v130, 0
v_pk_max_i16 v131, v131, 0
buffer_store_dwordx4 v[128:131], v26, s[12:15], s36 offen sc0 sc1
ds_write_b128 v26, v[128:131] offset:32768
v_mfma_f32_16x16x32_bf16 v[180:183], v[52:55], v[76:79], v[180:183]
v_mfma_f32_16x16x32_bf16 v[176:179], v[52:55], v[72:75], v[176:179]
v_cvt_pk_bf16_f32 v172, v172, v173
v_cvt_pk_bf16_f32 v173, v174, v175
v_cvt_pk_bf16_f32 v174, v188, v189
v_cvt_pk_bf16_f32 v175, v190, v191
v_pk_max_i16 v172, v172, 0
v_pk_max_i16 v173, v173, 0
v_pk_max_i16 v174, v174, 0
v_pk_max_i16 v175, v175, 0
buffer_store_dwordx4 v[172:175], v27, s[12:15], s37 offen sc0 sc1
ds_write_b128 v29, v[172:175] offset:43008
v_cvt_pk_bf16_f32 v168, v168, v169
v_cvt_pk_bf16_f32 v169, v170, v171
v_cvt_pk_bf16_f32 v170, v184, v185
v_cvt_pk_bf16_f32 v171, v186, v187
v_pk_max_i16 v168, v168, 0
v_pk_max_i16 v169, v169, 0
v_pk_max_i16 v170, v170, 0
v_pk_max_i16 v171, v171, 0
buffer_store_dwordx4 v[168:171], v27, s[12:15], s79 offen sc0 sc1
ds_write_b128 v29, v[168:171] offset:28672
v_cvt_pk_bf16_f32 v164, v164, v165
v_cvt_pk_bf16_f32 v165, v166, v167
v_cvt_pk_bf16_f32 v166, v180, v181
v_cvt_pk_bf16_f32 v167, v182, v183
v_pk_max_i16 v164, v164, 0
v_pk_max_i16 v165, v165, 0
v_pk_max_i16 v166, v166, 0
v_pk_max_i16 v167, v167, 0
buffer_store_dwordx4 v[164:167], v27, s[12:15], s78 offen sc0 sc1
ds_write_b128 v27, v[164:167] offset:47104
v_cvt_pk_bf16_f32 v160, v160, v161
v_cvt_pk_bf16_f32 v161, v162, v163
v_cvt_pk_bf16_f32 v162, v176, v177
v_cvt_pk_bf16_f32 v163, v178, v179
v_pk_max_i16 v160, v160, 0
v_pk_max_i16 v161, v161, 0
v_pk_max_i16 v162, v162, 0
v_pk_max_i16 v163, v163, 0
buffer_store_dwordx4 v[160:163], v27, s[12:15], s36 offen sc0 sc1
ds_write_b128 v27, v[160:163] offset:32768
s_branch LTC_j
LTC_l:
s_waitcnt lgkmcnt(6)
v_mfma_f32_16x16x32_bf16 v[128:131], v[40:43], v[72:75], v[128:131]
v_mfma_f32_16x16x32_bf16 v[132:135], v[40:43], v[76:79], v[132:135]
v_mfma_f32_16x16x32_bf16 v[136:139], v[40:43], v[80:83], v[136:139]
v_mfma_f32_16x16x32_bf16 v[140:143], v[40:43], v[84:87], v[140:143]
s_waitcnt lgkmcnt(4)
v_mfma_f32_16x16x32_bf16 v[156:159], v[44:47], v[84:87], v[156:159]
v_mfma_f32_16x16x32_bf16 v[152:155], v[44:47], v[80:83], v[152:155]
v_mfma_f32_16x16x32_bf16 v[148:151], v[44:47], v[76:79], v[148:151]
v_cvt_pk_bf16_f32 v140, v140, v141
v_cvt_pk_bf16_f32 v141, v142, v143
v_cvt_pk_bf16_f32 v142, v156, v157
v_cvt_pk_bf16_f32 v143, v158, v159
v_pk_max_i16 v140, v140, 0
v_mfma_f32_16x16x32_bf16 v[144:147], v[44:47], v[72:75], v[144:147]
v_pk_max_i16 v141, v141, 0
v_pk_max_i16 v142, v142, 0
v_pk_max_i16 v143, v143, 0
buffer_store_dwordx4 v[140:143], v26, s[12:15], s37 offen sc1
ds_write_b128 v28, v[140:143] offset:43008
s_waitcnt lgkmcnt(3)
v_mfma_f32_16x16x32_bf16 v[160:163], v[48:51], v[72:75], v[160:163]
v_cvt_pk_bf16_f32 v136, v136, v137
v_cvt_pk_bf16_f32 v137, v138, v139
v_cvt_pk_bf16_f32 v138, v152, v153
v_cvt_pk_bf16_f32 v139, v154, v155
v_pk_max_i16 v136, v136, 0
v_mfma_f32_16x16x32_bf16 v[164:167], v[48:51], v[76:79], v[164:167]
v_pk_max_i16 v137, v137, 0
v_pk_max_i16 v138, v138, 0
v_pk_max_i16 v139, v139, 0
buffer_store_dwordx4 v[136:139], v26, s[12:15], s79 offen sc1
ds_write_b128 v28, v[136:139] offset:28672
v_mfma_f32_16x16x32_bf16 v[168:171], v[48:51], v[80:83], v[168:171]
v_cvt_pk_bf16_f32 v132, v132, v133
v_cvt_pk_bf16_f32 v133, v134, v135
v_cvt_pk_bf16_f32 v134, v148, v149
v_cvt_pk_bf16_f32 v135, v150, v151
v_pk_max_i16 v132, v132, 0
v_mfma_f32_16x16x32_bf16 v[172:175], v[48:51], v[84:87], v[172:175]
v_pk_max_i16 v133, v133, 0
v_pk_max_i16 v134, v134, 0
v_pk_max_i16 v135, v135, 0
buffer_store_dwordx4 v[132:135], v26, s[12:15], s78 offen sc1
ds_write_b128 v26, v[132:135] offset:47104
s_waitcnt lgkmcnt(3)
v_mfma_f32_16x16x32_bf16 v[188:191], v[52:55], v[84:87], v[188:191]
v_cvt_pk_bf16_f32 v128, v128, v129
v_cvt_pk_bf16_f32 v129, v130, v131
v_cvt_pk_bf16_f32 v130, v144, v145
v_cvt_pk_bf16_f32 v131, v146, v147
v_pk_max_i16 v128, v128, 0
v_mfma_f32_16x16x32_bf16 v[184:187], v[52:55], v[80:83], v[184:187]
v_pk_max_i16 v129, v129, 0
v_pk_max_i16 v130, v130, 0
v_pk_max_i16 v131, v131, 0
buffer_store_dwordx4 v[128:131], v26, s[12:15], s36 offen sc1
ds_write_b128 v26, v[128:131] offset:32768
v_mfma_f32_16x16x32_bf16 v[180:183], v[52:55], v[76:79], v[180:183]
v_mfma_f32_16x16x32_bf16 v[176:179], v[52:55], v[72:75], v[176:179]
v_cvt_pk_bf16_f32 v172, v172, v173
v_cvt_pk_bf16_f32 v173, v174, v175
v_cvt_pk_bf16_f32 v174, v188, v189
v_cvt_pk_bf16_f32 v175, v190, v191
v_pk_max_i16 v172, v172, 0
v_pk_max_i16 v173, v173, 0
v_pk_max_i16 v174, v174, 0
v_pk_max_i16 v175, v175, 0
buffer_store_dwordx4 v[172:175], v27, s[12:15], s37 offen sc1
ds_write_b128 v29, v[172:175] offset:43008
v_cvt_pk_bf16_f32 v168, v168, v169
v_cvt_pk_bf16_f32 v169, v170, v171
v_cvt_pk_bf16_f32 v170, v184, v185
v_cvt_pk_bf16_f32 v171, v186, v187
v_pk_max_i16 v168, v168, 0
v_pk_max_i16 v169, v169, 0
v_pk_max_i16 v170, v170, 0
v_pk_max_i16 v171, v171, 0
buffer_store_dwordx4 v[168:171], v27, s[12:15], s79 offen sc1
ds_write_b128 v29, v[168:171] offset:28672
v_cvt_pk_bf16_f32 v164, v164, v165
v_cvt_pk_bf16_f32 v165, v166, v167
v_cvt_pk_bf16_f32 v166, v180, v181
v_cvt_pk_bf16_f32 v167, v182, v183
v_pk_max_i16 v164, v164, 0
v_pk_max_i16 v165, v165, 0
v_pk_max_i16 v166, v166, 0
v_pk_max_i16 v167, v167, 0
buffer_store_dwordx4 v[164:167], v27, s[12:15], s78 offen sc1
ds_write_b128 v27, v[164:167] offset:47104
v_cvt_pk_bf16_f32 v160, v160, v161
v_cvt_pk_bf16_f32 v161, v162, v163
v_cvt_pk_bf16_f32 v162, v176, v177
v_cvt_pk_bf16_f32 v163, v178, v179
v_pk_max_i16 v160, v160, 0
v_pk_max_i16 v161, v161, 0
v_pk_max_i16 v162, v162, 0
v_pk_max_i16 v163, v163, 0
buffer_store_dwordx4 v[160:163], v27, s[12:15], s36 offen sc1
ds_write_b128 v27, v[160:163] offset:32768
LTC_j:
v_add_u32 v20, s52, v18
v_add_u32 v21, 0x10000, v20
s_waitcnt lgkmcnt(0)
s_waitcnt vmcnt(12)
s_barrier
ds_read_b128 v[224:227], v124 offset:0
ds_read_b128 v[228:231], v124 offset:1024
ds_read_b64_tr_b16 v[24:25], v112 offset:16384
ds_read_b64_tr_b16 v[26:27], v112 offset:20480
ds_read_b64_tr_b16 v[28:29], v113 offset:16384
ds_read_b64_tr_b16 v[30:31], v113 offset:20480
ds_read_b64_tr_b16 v[32:33], v114 offset:16384
ds_read_b64_tr_b16 v[34:35], v114 offset:20480
ds_read_b64_tr_b16 v[36:37], v115 offset:16384
ds_read_b64_tr_b16 v[38:39], v115 offset:20480
ds_read_b64_tr_b16 v[40:41], v116 offset:16384
ds_read_b64_tr_b16 v[42:43], v116 offset:20480
ds_read_b64_tr_b16 v[44:45], v117 offset:16384
ds_read_b64_tr_b16 v[46:47], v117 offset:20480
ds_read_b64_tr_b16 v[48:49], v118 offset:16384
ds_read_b64_tr_b16 v[50:51], v118 offset:20480
ds_read_b64_tr_b16 v[52:53], v119 offset:16384
ds_read_b64_tr_b16 v[54:55], v119 offset:20480
s_waitcnt lgkmcnt(14)
v_mfma_f32_16x16x32_bf16 v[128:131], v[24:27], v[224:227], 0
ds_read_b128 v[232:235], v124 offset:2048
v_mfma_f32_16x16x32_bf16 v[132:135], v[24:27], v[228:231], 0
ds_read_b64_tr_b16 v[24:25], v112 offset:24576
ds_write_b128 v20, v[88:91] offset:0
s_waitcnt lgkmcnt(15)
v_mfma_f32_16x16x32_bf16 v[140:143], v[28:31], v[228:231], 0
ds_read_b64_tr_b16 v[26:27], v112 offset:28672
ds_read_b128 v[236:239], v124 offset:3072
v_mfma_f32_16x16x32_bf16 v[136:139], v[28:31], v[224:227], 0
ds_read_b64_tr_b16 v[28:29], v113 offset:24576
ds_write_b128 v20, v[92:95] offset:1024
s_waitcnt lgkmcnt(15)
v_mfma_f32_16x16x32_bf16 v[144:147], v[32:35], v[224:227], 0
ds_read_b64_tr_b16 v[30:31], v113 offset:28672
ds_read_b128 v[240:243], v124 offset:4096
v_mfma_f32_16x16x32_bf16 v[148:151], v[32:35], v[228:231], 0
ds_read_b64_tr_b16 v[32:33], v114 offset:24576
ds_write_b128 v20, v[96:99] offset:2048
v_mfma_f32_16x16x32_bf16 v[156:159], v[36:39], v[228:231], 0
ds_read_b64_tr_b16 v[34:35], v114 offset:28672
ds_read_b128 v[244:247], v124 offset:5120
v_mfma_f32_16x16x32_bf16 v[152:155], v[36:39], v[224:227], 0
ds_read_b64_tr_b16 v[36:37], v115 offset:24576
ds_write_b128 v20, v[100:103] offset:3072
s_waitcnt lgkmcnt(15)
v_mfma_f32_16x16x32_bf16 v[160:163], v[40:43], v[224:227], 0
ds_read_b64_tr_b16 v[38:39], v115 offset:28672
ds_read_b128 v[248:251], v124 offset:6144
s_waitcnt vmcnt(0)
s_mov_b64 exec, 1
s_cmp_lg_u32 s27, 0
s_cbranch_scc1 LC_hl
buffer_store_dword v0, v19, s[12:15], s48 offen sc0 sc1
s_branch LC_hj
LC_hl:
buffer_store_dword v0, v19, s[12:15], s48 offen
LC_hj:
s_mov_b64 exec, -1
v_mfma_f32_16x16x32_bf16 v[164:167], v[40:43], v[228:231], 0
ds_read_b64_tr_b16 v[40:41], v116 offset:24576
ds_write_b128 v20, v[192:195] offset:16384
v_mfma_f32_16x16x32_bf16 v[172:175], v[44:47], v[228:231], 0
ds_read_b64_tr_b16 v[42:43], v116 offset:28672
ds_read_b128 v[252:255], v124 offset:7168
v_mfma_f32_16x16x32_bf16 v[168:171], v[44:47], v[224:227], 0
ds_read_b64_tr_b16 v[44:45], v117 offset:24576
ds_write_b128 v20, v[196:199] offset:17408
v_mfma_f32_16x16x32_bf16 v[176:179], v[48:51], v[224:227], 0
ds_read_b64_tr_b16 v[46:47], v117 offset:28672
ds_read_b128 v[56:59], v124 offset:8192
v_mfma_f32_16x16x32_bf16 v[180:183], v[48:51], v[228:231], 0
ds_read_b64_tr_b16 v[48:49], v118 offset:24576
ds_write_b128 v20, v[200:203] offset:18432
v_mfma_f32_16x16x32_bf16 v[188:191], v[52:55], v[228:231], 0
ds_read_b64_tr_b16 v[50:51], v118 offset:28672
ds_read_b128 v[60:63], v124 offset:9216
v_mfma_f32_16x16x32_bf16 v[184:187], v[52:55], v[224:227], 0
ds_read_b64_tr_b16 v[52:53], v119 offset:24576
ds_read_b64_tr_b16 v[54:55], v119 offset:28672
ds_write_b128 v20, v[204:207] offset:19456
s_waitcnt lgkmcnt(15)
v_mfma_f32_16x16x32_bf16 v[128:131], v[24:27], v[232:235], v[128:131]
ds_read_b128 v[64:67], v124 offset:10240
v_mfma_f32_16x16x32_bf16 v[132:135], v[24:27], v[236:239], v[132:135]
ds_read_b64_tr_b16 v[24:25], v112 offset:49152
ds_write_b128 v21, v[208:211] offset:32768
v_mfma_f32_16x16x32_bf16 v[140:143], v[28:31], v[236:239], v[140:143]
ds_read_b64_tr_b16 v[26:27], v112 offset:53248
ds_read_b128 v[68:71], v124 offset:11264
v_mfma_f32_16x16x32_bf16 v[136:139], v[28:31], v[232:235], v[136:139]
ds_read_b64_tr_b16 v[28:29], v113 offset:49152
ds_write_b128 v21, v[212:215] offset:33792
v_mfma_f32_16x16x32_bf16 v[144:147], v[32:35], v[232:235], v[144:147]
ds_read_b64_tr_b16 v[30:31], v113 offset:53248
ds_read_b128 v[72:75], v124 offset:12288
v_mfma_f32_16x16x32_bf16 v[148:151], v[32:35], v[236:239], v[148:151]
ds_read_b64_tr_b16 v[32:33], v114 offset:49152
ds_write_b128 v21, v[216:219] offset:34816
v_mfma_f32_16x16x32_bf16 v[156:159], v[36:39], v[236:239], v[156:159]
ds_read_b64_tr_b16 v[34:35], v114 offset:53248
ds_read_b128 v[76:79], v124 offset:13312
v_mfma_f32_16x16x32_bf16 v[152:155], v[36:39], v[232:235], v[152:155]
ds_read_b64_tr_b16 v[36:37], v115 offset:49152
ds_write_b128 v21, v[220:223] offset:35840
s_waitcnt lgkmcnt(15)
v_mfma_f32_16x16x32_bf16 v[160:163], v[40:43], v[232:235], v[160:163]
ds_read_b64_tr_b16 v[38:39], v115 offset:53248
v_mfma_f32_16x16x32_bf16 v[164:167], v[40:43], v[236:239], v[164:167]
ds_read_b64_tr_b16 v[40:41], v116 offset:49152
v_mfma_f32_16x16x32_bf16 v[172:175], v[44:47], v[236:239], v[172:175]
ds_read_b64_tr_b16 v[42:43], v116 offset:53248
v_mfma_f32_16x16x32_bf16 v[168:171], v[44:47], v[232:235], v[168:171]
ds_read_b64_tr_b16 v[44:45], v117 offset:49152
v_mfma_f32_16x16x32_bf16 v[176:179], v[48:51], v[232:235], v[176:179]
ds_read_b64_tr_b16 v[46:47], v117 offset:53248
v_mfma_f32_16x16x32_bf16 v[180:183], v[48:51], v[236:239], v[180:183]
ds_read_b64_tr_b16 v[48:49], v118 offset:49152
v_mfma_f32_16x16x32_bf16 v[188:191], v[52:55], v[236:239], v[188:191]
ds_read_b64_tr_b16 v[50:51], v118 offset:53248
v_mov_b32 v126, 2
s_mov_b64 exec, s[60:61]
ds_write_b32 v125, v126
s_mov_b64 exec, -1
v_mfma_f32_16x16x32_bf16 v[184:187], v[52:55], v[232:235], v[184:187]
ds_read_b64_tr_b16 v[52:53], v119 offset:49152
ds_read_b64_tr_b16 v[54:55], v119 offset:53248
s_waitcnt lgkmcnt(15)
v_mfma_f32_16x16x32_bf16 v[128:131], v[24:27], v[240:243], v[128:131]
v_mfma_f32_16x16x32_bf16 v[132:135], v[24:27], v[244:247], v[132:135]
ds_read_b64_tr_b16 v[24:25], v112 offset:57344
v_mfma_f32_16x16x32_bf16 v[140:143], v[28:31], v[244:247], v[140:143]
ds_read_b64_tr_b16 v[26:27], v112 offset:61440
v_mfma_f32_16x16x32_bf16 v[136:139], v[28:31], v[240:243], v[136:139]
ds_read_b64_tr_b16 v[28:29], v113 offset:57344
s_waitcnt lgkmcnt(15)
v_mfma_f32_16x16x32_bf16 v[144:147], v[32:35], v[240:243], v[144:147]
ds_read_b64_tr_b16 v[30:31], v113 offset:61440
v_mfma_f32_16x16x32_bf16 v[148:151], v[32:35], v[244:247], v[148:151]
ds_read_b64_tr_b16 v[32:33], v114 offset:57344
s_waitcnt lgkmcnt(14)
v_mfma_f32_16x16x32_bf16 v[156:159], v[36:39], v[244:247], v[156:159]
ds_read_b64_tr_b16 v[34:35], v114 offset:61440
v_mfma_f32_16x16x32_bf16 v[152:155], v[36:39], v[240:243], v[152:155]
ds_read_b64_tr_b16 v[36:37], v115 offset:57344
s_waitcnt lgkmcnt(14)
v_mfma_f32_16x16x32_bf16 v[160:163], v[40:43], v[240:243], v[160:163]
ds_read_b64_tr_b16 v[38:39], v115 offset:61440
v_mfma_f32_16x16x32_bf16 v[164:167], v[40:43], v[244:247], v[164:167]
ds_read_b64_tr_b16 v[40:41], v116 offset:57344
ds_read_b32 v127, v125
s_waitcnt lgkmcnt(15)
v_mfma_f32_16x16x32_bf16 v[172:175], v[44:47], v[244:247], v[172:175]
ds_read_b64_tr_b16 v[42:43], v116 offset:61440
v_mfma_f32_16x16x32_bf16 v[168:171], v[44:47], v[240:243], v[168:171]
ds_read_b64_tr_b16 v[44:45], v117 offset:57344
s_waitcnt lgkmcnt(15)
v_mfma_f32_16x16x32_bf16 v[176:179], v[48:51], v[240:243], v[176:179]
ds_read_b64_tr_b16 v[46:47], v117 offset:61440
v_mfma_f32_16x16x32_bf16 v[180:183], v[48:51], v[244:247], v[180:183]
ds_read_b64_tr_b16 v[48:49], v118 offset:57344
s_waitcnt lgkmcnt(14)
v_mfma_f32_16x16x32_bf16 v[188:191], v[52:55], v[244:247], v[188:191]
ds_read_b64_tr_b16 v[50:51], v118 offset:61440
s_waitcnt lgkmcnt(5)
v_cmp_gt_u32 vcc, 2, v127
v_mfma_f32_16x16x32_bf16 v[184:187], v[52:55], v[240:243], v[184:187]
ds_read_b64_tr_b16 v[52:53], v119 offset:57344
ds_read_b64_tr_b16 v[54:55], v119 offset:61440
s_add_u32 m0, s52, 32768
s_cbranch_vccnz LC_s2
LC_b2:
v_mfma_f32_16x16x32_bf16 v[128:131], v[24:27], v[248:251], v[128:131]
buffer_load_dwordx4 v120, s[16:19], s50 offen offset:0 lds
v_mfma_f32_16x16x32_bf16 v[132:135], v[24:27], v[252:255], v[132:135]
ds_read_b64_tr_b16 v[24:25], v112 offset:32768
v_mfma_f32_16x16x32_bf16 v[140:143], v[28:31], v[252:255], v[140:143]
ds_read_b64_tr_b16 v[26:27], v112 offset:36864
buffer_load_dwordx4 v121, s[16:19], s50 offen offset:1024 lds
v_mfma_f32_16x16x32_bf16 v[136:139], v[28:31], v[248:251], v[136:139]
ds_read_b64_tr_b16 v[28:29], v113 offset:32768
v_mfma_f32_16x16x32_bf16 v[144:147], v[32:35], v[248:251], v[144:147]
ds_read_b64_tr_b16 v[30:31], v113 offset:36864
buffer_load_dwordx4 v122, s[16:19], s50 offen offset:2048 lds
v_mfma_f32_16x16x32_bf16 v[148:151], v[32:35], v[252:255], v[148:151]
ds_read_b64_tr_b16 v[32:33], v114 offset:32768
v_mfma_f32_16x16x32_bf16 v[156:159], v[36:39], v[252:255], v[156:159]
ds_read_b64_tr_b16 v[34:35], v114 offset:36864
buffer_load_dwordx4 v123, s[16:19], s50 offen offset:3072 lds
v_mfma_f32_16x16x32_bf16 v[152:155], v[36:39], v[248:251], v[152:155]
ds_read_b64_tr_b16 v[36:37], v115 offset:32768
s_add_u32 s54, s54, 131072
s_cmp_ge_u32 s54, s51
s_cselect_b32 s39, 458752, 0
s_add_u32 s50, s54, s39
s_add_u32 m0, s52, 49152
s_waitcnt lgkmcnt(13)
v_mfma_f32_16x16x32_bf16 v[160:163], v[40:43], v[248:251], v[160:163]
ds_read_b64_tr_b16 v[38:39], v115 offset:36864
buffer_load_dwordx4 v120, s[16:19], s50 offen offset:0 lds
v_mfma_f32_16x16x32_bf16 v[164:167], v[40:43], v[252:255], v[164:167]
ds_read_b64_tr_b16 v[40:41], v116 offset:32768
s_waitcnt lgkmcnt(13)
v_mfma_f32_16x16x32_bf16 v[172:175], v[44:47], v[252:255], v[172:175]
ds_read_b64_tr_b16 v[42:43], v116 offset:36864
buffer_load_dwordx4 v121, s[16:19], s50 offen offset:1024 lds
v_mfma_f32_16x16x32_bf16 v[168:171], v[44:47], v[248:251], v[168:171]
ds_read_b64_tr_b16 v[44:45], v117 offset:32768
s_waitcnt lgkmcnt(13)
v_mfma_f32_16x16x32_bf16 v[176:179], v[48:51], v[248:251], v[176:179]
ds_read_b64_tr_b16 v[46:47], v117 offset:36864
buffer_load_dwordx4 v122, s[16:19], s50 offen offset:2048 lds
v_mfma_f32_16x16x32_bf16 v[180:183], v[48:51], v[252:255], v[180:183]
ds_read_b64_tr_b16 v[48:49], v118 offset:32768
s_waitcnt lgkmcnt(13)
v_mfma_f32_16x16x32_bf16 v[188:191], v[52:55], v[252:255], v[188:191]
ds_read_b64_tr_b16 v[50:51], v118 offset:36864
buffer_load_dwordx4 v123, s[16:19], s50 offen offset:3072 lds
v_mov_b32 v126, 4
s_mov_b64 exec, s[60:61]
ds_write_b32 v125, v126
s_mov_b64 exec, -1
v_mfma_f32_16x16x32_bf16 v[184:187], v[52:55], v[248:251], v[184:187]
ds_read_b64_tr_b16 v[52:53], v119 offset:32768
ds_read_b64_tr_b16 v[54:55], v119 offset:36864
s_add_u32 s54, s54, 131072
s_cmp_ge_u32 s54, s51
s_cselect_b32 s39, 458752, 0
s_add_u32 s50, s54, s39
s_add_u32 m0, s52, 114688
s_waitcnt lgkmcnt(15)
v_mfma_f32_16x16x32_bf16 v[128:131], v[24:27], v[56:59], v[128:131]
buffer_load_dwordx4 v120, s[16:19], s50 offen offset:0 lds
v_mfma_f32_16x16x32_bf16 v[132:135], v[24:27], v[60:63], v[132:135]
ds_read_b64_tr_b16 v[24:25], v112 offset:40960
s_waitcnt lgkmcnt(14)
v_mfma_f32_16x16x32_bf16 v[140:143], v[28:31], v[60:63], v[140:143]
ds_read_b64_tr_b16 v[26:27], v112 offset:45056
buffer_load_dwordx4 v121, s[16:19], s50 offen offset:1024 lds
v_mfma_f32_16x16x32_bf16 v[136:139], v[28:31], v[56:59], v[136:139]
ds_read_b64_tr_b16 v[28:29], v113 offset:40960
s_waitcnt lgkmcnt(14)
v_mfma_f32_16x16x32_bf16 v[144:147], v[32:35], v[56:59], v[144:147]
ds_read_b64_tr_b16 v[30:31], v113 offset:45056
buffer_load_dwordx4 v122, s[16:19], s50 offen offset:2048 lds
v_mfma_f32_16x16x32_bf16 v[148:151], v[32:35], v[60:63], v[148:151]
ds_read_b64_tr_b16 v[32:33], v114 offset:40960
s_waitcnt lgkmcnt(14)
v_mfma_f32_16x16x32_bf16 v[156:159], v[36:39], v[60:63], v[156:159]
ds_read_b64_tr_b16 v[34:35], v114 offset:45056
buffer_load_dwordx4 v123, s[16:19], s50 offen offset:3072 lds
v_mfma_f32_16x16x32_bf16 v[152:155], v[36:39], v[56:59], v[152:155]
ds_read_b64_tr_b16 v[36:37], v115 offset:40960
s_add_u32 s54, s54, 131072
s_cmp_ge_u32 s54, s51
s_cselect_b32 s39, 458752, 0
s_add_u32 s50, s54, s39
s_waitcnt lgkmcnt(14)
v_mfma_f32_16x16x32_bf16 v[160:163], v[40:43], v[56:59], v[160:163]
ds_read_b64_tr_b16 v[38:39], v115 offset:45056
v_mfma_f32_16x16x32_bf16 v[164:167], v[40:43], v[60:63], v[164:167]
ds_read_b64_tr_b16 v[40:41], v116 offset:40960
ds_read_b32 v127, v125
s_waitcnt lgkmcnt(15)
v_mfma_f32_16x16x32_bf16 v[172:175], v[44:47], v[60:63], v[172:175]
ds_read_b64_tr_b16 v[42:43], v116 offset:45056
v_mfma_f32_16x16x32_bf16 v[168:171], v[44:47], v[56:59], v[168:171]
ds_read_b64_tr_b16 v[44:45], v117 offset:40960
s_waitcnt lgkmcnt(15)
v_mfma_f32_16x16x32_bf16 v[176:179], v[48:51], v[56:59], v[176:179]
ds_read_b64_tr_b16 v[46:47], v117 offset:45056
v_mfma_f32_16x16x32_bf16 v[180:183], v[48:51], v[60:63], v[180:183]
ds_read_b64_tr_b16 v[48:49], v118 offset:40960
s_waitcnt lgkmcnt(14)
v_mfma_f32_16x16x32_bf16 v[188:191], v[52:55], v[60:63], v[188:191]
ds_read_b64_tr_b16 v[50:51], v118 offset:45056
s_waitcnt lgkmcnt(5)
v_cmp_gt_u32 vcc, 4, v127
v_mfma_f32_16x16x32_bf16 v[184:187], v[52:55], v[56:59], v[184:187]
ds_read_b64_tr_b16 v[52:53], v119 offset:40960
ds_read_b64_tr_b16 v[54:55], v119 offset:45056
s_cbranch_vccnz LC_s4
LC_b4:
v_mfma_f32_16x16x32_bf16 v[128:131], v[24:27], v[64:67], v[128:131]
buffer_load_dwordx4 v[80:83], v18, s[12:15], s53 offen offset:0
v_mfma_f32_16x16x32_bf16 v[132:135], v[24:27], v[68:71], v[132:135]
ds_read_b64_tr_b16 v[24:25], v104 offset:0
v_mfma_f32_16x16x32_bf16 v[140:143], v[28:31], v[68:71], v[140:143]
ds_read_b64_tr_b16 v[26:27], v104 offset:4096
v_mfma_f32_16x16x32_bf16 v[136:139], v[28:31], v[64:67], v[136:139]
ds_read_b64_tr_b16 v[28:29], v105 offset:0
buffer_load_dwordx4 v[84:87], v18, s[12:15], s53 offen offset:1024
v_mfma_f32_16x16x32_bf16 v[144:147], v[32:35], v[64:67], v[144:147]
ds_read_b64_tr_b16 v[30:31], v105 offset:4096
s_add_u32 s53, s53, 2048
v_mfma_f32_16x16x32_bf16 v[148:151], v[32:35], v[68:71], v[148:151]
ds_read_b64_tr_b16 v[32:33], v106 offset:0
v_mfma_f32_16x16x32_bf16 v[156:159], v[36:39], v[68:71], v[156:159]
ds_read_b64_tr_b16 v[34:35], v106 offset:4096
buffer_load_dwordx4 v[88:91], v18, s[12:15], s53 offen offset:0
v_mfma_f32_16x16x32_bf16 v[152:155], v[36:39], v[64:67], v[152:155]
ds_read_b64_tr_b16 v[36:37], v107 offset:0
s_waitcnt lgkmcnt(13)
v_mfma_f32_16x16x32_bf16 v[160:163], v[40:43], v[64:67], v[160:163]
ds_read_b64_tr_b16 v[38:39], v107 offset:4096
v_mfma_f32_16x16x32_bf16 v[164:167], v[40:43], v[68:71], v[164:167]
ds_read_b64_tr_b16 v[40:41], v108 offset:0
buffer_load_dwordx4 v[92:95], v18, s[12:15], s53 offen offset:1024
s_waitcnt lgkmcnt(13)
v_mfma_f32_16x16x32_bf16 v[172:175], v[44:47], v[68:71], v[172:175]
ds_read_b64_tr_b16 v[42:43], v108 offset:4096
s_add_u32 s53, s53, 2048
v_mfma_f32_16x16x32_bf16 v[168:171], v[44:47], v[64:67], v[168:171]
ds_read_b64_tr_b16 v[44:45], v109 offset:0
s_waitcnt lgkmcnt(13)
v_mfma_f32_16x16x32_bf16 v[176:179], v[48:51], v[64:67], v[176:179]
ds_read_b64_tr_b16 v[46:47], v109 offset:4096
buffer_load_dwordx4 v[96:99], v18, s[12:15], s53 offen offset:0
v_mfma_f32_16x16x32_bf16 v[180:183], v[48:51], v[68:71], v[180:183]
ds_read_b64_tr_b16 v[48:49], v110 offset:0
s_waitcnt lgkmcnt(13)
v_mfma_f32_16x16x32_bf16 v[188:191], v[52:55], v[68:71], v[188:191]
ds_read_b64_tr_b16 v[50:51], v110 offset:4096
v_mov_b32 v126, 6
s_mov_b64 exec, s[60:61]
ds_write_b32 v125, v126
s_mov_b64 exec, -1
v_mfma_f32_16x16x32_bf16 v[184:187], v[52:55], v[64:67], v[184:187]
ds_read_b64_tr_b16 v[52:53], v111 offset:0
ds_read_b64_tr_b16 v[54:55], v111 offset:4096
buffer_load_dwordx4 v[100:103], v18, s[12:15], s53 offen offset:1024
s_waitcnt lgkmcnt(15)
v_mfma_f32_16x16x32_bf16 v[128:131], v[24:27], v[72:75], v[128:131]
s_add_u32 s53, s53, 2048
v_mfma_f32_16x16x32_bf16 v[132:135], v[24:27], v[76:79], v[132:135]
ds_read_b64_tr_b16 v[24:25], v104 offset:8192
s_waitcnt lgkmcnt(14)
v_mfma_f32_16x16x32_bf16 v[140:143], v[28:31], v[76:79], v[140:143]
ds_read_b64_tr_b16 v[26:27], v104 offset:12288
buffer_load_dwordx4 v[2:5], v18, s[12:15], s53 offen offset:0
v_mfma_f32_16x16x32_bf16 v[136:139], v[28:31], v[72:75], v[136:139]
ds_read_b64_tr_b16 v[28:29], v105 offset:8192
s_waitcnt lgkmcnt(14)
v_mfma_f32_16x16x32_bf16 v[144:147], v[32:35], v[72:75], v[144:147]
ds_read_b64_tr_b16 v[30:31], v105 offset:12288
v_mfma_f32_16x16x32_bf16 v[148:151], v[32:35], v[76:79], v[148:151]
ds_read_b64_tr_b16 v[32:33], v106 offset:8192
buffer_load_dwordx4 v[6:9], v18, s[12:15], s53 offen offset:1024
s_waitcnt lgkmcnt(14)
v_mfma_f32_16x16x32_bf16 v[156:159], v[36:39], v[76:79], v[156:159]
ds_read_b64_tr_b16 v[34:35], v106 offset:12288
s_add_u32 s53, s53, 2048
v_mfma_f32_16x16x32_bf16 v[152:155], v[36:39], v[72:75], v[152:155]
ds_read_b64_tr_b16 v[36:37], v107 offset:8192
s_waitcnt lgkmcnt(14)
v_mfma_f32_16x16x32_bf16 v[160:163], v[40:43], v[72:75], v[160:163]
ds_read_b64_tr_b16 v[38:39], v107 offset:12288
buffer_load_dwordx4 v[10:13], v18, s[12:15], s53 offen offset:0
v_mfma_f32_16x16x32_bf16 v[164:167], v[40:43], v[76:79], v[164:167]
ds_read_b64_tr_b16 v[40:41], v108 offset:8192
ds_read_b32 v127, v125
s_waitcnt lgkmcnt(15)
v_mfma_f32_16x16x32_bf16 v[172:175], v[44:47], v[76:79], v[172:175]
ds_read_b64_tr_b16 v[42:43], v108 offset:12288
v_mfma_f32_16x16x32_bf16 v[168:171], v[44:47], v[72:75], v[168:171]
ds_read_b64_tr_b16 v[44:45], v109 offset:8192
buffer_load_dwordx4 v[14:17], v18, s[12:15], s53 offen offset:1024
s_waitcnt lgkmcnt(15)
v_mfma_f32_16x16x32_bf16 v[176:179], v[48:51], v[72:75], v[176:179]
ds_read_b64_tr_b16 v[46:47], v109 offset:12288
s_add_u32 s53, s53, 2048
v_mfma_f32_16x16x32_bf16 v[180:183], v[48:51], v[76:79], v[180:183]
ds_read_b64_tr_b16 v[48:49], v110 offset:8192
s_waitcnt lgkmcnt(14)
v_mfma_f32_16x16x32_bf16 v[188:191], v[52:55], v[76:79], v[188:191]
ds_read_b64_tr_b16 v[50:51], v110 offset:12288
buffer_load_dwordx4 v[192:195], v18, s[12:15], s53 offen offset:0
s_waitcnt lgkmcnt(5)
v_cmp_gt_u32 vcc, 6, v127
v_mfma_f32_16x16x32_bf16 v[184:187], v[52:55], v[72:75], v[184:187]
ds_read_b64_tr_b16 v[52:53], v111 offset:8192
ds_read_b64_tr_b16 v[54:55], v111 offset:12288
s_cbranch_vccnz LC_s6
LC_b6:
s_waitcnt vmcnt(10)
v_mfma_f32_16x16x32_bf16 v[128:131], v[24:27], v[80:83], v[128:131]
s_waitcnt vmcnt(9)
v_mfma_f32_16x16x32_bf16 v[132:135], v[24:27], v[84:87], v[132:135]
ds_read_b64_tr_b16 v[24:25], v104 offset:16384
buffer_load_dwordx4 v[196:199], v18, s[12:15], s53 offen offset:1024
v_mfma_f32_16x16x32_bf16 v[140:143], v[28:31], v[84:87], v[140:143]
ds_read_b64_tr_b16 v[26:27], v104 offset:20480
s_add_u32 s53, s53, 2048
v_mfma_f32_16x16x32_bf16 v[136:139], v[28:31], v[80:83], v[136:139]
ds_read_b64_tr_b16 v[28:29], v105 offset:16384
v_mfma_f32_16x16x32_bf16 v[144:147], v[32:35], v[80:83], v[144:147]
ds_read_b64_tr_b16 v[30:31], v105 offset:20480
buffer_load_dwordx4 v[200:203], v18, s[12:15], s53 offen offset:0
v_mfma_f32_16x16x32_bf16 v[148:151], v[32:35], v[84:87], v[148:151]
ds_read_b64_tr_b16 v[32:33], v106 offset:16384
v_mfma_f32_16x16x32_bf16 v[156:159], v[36:39], v[84:87], v[156:159]
ds_read_b64_tr_b16 v[34:35], v106 offset:20480
v_mfma_f32_16x16x32_bf16 v[152:155], v[36:39], v[80:83], v[152:155]
ds_read_b64_tr_b16 v[36:37], v107 offset:16384
buffer_load_dwordx4 v[204:207], v18, s[12:15], s53 offen offset:1024
s_waitcnt lgkmcnt(13)
v_mfma_f32_16x16x32_bf16 v[160:163], v[40:43], v[80:83], v[160:163]
ds_read_b64_tr_b16 v[38:39], v107 offset:20480
s_add_u32 s53, s53, 2048
s_cmp_eq_u32 s53, s55
s_cselect_b32 s36, 14336, 0
s_add_u32 s53, s53, s36
v_mfma_f32_16x16x32_bf16 v[164:167], v[40:43], v[84:87], v[164:167]
ds_read_b64_tr_b16 v[40:41], v108 offset:16384
s_waitcnt lgkmcnt(13)
v_mfma_f32_16x16x32_bf16 v[172:175], v[44:47], v[84:87], v[172:175]
ds_read_b64_tr_b16 v[42:43], v108 offset:20480
buffer_load_dwordx4 v[208:211], v18, s[12:15], s53 offen offset:0
v_mfma_f32_16x16x32_bf16 v[168:171], v[44:47], v[80:83], v[168:171]
ds_read_b64_tr_b16 v[44:45], v109 offset:16384
s_waitcnt lgkmcnt(13)
v_mfma_f32_16x16x32_bf16 v[176:179], v[48:51], v[80:83], v[176:179]
ds_read_b64_tr_b16 v[46:47], v109 offset:20480
v_mfma_f32_16x16x32_bf16 v[180:183], v[48:51], v[84:87], v[180:183]
ds_read_b64_tr_b16 v[48:49], v110 offset:16384
buffer_load_dwordx4 v[212:215], v18, s[12:15], s53 offen offset:1024
s_waitcnt lgkmcnt(13)
v_mfma_f32_16x16x32_bf16 v[188:191], v[52:55], v[84:87], v[188:191]
ds_read_b64_tr_b16 v[50:51], v110 offset:20480
s_add_u32 s53, s53, 2048
v_mov_b32 v126, 8
s_mov_b64 exec, s[60:61]
ds_write_b32 v125, v126
s_mov_b64 exec, -1
v_mfma_f32_16x16x32_bf16 v[184:187], v[52:55], v[80:83], v[184:187]
ds_read_b64_tr_b16 v[52:53], v111 offset:16384
ds_read_b64_tr_b16 v[54:55], v111 offset:20480
s_waitcnt lgkmcnt(15)
s_waitcnt vmcnt(13)
v_mfma_f32_16x16x32_bf16 v[128:131], v[24:27], v[88:91], v[128:131]
buffer_load_dwordx4 v[216:219], v18, s[12:15], s53 offen offset:0
s_waitcnt vmcnt(13)
v_mfma_f32_16x16x32_bf16 v[132:135], v[24:27], v[92:95], v[132:135]
ds_read_b64_tr_b16 v[24:25], v104 offset:24576
s_waitcnt lgkmcnt(14)
v_mfma_f32_16x16x32_bf16 v[140:143], v[28:31], v[92:95], v[140:143]
ds_read_b64_tr_b16 v[26:27], v104 offset:28672
v_mfma_f32_16x16x32_bf16 v[136:139], v[28:31], v[88:91], v[136:139]
ds_read_b64_tr_b16 v[28:29], v105 offset:24576
buffer_load_dwordx4 v[220:223], v18, s[12:15], s53 offen offset:1024
s_waitcnt lgkmcnt(14)
v_mfma_f32_16x16x32_bf16 v[144:147], v[32:35], v[88:91], v[144:147]
ds_read_b64_tr_b16 v[30:31], v105 offset:28672
s_add_u32 s53, s53, 2048
v_mfma_f32_16x16x32_bf16 v[148:151], v[32:35], v[92:95], v[148:151]
ds_read_b64_tr_b16 v[32:33], v106 offset:24576
s_add_u32 m0, s52, 147456
s_waitcnt lgkmcnt(14)
v_mfma_f32_16x16x32_bf16 v[156:159], v[36:39], v[92:95], v[156:159]
ds_read_b64_tr_b16 v[34:35], v106 offset:28672
buffer_load_dwordx4 v120, s[16:19], s50 offen offset:0 lds
v_mfma_f32_16x16x32_bf16 v[152:155], v[36:39], v[88:91], v[152:155]
ds_read_b64_tr_b16 v[36:37], v107 offset:24576
s_waitcnt lgkmcnt(14)
v_mfma_f32_16x16x32_bf16 v[160:163], v[40:43], v[88:91], v[160:163]
ds_read_b64_tr_b16 v[38:39], v107 offset:28672
v_mfma_f32_16x16x32_bf16 v[164:167], v[40:43], v[92:95], v[164:167]
ds_read_b64_tr_b16 v[40:41], v108 offset:24576
buffer_load_dwordx4 v121, s[16:19], s50 offen offset:1024 lds
ds_read_b32 v127, v125
s_waitcnt lgkmcnt(15)
v_mfma_f32_16x16x32_bf16 v[172:175], v[44:47], v[92:95], v[172:175]
ds_read_b64_tr_b16 v[42:43], v108 offset:28672
v_mfma_f32_16x16x32_bf16 v[168:171], v[44:47], v[88:91], v[168:171]
ds_read_b64_tr_b16 v[44:45], v109 offset:24576
s_waitcnt lgkmcnt(15)
v_mfma_f32_16x16x32_bf16 v[176:179], v[48:51], v[88:91], v[176:179]
ds_read_b64_tr_b16 v[46:47], v109 offset:28672
buffer_load_dwordx4 v122, s[16:19], s50 offen offset:2048 lds
v_mfma_f32_16x16x32_bf16 v[180:183], v[48:51], v[92:95], v[180:183]
ds_read_b64_tr_b16 v[48:49], v110 offset:24576
s_waitcnt lgkmcnt(14)
v_mfma_f32_16x16x32_bf16 v[188:191], v[52:55], v[92:95], v[188:191]
ds_read_b64_tr_b16 v[50:51], v110 offset:28672
s_waitcnt lgkmcnt(5)
v_cmp_gt_u32 vcc, 8, v127
v_mfma_f32_16x16x32_bf16 v[184:187], v[52:55], v[88:91], v[184:187]
ds_read_b64_tr_b16 v[52:53], v111 offset:24576
ds_read_b64_tr_b16 v[54:55], v111 offset:28672
buffer_load_dwordx4 v123, s[16:19], s50 offen offset:3072 lds
s_cbranch_vccnz LC_s8
LC_b8:
s_waitcnt vmcnt(17)
v_mfma_f32_16x16x32_bf16 v[128:131], v[24:27], v[96:99], v[128:131]
s_add_u32 s54, s54, 131072
s_cmp_ge_u32 s54, s51
s_cselect_b32 s39, 458752, 0
s_add_u32 s50, s54, s39
s_waitcnt vmcnt(16)
v_mfma_f32_16x16x32_bf16 v[132:135], v[24:27], v[100:103], v[132:135]
ds_read_b64_tr_b16 v[24:25], v112 offset:0
v_mfma_f32_16x16x32_bf16 v[140:143], v[28:31], v[100:103], v[140:143]
ds_read_b64_tr_b16 v[26:27], v112 offset:4096
buffer_load_dwordx4 v[224:227], v18, s[12:15], s53 offen offset:0
v_mfma_f32_16x16x32_bf16 v[136:139], v[28:31], v[96:99], v[136:139]
ds_read_b64_tr_b16 v[28:29], v113 offset:0
v_mfma_f32_16x16x32_bf16 v[144:147], v[32:35], v[96:99], v[144:147]
ds_read_b64_tr_b16 v[30:31], v113 offset:4096
v_mfma_f32_16x16x32_bf16 v[148:151], v[32:35], v[100:103], v[148:151]
ds_read_b64_tr_b16 v[32:33], v114 offset:0
buffer_load_dwordx4 v[228:231], v18, s[12:15], s53 offen offset:1024
v_mfma_f32_16x16x32_bf16 v[156:159], v[36:39], v[100:103], v[156:159]
ds_read_b64_tr_b16 v[34:35], v114 offset:4096
s_add_u32 s53, s53, 2048
v_mfma_f32_16x16x32_bf16 v[152:155], v[36:39], v[96:99], v[152:155]
ds_read_b64_tr_b16 v[36:37], v115 offset:0
s_waitcnt lgkmcnt(13)
v_mfma_f32_16x16x32_bf16 v[160:163], v[40:43], v[96:99], v[160:163]
ds_read_b64_tr_b16 v[38:39], v115 offset:4096
buffer_load_dwordx4 v[232:235], v18, s[12:15], s53 offen offset:0
v_mfma_f32_16x16x32_bf16 v[164:167], v[40:43], v[100:103], v[164:167]
ds_read_b64_tr_b16 v[40:41], v116 offset:0
s_waitcnt lgkmcnt(13)
v_mfma_f32_16x16x32_bf16 v[172:175], v[44:47], v[100:103], v[172:175]
ds_read_b64_tr_b16 v[42:43], v116 offset:4096
v_mfma_f32_16x16x32_bf16 v[168:171], v[44:47], v[96:99], v[168:171]
ds_read_b64_tr_b16 v[44:45], v117 offset:0
buffer_load_dwordx4 v[236:239], v18, s[12:15], s53 offen offset:1024
s_waitcnt lgkmcnt(13)
v_mfma_f32_16x16x32_bf16 v[176:179], v[48:51], v[96:99], v[176:179]
ds_read_b64_tr_b16 v[46:47], v117 offset:4096
s_add_u32 s53, s53, 2048
v_mfma_f32_16x16x32_bf16 v[180:183], v[48:51], v[100:103], v[180:183]
ds_read_b64_tr_b16 v[48:49], v118 offset:0
s_add_u32 m0, s52, 131072
s_waitcnt lgkmcnt(13)
v_mfma_f32_16x16x32_bf16 v[188:191], v[52:55], v[100:103], v[188:191]
ds_read_b64_tr_b16 v[50:51], v118 offset:4096
buffer_load_dwordx4 v120, s[16:19], s50 offen offset:0 lds
v_mov_b32 v126, 10
s_mov_b64 exec, s[60:61]
ds_write_b32 v125, v126
s_mov_b64 exec, -1
v_mfma_f32_16x16x32_bf16 v[184:187], v[52:55], v[96:99], v[184:187]
ds_read_b64_tr_b16 v[52:53], v119 offset:0
ds_read_b64_tr_b16 v[54:55], v119 offset:4096
s_waitcnt lgkmcnt(15)
s_waitcnt vmcnt(20)
v_mfma_f32_16x16x32_bf16 v[128:131], v[24:27], v[2:5], v[128:131]
s_waitcnt vmcnt(19)
v_mfma_f32_16x16x32_bf16 v[132:135], v[24:27], v[6:9], v[132:135]
ds_read_b64_tr_b16 v[24:25], v112 offset:8192
buffer_load_dwordx4 v121, s[16:19], s50 offen offset:1024 lds
s_waitcnt lgkmcnt(14)
v_mfma_f32_16x16x32_bf16 v[140:143], v[28:31], v[6:9], v[140:143]
ds_read_b64_tr_b16 v[26:27], v112 offset:12288
v_mfma_f32_16x16x32_bf16 v[136:139], v[28:31], v[2:5], v[136:139]
ds_read_b64_tr_b16 v[28:29], v113 offset:8192
s_waitcnt lgkmcnt(14)
v_mfma_f32_16x16x32_bf16 v[144:147], v[32:35], v[2:5], v[144:147]
ds_read_b64_tr_b16 v[30:31], v113 offset:12288
buffer_load_dwordx4 v122, s[16:19], s50 offen offset:2048 lds
v_mfma_f32_16x16x32_bf16 v[148:151], v[32:35], v[6:9], v[148:151]
ds_read_b64_tr_b16 v[32:33], v114 offset:8192
s_waitcnt lgkmcnt(14)
v_mfma_f32_16x16x32_bf16 v[156:159], v[36:39], v[6:9], v[156:159]
ds_read_b64_tr_b16 v[34:35], v114 offset:12288
v_mfma_f32_16x16x32_bf16 v[152:155], v[36:39], v[2:5], v[152:155]
ds_read_b64_tr_b16 v[36:37], v115 offset:8192
buffer_load_dwordx4 v123, s[16:19], s50 offen offset:3072 lds
s_waitcnt lgkmcnt(14)
v_mfma_f32_16x16x32_bf16 v[160:163], v[40:43], v[2:5], v[160:163]
ds_read_b64_tr_b16 v[38:39], v115 offset:12288
s_add_u32 s54, s54, 131072
s_cmp_ge_u32 s54, s51
s_cselect_b32 s39, 458752, 0
s_add_u32 s50, s54, s39
v_mfma_f32_16x16x32_bf16 v[164:167], v[40:43], v[6:9], v[164:167]
ds_read_b64_tr_b16 v[40:41], v116 offset:8192
ds_read_b32 v127, v125
s_waitcnt lgkmcnt(15)
v_mfma_f32_16x16x32_bf16 v[172:175], v[44:47], v[6:9], v[172:175]
ds_read_b64_tr_b16 v[42:43], v116 offset:12288
buffer_load_dwordx4 v[240:243], v18, s[12:15], s53 offen offset:0
v_mfma_f32_16x16x32_bf16 v[168:171], v[44:47], v[2:5], v[168:171]
ds_read_b64_tr_b16 v[44:45], v117 offset:8192
s_waitcnt lgkmcnt(15)
v_mfma_f32_16x16x32_bf16 v[176:179], v[48:51], v[2:5], v[176:179]
ds_read_b64_tr_b16 v[46:47], v117 offset:12288
v_mfma_f32_16x16x32_bf16 v[180:183], v[48:51], v[6:9], v[180:183]
ds_read_b64_tr_b16 v[48:49], v118 offset:8192
buffer_load_dwordx4 v[244:247], v18, s[12:15], s53 offen offset:1024
s_waitcnt lgkmcnt(14)
v_mfma_f32_16x16x32_bf16 v[188:191], v[52:55], v[6:9], v[188:191]
ds_read_b64_tr_b16 v[50:51], v118 offset:12288
s_add_u32 s53, s53, 2048
s_waitcnt lgkmcnt(5)
v_cmp_gt_u32 vcc, 10, v127
v_mfma_f32_16x16x32_bf16 v[184:187], v[52:55], v[2:5], v[184:187]
ds_read_b64_tr_b16 v[52:53], v119 offset:8192
ds_read_b64_tr_b16 v[54:55], v119 offset:12288
s_cbranch_vccnz LC_s10
LC_b10:
s_waitcnt vmcnt(23)
v_mfma_f32_16x16x32_bf16 v[128:131], v[24:27], v[10:13], v[128:131]
buffer_load_dwordx4 v[248:251], v18, s[12:15], s53 offen offset:0
s_waitcnt vmcnt(23)
v_mfma_f32_16x16x32_bf16 v[132:135], v[24:27], v[14:17], v[132:135]
ds_read_b64_tr_b16 v[24:25], v104 offset:32768
v_mfma_f32_16x16x32_bf16 v[140:143], v[28:31], v[14:17], v[140:143]
ds_read_b64_tr_b16 v[26:27], v104 offset:36864
v_mfma_f32_16x16x32_bf16 v[136:139], v[28:31], v[10:13], v[136:139]
ds_read_b64_tr_b16 v[28:29], v105 offset:32768
buffer_load_dwordx4 v[252:255], v18, s[12:15], s53 offen offset:1024
v_mfma_f32_16x16x32_bf16 v[144:147], v[32:35], v[10:13], v[144:147]
ds_read_b64_tr_b16 v[30:31], v105 offset:36864
s_add_u32 s53, s53, 2048
v_mfma_f32_16x16x32_bf16 v[148:151], v[32:35], v[14:17], v[148:151]
ds_read_b64_tr_b16 v[32:33], v106 offset:32768
s_add_u32 m0, s52, 0
v_mfma_f32_16x16x32_bf16 v[156:159], v[36:39], v[14:17], v[156:159]
ds_read_b64_tr_b16 v[34:35], v106 offset:36864
buffer_load_dwordx4 v120, s[16:19], s50 offen offset:0 lds
v_mfma_f32_16x16x32_bf16 v[152:155], v[36:39], v[10:13], v[152:155]
ds_read_b64_tr_b16 v[36:37], v107 offset:32768
s_waitcnt lgkmcnt(13)
v_mfma_f32_16x16x32_bf16 v[160:163], v[40:43], v[10:13], v[160:163]
ds_read_b64_tr_b16 v[38:39], v107 offset:36864
v_mfma_f32_16x16x32_bf16 v[164:167], v[40:43], v[14:17], v[164:167]
ds_read_b64_tr_b16 v[40:41], v108 offset:32768
buffer_load_dwordx4 v121, s[16:19], s50 offen offset:1024 lds
s_waitcnt lgkmcnt(13)
v_mfma_f32_16x16x32_bf16 v[172:175], v[44:47], v[14:17], v[172:175]
ds_read_b64_tr_b16 v[42:43], v108 offset:36864
v_mfma_f32_16x16x32_bf16 v[168:171], v[44:47], v[10:13], v[168:171]
ds_read_b64_tr_b16 v[44:45], v109 offset:32768
s_waitcnt lgkmcnt(13)
v_mfma_f32_16x16x32_bf16 v[176:179], v[48:51], v[10:13], v[176:179]
ds_read_b64_tr_b16 v[46:47], v109 offset:36864
buffer_load_dwordx4 v122, s[16:19], s50 offen offset:2048 lds
v_mfma_f32_16x16x32_bf16 v[180:183], v[48:51], v[14:17], v[180:183]
ds_read_b64_tr_b16 v[48:49], v110 offset:32768
s_waitcnt lgkmcnt(13)
v_mfma_f32_16x16x32_bf16 v[188:191], v[52:55], v[14:17], v[188:191]
ds_read_b64_tr_b16 v[50:51], v110 offset:36864
v_mov_b32 v126, 12
s_mov_b64 exec, s[60:61]
ds_write_b32 v125, v126
s_mov_b64 exec, -1
v_mfma_f32_16x16x32_bf16 v[184:187], v[52:55], v[10:13], v[184:187]
ds_read_b64_tr_b16 v[52:53], v111 offset:32768
ds_read_b64_tr_b16 v[54:55], v111 offset:36864
buffer_load_dwordx4 v123, s[16:19], s50 offen offset:3072 lds
s_waitcnt lgkmcnt(15)
s_waitcnt vmcnt(27)
v_mfma_f32_16x16x32_bf16 v[128:131], v[24:27], v[192:195], v[128:131]
s_add_u32 s54, s54, 131072
s_cmp_ge_u32 s54, s51
s_cselect_b32 s39, 458752, 0
s_add_u32 s50, s54, s39
s_waitcnt vmcnt(26)
v_mfma_f32_16x16x32_bf16 v[132:135], v[24:27], v[196:199], v[132:135]
ds_read_b64_tr_b16 v[24:25], v104 offset:40960
s_waitcnt lgkmcnt(14)
v_mfma_f32_16x16x32_bf16 v[140:143], v[28:31], v[196:199], v[140:143]
ds_read_b64_tr_b16 v[26:27], v104 offset:45056
buffer_load_dwordx4 v[56:59], v18, s[12:15], s53 offen offset:0
v_mfma_f32_16x16x32_bf16 v[136:139], v[28:31], v[192:195], v[136:139]
ds_read_b64_tr_b16 v[28:29], v105 offset:40960
s_waitcnt lgkmcnt(14)
v_mfma_f32_16x16x32_bf16 v[144:147], v[32:35], v[192:195], v[144:147]
ds_read_b64_tr_b16 v[30:31], v105 offset:45056
v_mfma_f32_16x16x32_bf16 v[148:151], v[32:35], v[196:199], v[148:151]
ds_read_b64_tr_b16 v[32:33], v106 offset:40960
buffer_load_dwordx4 v[60:63], v18, s[12:15], s53 offen offset:1024
s_waitcnt lgkmcnt(14)
v_mfma_f32_16x16x32_bf16 v[156:159], v[36:39], v[196:199], v[156:159]
ds_read_b64_tr_b16 v[34:35], v106 offset:45056
s_add_u32 s53, s53, 2048
s_cmp_eq_u32 s53, s55
s_cselect_b32 s36, 14336, 0
s_add_u32 s53, s53, s36
v_mfma_f32_16x16x32_bf16 v[152:155], v[36:39], v[192:195], v[152:155]
ds_read_b64_tr_b16 v[36:37], v107 offset:40960
s_waitcnt lgkmcnt(14)
v_mfma_f32_16x16x32_bf16 v[160:163], v[40:43], v[192:195], v[160:163]
ds_read_b64_tr_b16 v[38:39], v107 offset:45056
buffer_load_dwordx4 v[64:67], v18, s[12:15], s53 offen offset:0
v_mfma_f32_16x16x32_bf16 v[164:167], v[40:43], v[196:199], v[164:167]
ds_read_b64_tr_b16 v[40:41], v108 offset:40960
ds_read_b32 v127, v125
s_waitcnt lgkmcnt(15)
v_mfma_f32_16x16x32_bf16 v[172:175], v[44:47], v[196:199], v[172:175]
ds_read_b64_tr_b16 v[42:43], v108 offset:45056
v_mfma_f32_16x16x32_bf16 v[168:171], v[44:47], v[192:195], v[168:171]
ds_read_b64_tr_b16 v[44:45], v109 offset:40960
buffer_load_dwordx4 v[68:71], v18, s[12:15], s53 offen offset:1024
s_waitcnt lgkmcnt(15)
v_mfma_f32_16x16x32_bf16 v[176:179], v[48:51], v[192:195], v[176:179]
ds_read_b64_tr_b16 v[46:47], v109 offset:45056
s_add_u32 s53, s53, 2048
v_mfma_f32_16x16x32_bf16 v[180:183], v[48:51], v[196:199], v[180:183]
ds_read_b64_tr_b16 v[48:49], v110 offset:40960
s_add_u32 m0, s52, 16384
s_waitcnt lgkmcnt(14)
v_mfma_f32_16x16x32_bf16 v[188:191], v[52:55], v[196:199], v[188:191]
ds_read_b64_tr_b16 v[50:51], v110 offset:45056
buffer_load_dwordx4 v120, s[16:19], s50 offen offset:0 lds
s_waitcnt lgkmcnt(5)
v_cmp_gt_u32 vcc, 12, v127
v_mfma_f32_16x16x32_bf16 v[184:187], v[52:55], v[192:195], v[184:187]
ds_read_b64_tr_b16 v[52:53], v111 offset:40960
ds_read_b64_tr_b16 v[54:55], v111 offset:45056
s_cbranch_vccnz LC_s12
LC_b12:
s_waitcnt vmcnt(30)
v_mfma_f32_16x16x32_bf16 v[128:131], v[24:27], v[200:203], v[128:131]
s_waitcnt vmcnt(29)
v_mfma_f32_16x16x32_bf16 v[132:135], v[24:27], v[204:207], v[132:135]
ds_read_b64_tr_b16 v[24:25], v104 offset:49152
buffer_load_dwordx4 v121, s[16:19], s50 offen offset:1024 lds
v_mfma_f32_16x16x32_bf16 v[140:143], v[28:31], v[204:207], v[140:143]
ds_read_b64_tr_b16 v[26:27], v104 offset:53248
v_mfma_f32_16x16x32_bf16 v[136:139], v[28:31], v[200:203], v[136:139]
ds_read_b64_tr_b16 v[28:29], v105 offset:49152
v_mfma_f32_16x16x32_bf16 v[144:147], v[32:35], v[200:203], v[144:147]
ds_read_b64_tr_b16 v[30:31], v105 offset:53248
buffer_load_dwordx4 v122, s[16:19], s50 offen offset:2048 lds
v_mfma_f32_16x16x32_bf16 v[148:151], v[32:35], v[204:207], v[148:151]
ds_read_b64_tr_b16 v[32:33], v106 offset:49152
v_mfma_f32_16x16x32_bf16 v[156:159], v[36:39], v[204:207], v[156:159]
ds_read_b64_tr_b16 v[34:35], v106 offset:53248
v_mfma_f32_16x16x32_bf16 v[152:155], v[36:39], v[200:203], v[152:155]
ds_read_b64_tr_b16 v[36:37], v107 offset:49152
buffer_load_dwordx4 v123, s[16:19], s50 offen offset:3072 lds
s_waitcnt lgkmcnt(13)
v_mfma_f32_16x16x32_bf16 v[160:163], v[40:43], v[200:203], v[160:163]
ds_read_b64_tr_b16 v[38:39], v107 offset:53248
s_add_u32 s54, s54, 131072
s_cmp_ge_u32 s54, s51
s_cselect_b32 s39, 458752, 0
s_add_u32 s50, s54, s39
v_mfma_f32_16x16x32_bf16 v[164:167], v[40:43], v[204:207], v[164:167]
ds_read_b64_tr_b16 v[40:41], v108 offset:49152
s_waitcnt lgkmcnt(13)
v_mfma_f32_16x16x32_bf16 v[172:175], v[44:47], v[204:207], v[172:175]
ds_read_b64_tr_b16 v[42:43], v108 offset:53248
buffer_load_dwordx4 v[72:75], v18, s[12:15], s53 offen offset:0
v_mfma_f32_16x16x32_bf16 v[168:171], v[44:47], v[200:203], v[168:171]
ds_read_b64_tr_b16 v[44:45], v109 offset:49152
s_waitcnt lgkmcnt(13)
v_mfma_f32_16x16x32_bf16 v[176:179], v[48:51], v[200:203], v[176:179]
ds_read_b64_tr_b16 v[46:47], v109 offset:53248
v_mfma_f32_16x16x32_bf16 v[180:183], v[48:51], v[204:207], v[180:183]
ds_read_b64_tr_b16 v[48:49], v110 offset:49152
buffer_load_dwordx4 v[76:79], v18, s[12:15], s53 offen offset:1024
s_waitcnt lgkmcnt(13)
v_mfma_f32_16x16x32_bf16 v[188:191], v[52:55], v[204:207], v[188:191]
ds_read_b64_tr_b16 v[50:51], v110 offset:53248
s_add_u32 s53, s53, 2048
v_mov_b32 v126, 14
s_mov_b64 exec, s[60:61]
ds_write_b32 v125, v126
s_mov_b64 exec, -1
v_mfma_f32_16x16x32_bf16 v[184:187], v[52:55], v[200:203], v[184:187]
ds_read_b64_tr_b16 v[52:53], v111 offset:49152
ds_read_b64_tr_b16 v[54:55], v111 offset:53248
s_waitcnt lgkmcnt(15)
s_waitcnt vmcnt(33)
v_mfma_f32_16x16x32_bf16 v[128:131], v[24:27], v[208:211], v[128:131]
buffer_load_dwordx4 v[80:83], v18, s[12:15], s53 offen offset:0
s_waitcnt vmcnt(33)
v_mfma_f32_16x16x32_bf16 v[132:135], v[24:27], v[212:215], v[132:135]
ds_read_b64_tr_b16 v[24:25], v104 offset:57344
s_waitcnt lgkmcnt(14)
v_mfma_f32_16x16x32_bf16 v[140:143], v[28:31], v[212:215], v[140:143]
ds_read_b64_tr_b16 v[26:27], v104 offset:61440
v_mfma_f32_16x16x32_bf16 v[136:139], v[28:31], v[208:211], v[136:139]
ds_read_b64_tr_b16 v[28:29], v105 offset:57344
buffer_load_dwordx4 v[84:87], v18, s[12:15], s53 offen offset:1024
s_waitcnt lgkmcnt(14)
v_mfma_f32_16x16x32_bf16 v[144:147], v[32:35], v[208:211], v[144:147]
ds_read_b64_tr_b16 v[30:31], v105 offset:61440
s_add_u32 s53, s53, 2048
v_mfma_f32_16x16x32_bf16 v[148:151], v[32:35], v[212:215], v[148:151]
ds_read_b64_tr_b16 v[32:33], v106 offset:57344
s_add_u32 m0, s52, 98304
s_waitcnt lgkmcnt(14)
v_mfma_f32_16x16x32_bf16 v[156:159], v[36:39], v[212:215], v[156:159]
ds_read_b64_tr_b16 v[34:35], v106 offset:61440
buffer_load_dwordx4 v120, s[16:19], s50 offen offset:0 lds
v_mfma_f32_16x16x32_bf16 v[152:155], v[36:39], v[208:211], v[152:155]
ds_read_b64_tr_b16 v[36:37], v107 offset:57344
s_waitcnt lgkmcnt(14)
v_mfma_f32_16x16x32_bf16 v[160:163], v[40:43], v[208:211], v[160:163]
ds_read_b64_tr_b16 v[38:39], v107 offset:61440
v_mfma_f32_16x16x32_bf16 v[164:167], v[40:43], v[212:215], v[164:167]
ds_read_b64_tr_b16 v[40:41], v108 offset:57344
buffer_load_dwordx4 v121, s[16:19], s50 offen offset:1024 lds
ds_read_b32 v127, v125
s_waitcnt lgkmcnt(15)
v_mfma_f32_16x16x32_bf16 v[172:175], v[44:47], v[212:215], v[172:175]
ds_read_b64_tr_b16 v[42:43], v108 offset:61440
v_mfma_f32_16x16x32_bf16 v[168:171], v[44:47], v[208:211], v[168:171]
ds_read_b64_tr_b16 v[44:45], v109 offset:57344
s_waitcnt lgkmcnt(15)
v_mfma_f32_16x16x32_bf16 v[176:179], v[48:51], v[208:211], v[176:179]
ds_read_b64_tr_b16 v[46:47], v109 offset:61440
buffer_load_dwordx4 v122, s[16:19], s50 offen offset:2048 lds
v_mfma_f32_16x16x32_bf16 v[180:183], v[48:51], v[212:215], v[180:183]
ds_read_b64_tr_b16 v[48:49], v110 offset:57344
s_waitcnt lgkmcnt(14)
v_mfma_f32_16x16x32_bf16 v[188:191], v[52:55], v[212:215], v[188:191]
ds_read_b64_tr_b16 v[50:51], v110 offset:61440
s_waitcnt lgkmcnt(5)
v_cmp_gt_u32 vcc, 14, v127
v_mfma_f32_16x16x32_bf16 v[184:187], v[52:55], v[208:211], v[184:187]
ds_read_b64_tr_b16 v[52:53], v111 offset:57344
ds_read_b64_tr_b16 v[54:55], v111 offset:61440
buffer_load_dwordx4 v123, s[16:19], s50 offen offset:3072 lds
s_cbranch_vccnz LC_s14
LC_b14:
s_waitcnt vmcnt(37)
v_mfma_f32_16x16x32_bf16 v[128:131], v[24:27], v[216:219], v[128:131]
s_add_u32 s54, s54, 131072
s_cmp_ge_u32 s54, s51
s_cselect_b32 s39, 458752, 0
s_add_u32 s50, s54, s39
s_waitcnt vmcnt(36)
v_mfma_f32_16x16x32_bf16 v[132:135], v[24:27], v[220:223], v[132:135]
ds_read_b64_tr_b16 v[24:25], v112 offset:16384
v_mfma_f32_16x16x32_bf16 v[140:143], v[28:31], v[220:223], v[140:143]
ds_read_b64_tr_b16 v[26:27], v112 offset:20480
buffer_load_dwordx4 v[88:91], v18, s[12:15], s53 offen offset:0
v_mfma_f32_16x16x32_bf16 v[136:139], v[28:31], v[216:219], v[136:139]
ds_read_b64_tr_b16 v[28:29], v113 offset:16384
v_mfma_f32_16x16x32_bf16 v[144:147], v[32:35], v[216:219], v[144:147]
ds_read_b64_tr_b16 v[30:31], v113 offset:20480
v_mfma_f32_16x16x32_bf16 v[148:151], v[32:35], v[220:223], v[148:151]
ds_read_b64_tr_b16 v[32:33], v114 offset:16384
buffer_load_dwordx4 v[92:95], v18, s[12:15], s53 offen offset:1024
v_mfma_f32_16x16x32_bf16 v[156:159], v[36:39], v[220:223], v[156:159]
ds_read_b64_tr_b16 v[34:35], v114 offset:20480
s_add_u32 s53, s53, 2048
v_mfma_f32_16x16x32_bf16 v[152:155], v[36:39], v[216:219], v[152:155]
ds_read_b64_tr_b16 v[36:37], v115 offset:16384
s_waitcnt lgkmcnt(13)
v_mfma_f32_16x16x32_bf16 v[160:163], v[40:43], v[216:219], v[160:163]
ds_read_b64_tr_b16 v[38:39], v115 offset:20480
buffer_load_dwordx4 v[96:99], v18, s[12:15], s53 offen offset:0
v_mfma_f32_16x16x32_bf16 v[164:167], v[40:43], v[220:223], v[164:167]
ds_read_b64_tr_b16 v[40:41], v116 offset:16384
s_waitcnt lgkmcnt(13)
v_mfma_f32_16x16x32_bf16 v[172:175], v[44:47], v[220:223], v[172:175]
ds_read_b64_tr_b16 v[42:43], v116 offset:20480
v_mfma_f32_16x16x32_bf16 v[168:171], v[44:47], v[216:219], v[168:171]
ds_read_b64_tr_b16 v[44:45], v117 offset:16384
buffer_load_dwordx4 v[100:103], v18, s[12:15], s53 offen offset:1024
s_waitcnt lgkmcnt(13)
v_mfma_f32_16x16x32_bf16 v[176:179], v[48:51], v[216:219], v[176:179]
ds_read_b64_tr_b16 v[46:47], v117 offset:20480
s_add_u32 s53, s53, 2048
v_mfma_f32_16x16x32_bf16 v[180:183], v[48:51], v[220:223], v[180:183]
ds_read_b64_tr_b16 v[48:49], v118 offset:16384
s_add_u32 m0, s52, 32768
s_waitcnt lgkmcnt(13)
v_mfma_f32_16x16x32_bf16 v[188:191], v[52:55], v[220:223], v[188:191]
ds_read_b64_tr_b16 v[50:51], v118 offset:20480
buffer_load_dwordx4 v120, s[16:19], s50 offen offset:0 lds
s_waitcnt vmcnt(37)
v_mov_b32 v126, 16
s_mov_b64 exec, s[60:61]
ds_write_b32 v125, v126
s_mov_b64 exec, -1
v_mfma_f32_16x16x32_bf16 v[184:187], v[52:55], v[216:219], v[184:187]
ds_read_b64_tr_b16 v[52:53], v119 offset:16384
ds_read_b64_tr_b16 v[54:55], v119 offset:20480
s_waitcnt lgkmcnt(15)
s_waitcnt vmcnt(36)
v_mfma_f32_16x16x32_bf16 v[128:131], v[24:27], v[224:227], v[128:131]
s_waitcnt vmcnt(35)
v_mfma_f32_16x16x32_bf16 v[132:135], v[24:27], v[228:231], v[132:135]
ds_read_b64_tr_b16 v[24:25], v112 offset:24576
buffer_load_dwordx4 v121, s[16:19], s50 offen offset:1024 lds
s_waitcnt lgkmcnt(14)
v_mfma_f32_16x16x32_bf16 v[140:143], v[28:31], v[228:231], v[140:143]
ds_read_b64_tr_b16 v[26:27], v112 offset:28672
v_mfma_f32_16x16x32_bf16 v[136:139], v[28:31], v[224:227], v[136:139]
ds_read_b64_tr_b16 v[28:29], v113 offset:24576
s_waitcnt lgkmcnt(14)
v_mfma_f32_16x16x32_bf16 v[144:147], v[32:35], v[224:227], v[144:147]
ds_read_b64_tr_b16 v[30:31], v113 offset:28672
buffer_load_dwordx4 v122, s[16:19], s50 offen offset:2048 lds
v_mfma_f32_16x16x32_bf16 v[148:151], v[32:35], v[228:231], v[148:151]
ds_read_b64_tr_b16 v[32:33], v114 offset:24576
s_waitcnt lgkmcnt(14)
v_mfma_f32_16x16x32_bf16 v[156:159], v[36:39], v[228:231], v[156:159]
ds_read_b64_tr_b16 v[34:35], v114 offset:28672
v_mfma_f32_16x16x32_bf16 v[152:155], v[36:39], v[224:227], v[152:155]
ds_read_b64_tr_b16 v[36:37], v115 offset:24576
buffer_load_dwordx4 v123, s[16:19], s50 offen offset:3072 lds
s_waitcnt lgkmcnt(14)
v_mfma_f32_16x16x32_bf16 v[160:163], v[40:43], v[224:227], v[160:163]
ds_read_b64_tr_b16 v[38:39], v115 offset:28672
s_add_u32 s54, s54, 131072
s_cmp_ge_u32 s54, s51
s_cselect_b32 s39, 458752, 0
s_add_u32 s50, s54, s39
v_mfma_f32_16x16x32_bf16 v[164:167], v[40:43], v[228:231], v[164:167]
ds_read_b64_tr_b16 v[40:41], v116 offset:24576
ds_read_b32 v127, v125
s_waitcnt lgkmcnt(15)
v_mfma_f32_16x16x32_bf16 v[172:175], v[44:47], v[228:231], v[172:175]
ds_read_b64_tr_b16 v[42:43], v116 offset:28672
buffer_load_dwordx4 v[2:5], v18, s[12:15], s53 offen offset:0
v_mfma_f32_16x16x32_bf16 v[168:171], v[44:47], v[224:227], v[168:171]
ds_read_b64_tr_b16 v[44:45], v117 offset:24576
s_waitcnt lgkmcnt(15)
v_mfma_f32_16x16x32_bf16 v[176:179], v[48:51], v[224:227], v[176:179]
ds_read_b64_tr_b16 v[46:47], v117 offset:28672
v_mfma_f32_16x16x32_bf16 v[180:183], v[48:51], v[228:231], v[180:183]
ds_read_b64_tr_b16 v[48:49], v118 offset:24576
buffer_load_dwordx4 v[6:9], v18, s[12:15], s53 offen offset:1024
s_waitcnt lgkmcnt(14)
v_mfma_f32_16x16x32_bf16 v[188:191], v[52:55], v[228:231], v[188:191]
ds_read_b64_tr_b16 v[50:51], v118 offset:28672
s_add_u32 s53, s53, 2048
s_waitcnt lgkmcnt(5)
v_cmp_gt_u32 vcc, 16, v127
v_mfma_f32_16x16x32_bf16 v[184:187], v[52:55], v[224:227], v[184:187]
ds_read_b64_tr_b16 v[52:53], v119 offset:24576
ds_read_b64_tr_b16 v[54:55], v119 offset:28672
s_cbranch_vccnz LC_s16
LC_b16:
s_waitcnt vmcnt(39)
v_mfma_f32_16x16x32_bf16 v[128:131], v[24:27], v[232:235], v[128:131]
buffer_load_dwordx4 v[10:13], v18, s[12:15], s53 offen offset:0
s_waitcnt vmcnt(39)
v_mfma_f32_16x16x32_bf16 v[132:135], v[24:27], v[236:239], v[132:135]
ds_read_b64_tr_b16 v[24:25], v112 offset:49152
v_mfma_f32_16x16x32_bf16 v[140:143], v[28:31], v[236:239], v[140:143]
ds_read_b64_tr_b16 v[26:27], v112 offset:53248
v_mfma_f32_16x16x32_bf16 v[136:139], v[28:31], v[232:235], v[136:139]
ds_read_b64_tr_b16 v[28:29], v113 offset:49152
buffer_load_dwordx4 v[14:17], v18, s[12:15], s53 offen offset:1024
v_mfma_f32_16x16x32_bf16 v[144:147], v[32:35], v[232:235], v[144:147]
ds_read_b64_tr_b16 v[30:31], v113 offset:53248
s_add_u32 s53, s53, 2048
s_cmp_eq_u32 s53, s55
s_cselect_b32 s36, 14336, 0
s_add_u32 s53, s53, s36
v_mfma_f32_16x16x32_bf16 v[148:151], v[32:35], v[236:239], v[148:151]
ds_read_b64_tr_b16 v[32:33], v114 offset:49152
s_add_u32 m0, s52, 49152
v_mfma_f32_16x16x32_bf16 v[156:159], v[36:39], v[236:239], v[156:159]
ds_read_b64_tr_b16 v[34:35], v114 offset:53248
buffer_load_dwordx4 v120, s[16:19], s50 offen offset:0 lds
v_mfma_f32_16x16x32_bf16 v[152:155], v[36:39], v[232:235], v[152:155]
ds_read_b64_tr_b16 v[36:37], v115 offset:49152
s_waitcnt lgkmcnt(13)
v_mfma_f32_16x16x32_bf16 v[160:163], v[40:43], v[232:235], v[160:163]
ds_read_b64_tr_b16 v[38:39], v115 offset:53248
v_mfma_f32_16x16x32_bf16 v[164:167], v[40:43], v[236:239], v[164:167]
ds_read_b64_tr_b16 v[40:41], v116 offset:49152
buffer_load_dwordx4 v121, s[16:19], s50 offen offset:1024 lds
s_waitcnt lgkmcnt(13)
v_mfma_f32_16x16x32_bf16 v[172:175], v[44:47], v[236:239], v[172:175]
ds_read_b64_tr_b16 v[42:43], v116 offset:53248
v_mfma_f32_16x16x32_bf16 v[168:171], v[44:47], v[232:235], v[168:171]
ds_read_b64_tr_b16 v[44:45], v117 offset:49152
s_waitcnt lgkmcnt(13)
v_mfma_f32_16x16x32_bf16 v[176:179], v[48:51], v[232:235], v[176:179]
ds_read_b64_tr_b16 v[46:47], v117 offset:53248
buffer_load_dwordx4 v122, s[16:19], s50 offen offset:2048 lds
v_mfma_f32_16x16x32_bf16 v[180:183], v[48:51], v[236:239], v[180:183]
ds_read_b64_tr_b16 v[48:49], v118 offset:49152
s_waitcnt lgkmcnt(13)
v_mfma_f32_16x16x32_bf16 v[188:191], v[52:55], v[236:239], v[188:191]
ds_read_b64_tr_b16 v[50:51], v118 offset:53248
s_waitcnt vmcnt(39)
v_mov_b32 v126, 18
s_mov_b64 exec, s[60:61]
ds_write_b32 v125, v126
s_mov_b64 exec, -1
v_mfma_f32_16x16x32_bf16 v[184:187], v[52:55], v[232:235], v[184:187]
ds_read_b64_tr_b16 v[52:53], v119 offset:49152
ds_read_b64_tr_b16 v[54:55], v119 offset:53248
buffer_load_dwordx4 v123, s[16:19], s50 offen offset:3072 lds
s_waitcnt lgkmcnt(15)
s_waitcnt vmcnt(39)
v_mfma_f32_16x16x32_bf16 v[128:131], v[24:27], v[240:243], v[128:131]
s_add_u32 s54, s54, 131072
s_cmp_ge_u32 s54, s51
s_cselect_b32 s39, 458752, 0
s_add_u32 s50, s54, s39
s_waitcnt vmcnt(38)
v_mfma_f32_16x16x32_bf16 v[132:135], v[24:27], v[244:247], v[132:135]
ds_read_b64_tr_b16 v[24:25], v112 offset:57344
s_waitcnt lgkmcnt(14)
v_mfma_f32_16x16x32_bf16 v[140:143], v[28:31], v[244:247], v[140:143]
ds_read_b64_tr_b16 v[26:27], v112 offset:61440
buffer_load_dwordx4 v[192:195], v18, s[12:15], s53 offen offset:0
v_mfma_f32_16x16x32_bf16 v[136:139], v[28:31], v[240:243], v[136:139]
ds_read_b64_tr_b16 v[28:29], v113 offset:57344
s_waitcnt lgkmcnt(14)
v_mfma_f32_16x16x32_bf16 v[144:147], v[32:35], v[240:243], v[144:147]
ds_read_b64_tr_b16 v[30:31], v113 offset:61440
v_mfma_f32_16x16x32_bf16 v[148:151], v[32:35], v[244:247], v[148:151]
ds_read_b64_tr_b16 v[32:33], v114 offset:57344
buffer_load_dwordx4 v[196:199], v18, s[12:15], s53 offen offset:1024
s_waitcnt lgkmcnt(14)
v_mfma_f32_16x16x32_bf16 v[156:159], v[36:39], v[244:247], v[156:159]
ds_read_b64_tr_b16 v[34:35], v114 offset:61440
s_add_u32 s53, s53, 2048
v_mfma_f32_16x16x32_bf16 v[152:155], v[36:39], v[240:243], v[152:155]
ds_read_b64_tr_b16 v[36:37], v115 offset:57344
s_waitcnt lgkmcnt(14)
v_mfma_f32_16x16x32_bf16 v[160:163], v[40:43], v[240:243], v[160:163]
ds_read_b64_tr_b16 v[38:39], v115 offset:61440
buffer_load_dwordx4 v[200:203], v18, s[12:15], s53 offen offset:0
v_mfma_f32_16x16x32_bf16 v[164:167], v[40:43], v[244:247], v[164:167]
ds_read_b64_tr_b16 v[40:41], v116 offset:57344
ds_read_b32 v127, v125
s_waitcnt lgkmcnt(15)
v_mfma_f32_16x16x32_bf16 v[172:175], v[44:47], v[244:247], v[172:175]
ds_read_b64_tr_b16 v[42:43], v116 offset:61440
v_mfma_f32_16x16x32_bf16 v[168:171], v[44:47], v[240:243], v[168:171]
ds_read_b64_tr_b16 v[44:45], v117 offset:57344
buffer_load_dwordx4 v[204:207], v18, s[12:15], s53 offen offset:1024
s_waitcnt lgkmcnt(15)
v_mfma_f32_16x16x32_bf16 v[176:179], v[48:51], v[240:243], v[176:179]
ds_read_b64_tr_b16 v[46:47], v117 offset:61440
s_add_u32 s53, s53, 2048
v_mfma_f32_16x16x32_bf16 v[180:183], v[48:51], v[244:247], v[180:183]
ds_read_b64_tr_b16 v[48:49], v118 offset:57344
s_waitcnt lgkmcnt(14)
v_mfma_f32_16x16x32_bf16 v[188:191], v[52:55], v[244:247], v[188:191]
ds_read_b64_tr_b16 v[50:51], v118 offset:61440
buffer_load_dwordx4 v[208:211], v18, s[12:15], s53 offen offset:0
s_waitcnt lgkmcnt(5)
v_cmp_gt_u32 vcc, 18, v127
v_mfma_f32_16x16x32_bf16 v[184:187], v[52:55], v[240:243], v[184:187]
ds_read_b64_tr_b16 v[52:53], v119 offset:57344
ds_read_b64_tr_b16 v[54:55], v119 offset:61440
s_cbranch_vccnz LC_s18
LC_b18:
s_waitcnt vmcnt(42)
v_mfma_f32_16x16x32_bf16 v[128:131], v[24:27], v[248:251], v[128:131]
s_add_u32 m0, s52, 114688
s_waitcnt vmcnt(41)
v_mfma_f32_16x16x32_bf16 v[132:135], v[24:27], v[252:255], v[132:135]
ds_read_b64_tr_b16 v[24:25], v112 offset:32768
buffer_load_dwordx4 v120, s[16:19], s50 offen offset:0 lds
v_mfma_f32_16x16x32_bf16 v[140:143], v[28:31], v[252:255], v[140:143]
ds_read_b64_tr_b16 v[26:27], v112 offset:36864
v_mfma_f32_16x16x32_bf16 v[136:139], v[28:31], v[248:251], v[136:139]
ds_read_b64_tr_b16 v[28:29], v113 offset:32768
v_mfma_f32_16x16x32_bf16 v[144:147], v[32:35], v[248:251], v[144:147]
ds_read_b64_tr_b16 v[30:31], v113 offset:36864
buffer_load_dwordx4 v121, s[16:19], s50 offen offset:1024 lds
v_mfma_f32_16x16x32_bf16 v[148:151], v[32:35], v[252:255], v[148:151]
ds_read_b64_tr_b16 v[32:33], v114 offset:32768
v_mfma_f32_16x16x32_bf16 v[156:159], v[36:39], v[252:255], v[156:159]
ds_read_b64_tr_b16 v[34:35], v114 offset:36864
v_mfma_f32_16x16x32_bf16 v[152:155], v[36:39], v[248:251], v[152:155]
ds_read_b64_tr_b16 v[36:37], v115 offset:32768
buffer_load_dwordx4 v122, s[16:19], s50 offen offset:2048 lds
s_waitcnt lgkmcnt(13)
v_mfma_f32_16x16x32_bf16 v[160:163], v[40:43], v[248:251], v[160:163]
ds_read_b64_tr_b16 v[38:39], v115 offset:36864
v_mfma_f32_16x16x32_bf16 v[164:167], v[40:43], v[252:255], v[164:167]
ds_read_b64_tr_b16 v[40:41], v116 offset:32768
s_waitcnt lgkmcnt(13)
v_mfma_f32_16x16x32_bf16 v[172:175], v[44:47], v[252:255], v[172:175]
ds_read_b64_tr_b16 v[42:43], v116 offset:36864
buffer_load_dwordx4 v123, s[16:19], s50 offen offset:3072 lds
v_mfma_f32_16x16x32_bf16 v[168:171], v[44:47], v[248:251], v[168:171]
ds_read_b64_tr_b16 v[44:45], v117 offset:32768
s_add_u32 s54, s54, 131072
s_cmp_ge_u32 s54, s51
s_cselect_b32 s39, 458752, 0
s_add_u32 s50, s54, s39
s_waitcnt lgkmcnt(13)
v_mfma_f32_16x16x32_bf16 v[176:179], v[48:51], v[248:251], v[176:179]
ds_read_b64_tr_b16 v[46:47], v117 offset:36864
v_mfma_f32_16x16x32_bf16 v[180:183], v[48:51], v[252:255], v[180:183]
ds_read_b64_tr_b16 v[48:49], v118 offset:32768
buffer_load_dwordx4 v[212:215], v18, s[12:15], s53 offen offset:1024
s_waitcnt lgkmcnt(13)
v_mfma_f32_16x16x32_bf16 v[188:191], v[52:55], v[252:255], v[188:191]
ds_read_b64_tr_b16 v[50:51], v118 offset:36864
s_add_u32 s53, s53, 2048
s_waitcnt vmcnt(42)
v_mov_b32 v126, 20
s_mov_b64 exec, s[60:61]
ds_write_b32 v125, v126
s_mov_b64 exec, -1
v_mfma_f32_16x16x32_bf16 v[184:187], v[52:55], v[248:251], v[184:187]
ds_read_b64_tr_b16 v[52:53], v119 offset:32768
ds_read_b64_tr_b16 v[54:55], v119 offset:36864
s_waitcnt lgkmcnt(15)
s_waitcnt vmcnt(41)
v_mfma_f32_16x16x32_bf16 v[128:131], v[24:27], v[56:59], v[128:131]
buffer_load_dwordx4 v[216:219], v18, s[12:15], s53 offen offset:0
s_waitcnt vmcnt(41)
v_mfma_f32_16x16x32_bf16 v[132:135], v[24:27], v[60:63], v[132:135]
ds_read_b64_tr_b16 v[24:25], v112 offset:40960
s_waitcnt lgkmcnt(14)
v_mfma_f32_16x16x32_bf16 v[140:143], v[28:31], v[60:63], v[140:143]
ds_read_b64_tr_b16 v[26:27], v112 offset:45056
v_mfma_f32_16x16x32_bf16 v[136:139], v[28:31], v[56:59], v[136:139]
ds_read_b64_tr_b16 v[28:29], v113 offset:40960
buffer_load_dwordx4 v[220:223], v18, s[12:15], s53 offen offset:1024
s_waitcnt lgkmcnt(14)
v_mfma_f32_16x16x32_bf16 v[144:147], v[32:35], v[56:59], v[144:147]
ds_read_b64_tr_b16 v[30:31], v113 offset:45056
s_add_u32 s53, s53, 2048
v_mfma_f32_16x16x32_bf16 v[148:151], v[32:35], v[60:63], v[148:151]
ds_read_b64_tr_b16 v[32:33], v114 offset:40960
s_waitcnt lgkmcnt(14)
v_mfma_f32_16x16x32_bf16 v[156:159], v[36:39], v[60:63], v[156:159]
ds_read_b64_tr_b16 v[34:35], v114 offset:45056
buffer_load_dwordx4 v[224:227], v18, s[12:15], s53 offen offset:0
v_mfma_f32_16x16x32_bf16 v[152:155], v[36:39], v[56:59], v[152:155]
ds_read_b64_tr_b16 v[36:37], v115 offset:40960
s_waitcnt lgkmcnt(14)
v_mfma_f32_16x16x32_bf16 v[160:163], v[40:43], v[56:59], v[160:163]
ds_read_b64_tr_b16 v[38:39], v115 offset:45056
v_mfma_f32_16x16x32_bf16 v[164:167], v[40:43], v[60:63], v[164:167]
ds_read_b64_tr_b16 v[40:41], v116 offset:40960
buffer_load_dwordx4 v[228:231], v18, s[12:15], s53 offen offset:1024
ds_read_b32 v127, v125
s_waitcnt lgkmcnt(15)
v_mfma_f32_16x16x32_bf16 v[172:175], v[44:47], v[60:63], v[172:175]
ds_read_b64_tr_b16 v[42:43], v116 offset:45056
s_add_u32 s53, s53, 2048
v_mfma_f32_16x16x32_bf16 v[168:171], v[44:47], v[56:59], v[168:171]
ds_read_b64_tr_b16 v[44:45], v117 offset:40960
s_waitcnt lgkmcnt(15)
v_mfma_f32_16x16x32_bf16 v[176:179], v[48:51], v[56:59], v[176:179]
ds_read_b64_tr_b16 v[46:47], v117 offset:45056
buffer_load_dwordx4 v[232:235], v18, s[12:15], s53 offen offset:0
v_mfma_f32_16x16x32_bf16 v[180:183], v[48:51], v[60:63], v[180:183]
ds_read_b64_tr_b16 v[48:49], v118 offset:40960
s_waitcnt lgkmcnt(14)
v_mfma_f32_16x16x32_bf16 v[188:191], v[52:55], v[60:63], v[188:191]
ds_read_b64_tr_b16 v[50:51], v118 offset:45056
s_waitcnt lgkmcnt(5)
v_cmp_gt_u32 vcc, 20, v127
v_mfma_f32_16x16x32_bf16 v[184:187], v[52:55], v[56:59], v[184:187]
ds_read_b64_tr_b16 v[52:53], v119 offset:40960
ds_read_b64_tr_b16 v[54:55], v119 offset:45056
buffer_load_dwordx4 v[236:239], v18, s[12:15], s53 offen offset:1024
s_cbranch_vccnz LC_s20
LC_b20:
s_waitcnt vmcnt(45)
v_mfma_f32_16x16x32_bf16 v[128:131], v[24:27], v[64:67], v[128:131]
s_add_u32 s53, s53, 2048
s_waitcnt vmcnt(44)
v_mfma_f32_16x16x32_bf16 v[132:135], v[24:27], v[68:71], v[132:135]
ds_read_b64_tr_b16 v[24:25], v104 offset:0
s_add_u32 m0, s52, 147456
v_mfma_f32_16x16x32_bf16 v[140:143], v[28:31], v[68:71], v[140:143]
ds_read_b64_tr_b16 v[26:27], v104 offset:4096
buffer_load_dwordx4 v120, s[16:19], s50 offen offset:0 lds
v_mfma_f32_16x16x32_bf16 v[136:139], v[28:31], v[64:67], v[136:139]
ds_read_b64_tr_b16 v[28:29], v105 offset:0
v_mfma_f32_16x16x32_bf16 v[144:147], v[32:35], v[64:67], v[144:147]
ds_read_b64_tr_b16 v[30:31], v105 offset:4096
v_mfma_f32_16x16x32_bf16 v[148:151], v[32:35], v[68:71], v[148:151]
ds_read_b64_tr_b16 v[32:33], v106 offset:0
buffer_load_dwordx4 v121, s[16:19], s50 offen offset:1024 lds
v_mfma_f32_16x16x32_bf16 v[156:159], v[36:39], v[68:71], v[156:159]
ds_read_b64_tr_b16 v[34:35], v106 offset:4096
v_mfma_f32_16x16x32_bf16 v[152:155], v[36:39], v[64:67], v[152:155]
ds_read_b64_tr_b16 v[36:37], v107 offset:0
s_waitcnt lgkmcnt(13)
v_mfma_f32_16x16x32_bf16 v[160:163], v[40:43], v[64:67], v[160:163]
ds_read_b64_tr_b16 v[38:39], v107 offset:4096
buffer_load_dwordx4 v122, s[16:19], s50 offen offset:2048 lds
v_mfma_f32_16x16x32_bf16 v[164:167], v[40:43], v[68:71], v[164:167]
ds_read_b64_tr_b16 v[40:41], v108 offset:0
s_waitcnt lgkmcnt(13)
v_mfma_f32_16x16x32_bf16 v[172:175], v[44:47], v[68:71], v[172:175]
ds_read_b64_tr_b16 v[42:43], v108 offset:4096
v_mfma_f32_16x16x32_bf16 v[168:171], v[44:47], v[64:67], v[168:171]
ds_read_b64_tr_b16 v[44:45], v109 offset:0
buffer_load_dwordx4 v123, s[16:19], s50 offen offset:3072 lds
s_waitcnt lgkmcnt(13)
v_mfma_f32_16x16x32_bf16 v[176:179], v[48:51], v[64:67], v[176:179]
ds_read_b64_tr_b16 v[46:47], v109 offset:4096
s_add_u32 s54, s54, 131072
s_cmp_ge_u32 s54, s51
s_cselect_b32 s39, 458752, 0
s_add_u32 s50, s54, s39
v_mfma_f32_16x16x32_bf16 v[180:183], v[48:51], v[68:71], v[180:183]
ds_read_b64_tr_b16 v[48:49], v110 offset:0
s_waitcnt lgkmcnt(13)
v_mfma_f32_16x16x32_bf16 v[188:191], v[52:55], v[68:71], v[188:191]
ds_read_b64_tr_b16 v[50:51], v110 offset:4096
buffer_load_dwordx4 v[240:243], v18, s[12:15], s53 offen offset:0
s_waitcnt vmcnt(45)
v_mov_b32 v126, 22
s_mov_b64 exec, s[60:61]
ds_write_b32 v125, v126
s_mov_b64 exec, -1
v_mfma_f32_16x16x32_bf16 v[184:187], v[52:55], v[64:67], v[184:187]
ds_read_b64_tr_b16 v[52:53], v111 offset:0
ds_read_b64_tr_b16 v[54:55], v111 offset:4096
s_waitcnt lgkmcnt(15)
s_waitcnt vmcnt(44)
v_mfma_f32_16x16x32_bf16 v[128:131], v[24:27], v[72:75], v[128:131]
s_waitcnt vmcnt(43)
v_mfma_f32_16x16x32_bf16 v[132:135], v[24:27], v[76:79], v[132:135]
ds_read_b64_tr_b16 v[24:25], v104 offset:8192
buffer_load_dwordx4 v[244:247], v18, s[12:15], s53 offen offset:1024
s_waitcnt lgkmcnt(14)
v_mfma_f32_16x16x32_bf16 v[140:143], v[28:31], v[76:79], v[140:143]
ds_read_b64_tr_b16 v[26:27], v104 offset:12288
s_add_u32 s53, s53, 2048
s_cmp_eq_u32 s53, s55
s_cselect_b32 s36, 14336, 0
s_add_u32 s53, s53, s36
v_mfma_f32_16x16x32_bf16 v[136:139], v[28:31], v[72:75], v[136:139]
ds_read_b64_tr_b16 v[28:29], v105 offset:8192
s_waitcnt lgkmcnt(14)
v_mfma_f32_16x16x32_bf16 v[144:147], v[32:35], v[72:75], v[144:147]
ds_read_b64_tr_b16 v[30:31], v105 offset:12288
buffer_load_dwordx4 v[248:251], v18, s[12:15], s53 offen offset:0
v_mfma_f32_16x16x32_bf16 v[148:151], v[32:35], v[76:79], v[148:151]
ds_read_b64_tr_b16 v[32:33], v106 offset:8192
s_waitcnt lgkmcnt(14)
v_mfma_f32_16x16x32_bf16 v[156:159], v[36:39], v[76:79], v[156:159]
ds_read_b64_tr_b16 v[34:35], v106 offset:12288
v_mfma_f32_16x16x32_bf16 v[152:155], v[36:39], v[72:75], v[152:155]
ds_read_b64_tr_b16 v[36:37], v107 offset:8192
buffer_load_dwordx4 v[252:255], v18, s[12:15], s53 offen offset:1024
s_waitcnt lgkmcnt(14)
v_mfma_f32_16x16x32_bf16 v[160:163], v[40:43], v[72:75], v[160:163]
ds_read_b64_tr_b16 v[38:39], v107 offset:12288
s_add_u32 s53, s53, 2048
v_mfma_f32_16x16x32_bf16 v[164:167], v[40:43], v[76:79], v[164:167]
ds_read_b64_tr_b16 v[40:41], v108 offset:8192
ds_read_b32 v127, v125
s_waitcnt lgkmcnt(15)
v_mfma_f32_16x16x32_bf16 v[172:175], v[44:47], v[76:79], v[172:175]
ds_read_b64_tr_b16 v[42:43], v108 offset:12288
buffer_load_dwordx4 v[56:59], v18, s[12:15], s53 offen offset:0
v_mfma_f32_16x16x32_bf16 v[168:171], v[44:47], v[72:75], v[168:171]
ds_read_b64_tr_b16 v[44:45], v109 offset:8192
s_waitcnt lgkmcnt(15)
v_mfma_f32_16x16x32_bf16 v[176:179], v[48:51], v[72:75], v[176:179]
ds_read_b64_tr_b16 v[46:47], v109 offset:12288
v_mfma_f32_16x16x32_bf16 v[180:183], v[48:51], v[76:79], v[180:183]
ds_read_b64_tr_b16 v[48:49], v110 offset:8192
buffer_load_dwordx4 v[60:63], v18, s[12:15], s53 offen offset:1024
s_waitcnt lgkmcnt(14)
v_mfma_f32_16x16x32_bf16 v[188:191], v[52:55], v[76:79], v[188:191]
ds_read_b64_tr_b16 v[50:51], v110 offset:12288
s_add_u32 s53, s53, 2048
s_waitcnt lgkmcnt(5)
v_cmp_gt_u32 vcc, 22, v127
v_mfma_f32_16x16x32_bf16 v[184:187], v[52:55], v[72:75], v[184:187]
ds_read_b64_tr_b16 v[52:53], v111 offset:8192
ds_read_b64_tr_b16 v[54:55], v111 offset:12288
s_add_u32 m0, s52, 131072
s_cbranch_vccnz LC_s22
LC_b22:
s_waitcnt vmcnt(47)
v_mfma_f32_16x16x32_bf16 v[128:131], v[24:27], v[80:83], v[128:131]
buffer_load_dwordx4 v120, s[16:19], s50 offen offset:0 lds
s_waitcnt vmcnt(47)
v_mfma_f32_16x16x32_bf16 v[132:135], v[24:27], v[84:87], v[132:135]
ds_read_b64_tr_b16 v[24:25], v104 offset:16384
v_mfma_f32_16x16x32_bf16 v[140:143], v[28:31], v[84:87], v[140:143]
ds_read_b64_tr_b16 v[26:27], v104 offset:20480
v_mfma_f32_16x16x32_bf16 v[136:139], v[28:31], v[80:83], v[136:139]
ds_read_b64_tr_b16 v[28:29], v105 offset:16384
buffer_load_dwordx4 v121, s[16:19], s50 offen offset:1024 lds
v_mfma_f32_16x16x32_bf16 v[144:147], v[32:35], v[80:83], v[144:147]
ds_read_b64_tr_b16 v[30:31], v105 offset:20480
v_mfma_f32_16x16x32_bf16 v[148:151], v[32:35], v[84:87], v[148:151]
ds_read_b64_tr_b16 v[32:33], v106 offset:16384
v_mfma_f32_16x16x32_bf16 v[156:159], v[36:39], v[84:87], v[156:159]
ds_read_b64_tr_b16 v[34:35], v106 offset:20480
buffer_load_dwordx4 v122, s[16:19], s50 offen offset:2048 lds
v_mfma_f32_16x16x32_bf16 v[152:155], v[36:39], v[80:83], v[152:155]
ds_read_b64_tr_b16 v[36:37], v107 offset:16384
s_waitcnt lgkmcnt(13)
v_mfma_f32_16x16x32_bf16 v[160:163], v[40:43], v[80:83], v[160:163]
ds_read_b64_tr_b16 v[38:39], v107 offset:20480
v_mfma_f32_16x16x32_bf16 v[164:167], v[40:43], v[84:87], v[164:167]
ds_read_b64_tr_b16 v[40:41], v108 offset:16384
buffer_load_dwordx4 v123, s[16:19], s50 offen offset:3072 lds
s_waitcnt lgkmcnt(13)
v_mfma_f32_16x16x32_bf16 v[172:175], v[44:47], v[84:87], v[172:175]
ds_read_b64_tr_b16 v[42:43], v108 offset:20480
s_add_u32 s54, s54, 131072
s_cmp_ge_u32 s54, s51
s_cselect_b32 s39, 458752, 0
s_add_u32 s50, s54, s39
v_mfma_f32_16x16x32_bf16 v[168:171], v[44:47], v[80:83], v[168:171]
ds_read_b64_tr_b16 v[44:45], v109 offset:16384
s_waitcnt lgkmcnt(13)
v_mfma_f32_16x16x32_bf16 v[176:179], v[48:51], v[80:83], v[176:179]
ds_read_b64_tr_b16 v[46:47], v109 offset:20480
buffer_load_dwordx4 v[64:67], v18, s[12:15], s53 offen offset:0
v_mfma_f32_16x16x32_bf16 v[180:183], v[48:51], v[84:87], v[180:183]
ds_read_b64_tr_b16 v[48:49], v110 offset:16384
s_waitcnt lgkmcnt(13)
v_mfma_f32_16x16x32_bf16 v[188:191], v[52:55], v[84:87], v[188:191]
ds_read_b64_tr_b16 v[50:51], v110 offset:20480
s_waitcnt vmcnt(47)
v_mov_b32 v126, 24
s_mov_b64 exec, s[60:61]
ds_write_b32 v125, v126
s_mov_b64 exec, -1
v_mfma_f32_16x16x32_bf16 v[184:187], v[52:55], v[80:83], v[184:187]
ds_read_b64_tr_b16 v[52:53], v111 offset:16384
ds_read_b64_tr_b16 v[54:55], v111 offset:20480
buffer_load_dwordx4 v[68:71], v18, s[12:15], s53 offen offset:1024
s_waitcnt lgkmcnt(15)
s_waitcnt vmcnt(47)
v_mfma_f32_16x16x32_bf16 v[128:131], v[24:27], v[88:91], v[128:131]
s_add_u32 s53, s53, 2048
s_waitcnt vmcnt(46)
v_mfma_f32_16x16x32_bf16 v[132:135], v[24:27], v[92:95], v[132:135]
ds_read_b64_tr_b16 v[24:25], v104 offset:24576
s_waitcnt lgkmcnt(14)
v_mfma_f32_16x16x32_bf16 v[140:143], v[28:31], v[92:95], v[140:143]
ds_read_b64_tr_b16 v[26:27], v104 offset:28672
buffer_load_dwordx4 v[72:75], v18, s[12:15], s53 offen offset:0
v_mfma_f32_16x16x32_bf16 v[136:139], v[28:31], v[88:91], v[136:139]
ds_read_b64_tr_b16 v[28:29], v105 offset:24576
s_waitcnt lgkmcnt(14)
v_mfma_f32_16x16x32_bf16 v[144:147], v[32:35], v[88:91], v[144:147]
ds_read_b64_tr_b16 v[30:31], v105 offset:28672
v_mfma_f32_16x16x32_bf16 v[148:151], v[32:35], v[92:95], v[148:151]
ds_read_b64_tr_b16 v[32:33], v106 offset:24576
buffer_load_dwordx4 v[76:79], v18, s[12:15], s53 offen offset:1024
s_waitcnt lgkmcnt(14)
v_mfma_f32_16x16x32_bf16 v[156:159], v[36:39], v[92:95], v[156:159]
ds_read_b64_tr_b16 v[34:35], v106 offset:28672
s_add_u32 s53, s53, 2048
v_mfma_f32_16x16x32_bf16 v[152:155], v[36:39], v[88:91], v[152:155]
ds_read_b64_tr_b16 v[36:37], v107 offset:24576
s_waitcnt lgkmcnt(14)
v_mfma_f32_16x16x32_bf16 v[160:163], v[40:43], v[88:91], v[160:163]
ds_read_b64_tr_b16 v[38:39], v107 offset:28672
buffer_load_dwordx4 v[80:83], v18, s[12:15], s53 offen offset:0
v_mfma_f32_16x16x32_bf16 v[164:167], v[40:43], v[92:95], v[164:167]
ds_read_b64_tr_b16 v[40:41], v108 offset:24576
ds_read_b32 v127, v125
s_waitcnt lgkmcnt(15)
v_mfma_f32_16x16x32_bf16 v[172:175], v[44:47], v[92:95], v[172:175]
ds_read_b64_tr_b16 v[42:43], v108 offset:28672
v_mfma_f32_16x16x32_bf16 v[168:171], v[44:47], v[88:91], v[168:171]
ds_read_b64_tr_b16 v[44:45], v109 offset:24576
buffer_load_dwordx4 v[84:87], v18, s[12:15], s53 offen offset:1024
s_waitcnt lgkmcnt(15)
v_mfma_f32_16x16x32_bf16 v[176:179], v[48:51], v[88:91], v[176:179]
ds_read_b64_tr_b16 v[46:47], v109 offset:28672
s_add_u32 s53, s53, 2048
v_mfma_f32_16x16x32_bf16 v[180:183], v[48:51], v[92:95], v[180:183]
ds_read_b64_tr_b16 v[48:49], v110 offset:24576
s_waitcnt lgkmcnt(14)
v_mfma_f32_16x16x32_bf16 v[188:191], v[52:55], v[92:95], v[188:191]
ds_read_b64_tr_b16 v[50:51], v110 offset:28672
s_waitcnt lgkmcnt(5)
v_cmp_gt_u32 vcc, 24, v127
v_mfma_f32_16x16x32_bf16 v[184:187], v[52:55], v[88:91], v[184:187]
ds_read_b64_tr_b16 v[52:53], v111 offset:24576
ds_read_b64_tr_b16 v[54:55], v111 offset:28672
s_add_u32 m0, s52, 0
s_cbranch_vccnz LC_s24
LC_b24:
s_waitcnt vmcnt(49)
v_mfma_f32_16x16x32_bf16 v[128:131], v[24:27], v[96:99], v[128:131]
buffer_load_dwordx4 v120, s[16:19], s50 offen offset:0 lds
s_waitcnt vmcnt(49)
v_mfma_f32_16x16x32_bf16 v[132:135], v[24:27], v[100:103], v[132:135]
ds_read_b64_tr_b16 v[24:25], v112 offset:0
v_mfma_f32_16x16x32_bf16 v[140:143], v[28:31], v[100:103], v[140:143]
ds_read_b64_tr_b16 v[26:27], v112 offset:4096
v_mfma_f32_16x16x32_bf16 v[136:139], v[28:31], v[96:99], v[136:139]
ds_read_b64_tr_b16 v[28:29], v113 offset:0
buffer_load_dwordx4 v121, s[16:19], s50 offen offset:1024 lds
v_mfma_f32_16x16x32_bf16 v[144:147], v[32:35], v[96:99], v[144:147]
ds_read_b64_tr_b16 v[30:31], v113 offset:4096
v_mfma_f32_16x16x32_bf16 v[148:151], v[32:35], v[100:103], v[148:151]
ds_read_b64_tr_b16 v[32:33], v114 offset:0
v_mfma_f32_16x16x32_bf16 v[156:159], v[36:39], v[100:103], v[156:159]
ds_read_b64_tr_b16 v[34:35], v114 offset:4096
buffer_load_dwordx4 v122, s[16:19], s50 offen offset:2048 lds
v_mfma_f32_16x16x32_bf16 v[152:155], v[36:39], v[96:99], v[152:155]
ds_read_b64_tr_b16 v[36:37], v115 offset:0
s_waitcnt lgkmcnt(13)
v_mfma_f32_16x16x32_bf16 v[160:163], v[40:43], v[96:99], v[160:163]
ds_read_b64_tr_b16 v[38:39], v115 offset:4096
v_mfma_f32_16x16x32_bf16 v[164:167], v[40:43], v[100:103], v[164:167]
ds_read_b64_tr_b16 v[40:41], v116 offset:0
buffer_load_dwordx4 v123, s[16:19], s50 offen offset:3072 lds
s_waitcnt lgkmcnt(13)
v_mfma_f32_16x16x32_bf16 v[172:175], v[44:47], v[100:103], v[172:175]
ds_read_b64_tr_b16 v[42:43], v116 offset:4096
s_add_u32 s54, s54, 131072
s_cmp_ge_u32 s54, s51
s_cselect_b32 s39, 458752, 0
s_add_u32 s50, s54, s39
v_mfma_f32_16x16x32_bf16 v[168:171], v[44:47], v[96:99], v[168:171]
ds_read_b64_tr_b16 v[44:45], v117 offset:0
s_waitcnt lgkmcnt(13)
v_mfma_f32_16x16x32_bf16 v[176:179], v[48:51], v[96:99], v[176:179]
ds_read_b64_tr_b16 v[46:47], v117 offset:4096
buffer_load_dwordx4 v[88:91], v18, s[12:15], s53 offen offset:0
v_mfma_f32_16x16x32_bf16 v[180:183], v[48:51], v[100:103], v[180:183]
ds_read_b64_tr_b16 v[48:49], v118 offset:0
s_waitcnt lgkmcnt(13)
v_mfma_f32_16x16x32_bf16 v[188:191], v[52:55], v[100:103], v[188:191]
ds_read_b64_tr_b16 v[50:51], v118 offset:4096
s_waitcnt vmcnt(49)
v_mov_b32 v126, 26
s_mov_b64 exec, s[60:61]
ds_write_b32 v125, v126
s_mov_b64 exec, -1
v_mfma_f32_16x16x32_bf16 v[184:187], v[52:55], v[96:99], v[184:187]
ds_read_b64_tr_b16 v[52:53], v119 offset:0
ds_read_b64_tr_b16 v[54:55], v119 offset:4096
buffer_load_dwordx4 v[92:95], v18, s[12:15], s53 offen offset:1024
s_waitcnt lgkmcnt(15)
s_waitcnt vmcnt(49)
v_mfma_f32_16x16x32_bf16 v[128:131], v[24:27], v[2:5], v[128:131]
s_add_u32 s53, s53, 2048
s_waitcnt vmcnt(48)
v_mfma_f32_16x16x32_bf16 v[132:135], v[24:27], v[6:9], v[132:135]
ds_read_b64_tr_b16 v[24:25], v112 offset:8192
s_waitcnt lgkmcnt(14)
v_mfma_f32_16x16x32_bf16 v[140:143], v[28:31], v[6:9], v[140:143]
ds_read_b64_tr_b16 v[26:27], v112 offset:12288
buffer_load_dwordx4 v[96:99], v18, s[12:15], s53 offen offset:0
v_mfma_f32_16x16x32_bf16 v[136:139], v[28:31], v[2:5], v[136:139]
ds_read_b64_tr_b16 v[28:29], v113 offset:8192
s_waitcnt lgkmcnt(14)
v_mfma_f32_16x16x32_bf16 v[144:147], v[32:35], v[2:5], v[144:147]
ds_read_b64_tr_b16 v[30:31], v113 offset:12288
v_mfma_f32_16x16x32_bf16 v[148:151], v[32:35], v[6:9], v[148:151]
ds_read_b64_tr_b16 v[32:33], v114 offset:8192
buffer_load_dwordx4 v[100:103], v18, s[12:15], s53 offen offset:1024
s_waitcnt lgkmcnt(14)
v_mfma_f32_16x16x32_bf16 v[156:159], v[36:39], v[6:9], v[156:159]
ds_read_b64_tr_b16 v[34:35], v114 offset:12288
s_add_u32 s53, s53, 2048
s_cmp_eq_u32 s53, s55
s_cselect_b32 s36, 14336, 0
s_add_u32 s53, s53, s36
v_mfma_f32_16x16x32_bf16 v[152:155], v[36:39], v[2:5], v[152:155]
ds_read_b64_tr_b16 v[36:37], v115 offset:8192
s_waitcnt lgkmcnt(14)
v_mfma_f32_16x16x32_bf16 v[160:163], v[40:43], v[2:5], v[160:163]
ds_read_b64_tr_b16 v[38:39], v115 offset:12288
v_mfma_f32_16x16x32_bf16 v[164:167], v[40:43], v[6:9], v[164:167]
ds_read_b64_tr_b16 v[40:41], v116 offset:8192
ds_read_b32 v127, v125
s_waitcnt lgkmcnt(15)
v_mfma_f32_16x16x32_bf16 v[172:175], v[44:47], v[6:9], v[172:175]
ds_read_b64_tr_b16 v[42:43], v116 offset:12288
v_mfma_f32_16x16x32_bf16 v[168:171], v[44:47], v[2:5], v[168:171]
ds_read_b64_tr_b16 v[44:45], v117 offset:8192
s_waitcnt lgkmcnt(15)
v_mfma_f32_16x16x32_bf16 v[176:179], v[48:51], v[2:5], v[176:179]
ds_read_b64_tr_b16 v[46:47], v117 offset:12288
v_mfma_f32_16x16x32_bf16 v[180:183], v[48:51], v[6:9], v[180:183]
ds_read_b64_tr_b16 v[48:49], v118 offset:8192
s_waitcnt lgkmcnt(14)
v_mfma_f32_16x16x32_bf16 v[188:191], v[52:55], v[6:9], v[188:191]
ds_read_b64_tr_b16 v[50:51], v118 offset:12288
s_waitcnt lgkmcnt(5)
v_cmp_gt_u32 vcc, 26, v127
v_mfma_f32_16x16x32_bf16 v[184:187], v[52:55], v[2:5], v[184:187]
ds_read_b64_tr_b16 v[52:53], v119 offset:8192
ds_read_b64_tr_b16 v[54:55], v119 offset:12288
s_add_u32 m0, s52, 16384
s_cbranch_vccnz LC_s26
LC_b26:
s_waitcnt vmcnt(49)
v_mfma_f32_16x16x32_bf16 v[128:131], v[24:27], v[10:13], v[128:131]
buffer_load_dwordx4 v120, s[16:19], s50 offen offset:0 lds
s_waitcnt vmcnt(49)
v_mfma_f32_16x16x32_bf16 v[132:135], v[24:27], v[14:17], v[132:135]
ds_read_b64_tr_b16 v[24:25], v104 offset:32768
v_mfma_f32_16x16x32_bf16 v[140:143], v[28:31], v[14:17], v[140:143]
ds_read_b64_tr_b16 v[26:27], v104 offset:36864
v_mfma_f32_16x16x32_bf16 v[136:139], v[28:31], v[10:13], v[136:139]
ds_read_b64_tr_b16 v[28:29], v105 offset:32768
buffer_load_dwordx4 v121, s[16:19], s50 offen offset:1024 lds
v_mfma_f32_16x16x32_bf16 v[144:147], v[32:35], v[10:13], v[144:147]
ds_read_b64_tr_b16 v[30:31], v105 offset:36864
v_mfma_f32_16x16x32_bf16 v[148:151], v[32:35], v[14:17], v[148:151]
ds_read_b64_tr_b16 v[32:33], v106 offset:32768
v_mfma_f32_16x16x32_bf16 v[156:159], v[36:39], v[14:17], v[156:159]
ds_read_b64_tr_b16 v[34:35], v106 offset:36864
buffer_load_dwordx4 v122, s[16:19], s50 offen offset:2048 lds
v_mfma_f32_16x16x32_bf16 v[152:155], v[36:39], v[10:13], v[152:155]
ds_read_b64_tr_b16 v[36:37], v107 offset:32768
s_waitcnt lgkmcnt(13)
v_mfma_f32_16x16x32_bf16 v[160:163], v[40:43], v[10:13], v[160:163]
ds_read_b64_tr_b16 v[38:39], v107 offset:36864
v_mfma_f32_16x16x32_bf16 v[164:167], v[40:43], v[14:17], v[164:167]
ds_read_b64_tr_b16 v[40:41], v108 offset:32768
buffer_load_dwordx4 v123, s[16:19], s50 offen offset:3072 lds
s_waitcnt lgkmcnt(13)
v_mfma_f32_16x16x32_bf16 v[172:175], v[44:47], v[14:17], v[172:175]
ds_read_b64_tr_b16 v[42:43], v108 offset:36864
s_add_u32 s54, s54, 131072
s_cmp_ge_u32 s54, s51
s_cselect_b32 s39, 458752, 0
s_add_u32 s50, s54, s39
v_mfma_f32_16x16x32_bf16 v[168:171], v[44:47], v[10:13], v[168:171]
ds_read_b64_tr_b16 v[44:45], v109 offset:32768
s_waitcnt lgkmcnt(13)
v_mfma_f32_16x16x32_bf16 v[176:179], v[48:51], v[10:13], v[176:179]
ds_read_b64_tr_b16 v[46:47], v109 offset:36864
buffer_load_dwordx4 v[2:5], v18, s[12:15], s53 offen offset:0
v_mfma_f32_16x16x32_bf16 v[180:183], v[48:51], v[14:17], v[180:183]
ds_read_b64_tr_b16 v[48:49], v110 offset:32768
s_waitcnt lgkmcnt(13)
v_mfma_f32_16x16x32_bf16 v[188:191], v[52:55], v[14:17], v[188:191]
ds_read_b64_tr_b16 v[50:51], v110 offset:36864
s_waitcnt vmcnt(49)
v_mov_b32 v126, 28
s_mov_b64 exec, s[60:61]
ds_write_b32 v125, v126
s_mov_b64 exec, -1
v_mfma_f32_16x16x32_bf16 v[184:187], v[52:55], v[10:13], v[184:187]
ds_read_b64_tr_b16 v[52:53], v111 offset:32768
ds_read_b64_tr_b16 v[54:55], v111 offset:36864
buffer_load_dwordx4 v[6:9], v18, s[12:15], s53 offen offset:1024
s_waitcnt lgkmcnt(15)
s_waitcnt vmcnt(49)
v_mfma_f32_16x16x32_bf16 v[128:131], v[24:27], v[192:195], v[128:131]
s_add_u32 s53, s53, 2048
s_waitcnt vmcnt(48)
v_mfma_f32_16x16x32_bf16 v[132:135], v[24:27], v[196:199], v[132:135]
ds_read_b64_tr_b16 v[24:25], v104 offset:40960
s_waitcnt lgkmcnt(14)
v_mfma_f32_16x16x32_bf16 v[140:143], v[28:31], v[196:199], v[140:143]
ds_read_b64_tr_b16 v[26:27], v104 offset:45056
buffer_load_dwordx4 v[10:13], v18, s[12:15], s53 offen offset:0
v_mfma_f32_16x16x32_bf16 v[136:139], v[28:31], v[192:195], v[136:139]
ds_read_b64_tr_b16 v[28:29], v105 offset:40960
s_waitcnt lgkmcnt(14)
v_mfma_f32_16x16x32_bf16 v[144:147], v[32:35], v[192:195], v[144:147]
ds_read_b64_tr_b16 v[30:31], v105 offset:45056
v_mfma_f32_16x16x32_bf16 v[148:151], v[32:35], v[196:199], v[148:151]
ds_read_b64_tr_b16 v[32:33], v106 offset:40960
buffer_load_dwordx4 v[14:17], v18, s[12:15], s53 offen offset:1024
s_waitcnt lgkmcnt(14)
v_mfma_f32_16x16x32_bf16 v[156:159], v[36:39], v[196:199], v[156:159]
ds_read_b64_tr_b16 v[34:35], v106 offset:45056
s_add_u32 s53, s53, 2048
v_mfma_f32_16x16x32_bf16 v[152:155], v[36:39], v[192:195], v[152:155]
ds_read_b64_tr_b16 v[36:37], v107 offset:40960
s_waitcnt lgkmcnt(14)
v_mfma_f32_16x16x32_bf16 v[160:163], v[40:43], v[192:195], v[160:163]
ds_read_b64_tr_b16 v[38:39], v107 offset:45056
v_mfma_f32_16x16x32_bf16 v[164:167], v[40:43], v[196:199], v[164:167]
ds_read_b64_tr_b16 v[40:41], v108 offset:40960
ds_read_b32 v127, v125
s_waitcnt lgkmcnt(15)
v_mfma_f32_16x16x32_bf16 v[172:175], v[44:47], v[196:199], v[172:175]
ds_read_b64_tr_b16 v[42:43], v108 offset:45056
v_mfma_f32_16x16x32_bf16 v[168:171], v[44:47], v[192:195], v[168:171]
ds_read_b64_tr_b16 v[44:45], v109 offset:40960
s_waitcnt lgkmcnt(15)
v_mfma_f32_16x16x32_bf16 v[176:179], v[48:51], v[192:195], v[176:179]
ds_read_b64_tr_b16 v[46:47], v109 offset:45056
v_mfma_f32_16x16x32_bf16 v[180:183], v[48:51], v[196:199], v[180:183]
ds_read_b64_tr_b16 v[48:49], v110 offset:40960
s_waitcnt lgkmcnt(14)
v_mfma_f32_16x16x32_bf16 v[188:191], v[52:55], v[196:199], v[188:191]
ds_read_b64_tr_b16 v[50:51], v110 offset:45056
s_waitcnt lgkmcnt(5)
v_cmp_gt_u32 vcc, 28, v127
v_mfma_f32_16x16x32_bf16 v[184:187], v[52:55], v[192:195], v[184:187]
ds_read_b64_tr_b16 v[52:53], v111 offset:40960
ds_read_b64_tr_b16 v[54:55], v111 offset:45056
s_add_u32 m0, s52, 98304
s_cbranch_vccnz LC_s28
LC_b28:
s_waitcnt vmcnt(49)
v_mfma_f32_16x16x32_bf16 v[128:131], v[24:27], v[200:203], v[128:131]
buffer_load_dwordx4 v120, s[16:19], s50 offen offset:0 lds
s_waitcnt vmcnt(49)
v_mfma_f32_16x16x32_bf16 v[132:135], v[24:27], v[204:207], v[132:135]
ds_read_b64_tr_b16 v[24:25], v104 offset:49152
v_mfma_f32_16x16x32_bf16 v[140:143], v[28:31], v[204:207], v[140:143]
ds_read_b64_tr_b16 v[26:27], v104 offset:53248
v_mfma_f32_16x16x32_bf16 v[136:139], v[28:31], v[200:203], v[136:139]
ds_read_b64_tr_b16 v[28:29], v105 offset:49152
buffer_load_dwordx4 v121, s[16:19], s50 offen offset:1024 lds
v_mfma_f32_16x16x32_bf16 v[144:147], v[32:35], v[200:203], v[144:147]
ds_read_b64_tr_b16 v[30:31], v105 offset:53248
v_mfma_f32_16x16x32_bf16 v[148:151], v[32:35], v[204:207], v[148:151]
ds_read_b64_tr_b16 v[32:33], v106 offset:49152
v_mfma_f32_16x16x32_bf16 v[156:159], v[36:39], v[204:207], v[156:159]
ds_read_b64_tr_b16 v[34:35], v106 offset:53248
buffer_load_dwordx4 v122, s[16:19], s50 offen offset:2048 lds
v_mfma_f32_16x16x32_bf16 v[152:155], v[36:39], v[200:203], v[152:155]
ds_read_b64_tr_b16 v[36:37], v107 offset:49152
s_waitcnt lgkmcnt(13)
v_mfma_f32_16x16x32_bf16 v[160:163], v[40:43], v[200:203], v[160:163]
ds_read_b64_tr_b16 v[38:39], v107 offset:53248
v_mfma_f32_16x16x32_bf16 v[164:167], v[40:43], v[204:207], v[164:167]
ds_read_b64_tr_b16 v[40:41], v108 offset:49152
buffer_load_dwordx4 v123, s[16:19], s50 offen offset:3072 lds
s_waitcnt lgkmcnt(13)
v_mfma_f32_16x16x32_bf16 v[172:175], v[44:47], v[204:207], v[172:175]
ds_read_b64_tr_b16 v[42:43], v108 offset:53248
s_add_u32 s54, s54, 131072
s_cmp_ge_u32 s54, s51
s_cselect_b32 s39, 458752, 0
s_add_u32 s50, s54, s39
v_mfma_f32_16x16x32_bf16 v[168:171], v[44:47], v[200:203], v[168:171]
ds_read_b64_tr_b16 v[44:45], v109 offset:49152
s_waitcnt lgkmcnt(13)
v_mfma_f32_16x16x32_bf16 v[176:179], v[48:51], v[200:203], v[176:179]
ds_read_b64_tr_b16 v[46:47], v109 offset:53248
buffer_load_dwordx4 v[192:195], v18, s[12:15], s53 offen offset:0
v_mfma_f32_16x16x32_bf16 v[180:183], v[48:51], v[204:207], v[180:183]
ds_read_b64_tr_b16 v[48:49], v110 offset:49152
s_waitcnt lgkmcnt(13)
v_mfma_f32_16x16x32_bf16 v[188:191], v[52:55], v[204:207], v[188:191]
ds_read_b64_tr_b16 v[50:51], v110 offset:53248
s_waitcnt vmcnt(48)
v_mov_b32 v126, 30
s_mov_b64 exec, s[60:61]
ds_write_b32 v125, v126
s_mov_b64 exec, -1
v_mfma_f32_16x16x32_bf16 v[184:187], v[52:55], v[200:203], v[184:187]
ds_read_b64_tr_b16 v[52:53], v111 offset:49152
ds_read_b64_tr_b16 v[54:55], v111 offset:53248
buffer_load_dwordx4 v[196:199], v18, s[12:15], s53 offen offset:1024
s_waitcnt lgkmcnt(15)
v_mfma_f32_16x16x32_bf16 v[128:131], v[24:27], v[208:211], v[128:131]
s_add_u32 s53, s53, 2048
s_waitcnt vmcnt(48)
v_mfma_f32_16x16x32_bf16 v[132:135], v[24:27], v[212:215], v[132:135]
ds_read_b64_tr_b16 v[24:25], v104 offset:57344
s_waitcnt lgkmcnt(14)
v_mfma_f32_16x16x32_bf16 v[140:143], v[28:31], v[212:215], v[140:143]
ds_read_b64_tr_b16 v[26:27], v104 offset:61440
buffer_load_dwordx4 v[200:203], v18, s[12:15], s53 offen offset:0
v_mfma_f32_16x16x32_bf16 v[136:139], v[28:31], v[208:211], v[136:139]
ds_read_b64_tr_b16 v[28:29], v105 offset:57344
s_waitcnt lgkmcnt(14)
v_mfma_f32_16x16x32_bf16 v[144:147], v[32:35], v[208:211], v[144:147]
ds_read_b64_tr_b16 v[30:31], v105 offset:61440
v_mfma_f32_16x16x32_bf16 v[148:151], v[32:35], v[212:215], v[148:151]
ds_read_b64_tr_b16 v[32:33], v106 offset:57344
buffer_load_dwordx4 v[204:207], v18, s[12:15], s53 offen offset:1024
s_waitcnt lgkmcnt(14)
v_mfma_f32_16x16x32_bf16 v[156:159], v[36:39], v[212:215], v[156:159]
ds_read_b64_tr_b16 v[34:35], v106 offset:61440
s_add_u32 s53, s53, 2048
v_mfma_f32_16x16x32_bf16 v[152:155], v[36:39], v[208:211], v[152:155]
ds_read_b64_tr_b16 v[36:37], v107 offset:57344
s_waitcnt lgkmcnt(14)
v_mfma_f32_16x16x32_bf16 v[160:163], v[40:43], v[208:211], v[160:163]
ds_read_b64_tr_b16 v[38:39], v107 offset:61440
v_mfma_f32_16x16x32_bf16 v[164:167], v[40:43], v[212:215], v[164:167]
ds_read_b64_tr_b16 v[40:41], v108 offset:57344
ds_read_b32 v127, v125
s_waitcnt lgkmcnt(15)
v_mfma_f32_16x16x32_bf16 v[172:175], v[44:47], v[212:215], v[172:175]
ds_read_b64_tr_b16 v[42:43], v108 offset:61440
v_mfma_f32_16x16x32_bf16 v[168:171], v[44:47], v[208:211], v[168:171]
ds_read_b64_tr_b16 v[44:45], v109 offset:57344
s_waitcnt lgkmcnt(15)
v_mfma_f32_16x16x32_bf16 v[176:179], v[48:51], v[208:211], v[176:179]
ds_read_b64_tr_b16 v[46:47], v109 offset:61440
v_mfma_f32_16x16x32_bf16 v[180:183], v[48:51], v[212:215], v[180:183]
ds_read_b64_tr_b16 v[48:49], v110 offset:57344
s_waitcnt lgkmcnt(14)
v_mfma_f32_16x16x32_bf16 v[188:191], v[52:55], v[212:215], v[188:191]
ds_read_b64_tr_b16 v[50:51], v110 offset:61440
s_waitcnt lgkmcnt(5)
v_cmp_gt_u32 vcc, 30, v127
v_mfma_f32_16x16x32_bf16 v[184:187], v[52:55], v[208:211], v[184:187]
ds_read_b64_tr_b16 v[52:53], v111 offset:57344
ds_read_b64_tr_b16 v[54:55], v111 offset:61440
s_add_u32 m0, s52, 32768
s_cbranch_vccnz LC_s30
LC_b30:
s_waitcnt vmcnt(49)
v_mfma_f32_16x16x32_bf16 v[128:131], v[24:27], v[216:219], v[128:131]
buffer_load_dwordx4 v120, s[16:19], s50 offen offset:0 lds
s_waitcnt vmcnt(49)
v_mfma_f32_16x16x32_bf16 v[132:135], v[24:27], v[220:223], v[132:135]
ds_read_b64_tr_b16 v[24:25], v112 offset:16384
v_mfma_f32_16x16x32_bf16 v[140:143], v[28:31], v[220:223], v[140:143]
ds_read_b64_tr_b16 v[26:27], v112 offset:20480
v_mfma_f32_16x16x32_bf16 v[136:139], v[28:31], v[216:219], v[136:139]
ds_read_b64_tr_b16 v[28:29], v113 offset:16384
buffer_load_dwordx4 v121, s[16:19], s50 offen offset:1024 lds
v_mfma_f32_16x16x32_bf16 v[144:147], v[32:35], v[216:219], v[144:147]
ds_read_b64_tr_b16 v[30:31], v113 offset:20480
v_mfma_f32_16x16x32_bf16 v[148:151], v[32:35], v[220:223], v[148:151]
ds_read_b64_tr_b16 v[32:33], v114 offset:16384
v_mfma_f32_16x16x32_bf16 v[156:159], v[36:39], v[220:223], v[156:159]
ds_read_b64_tr_b16 v[34:35], v114 offset:20480
buffer_load_dwordx4 v122, s[16:19], s50 offen offset:2048 lds
v_mfma_f32_16x16x32_bf16 v[152:155], v[36:39], v[216:219], v[152:155]
ds_read_b64_tr_b16 v[36:37], v115 offset:16384
s_waitcnt lgkmcnt(13)
v_mfma_f32_16x16x32_bf16 v[160:163], v[40:43], v[216:219], v[160:163]
ds_read_b64_tr_b16 v[38:39], v115 offset:20480
v_mfma_f32_16x16x32_bf16 v[164:167], v[40:43], v[220:223], v[164:167]
ds_read_b64_tr_b16 v[40:41], v116 offset:16384
buffer_load_dwordx4 v123, s[16:19], s50 offen offset:3072 lds
s_waitcnt lgkmcnt(13)
v_mfma_f32_16x16x32_bf16 v[172:175], v[44:47], v[220:223], v[172:175]
ds_read_b64_tr_b16 v[42:43], v116 offset:20480
s_add_u32 s54, s54, 131072
s_cmp_ge_u32 s54, s51
s_cselect_b32 s39, 458752, 0
s_add_u32 s50, s54, s39
v_mfma_f32_16x16x32_bf16 v[168:171], v[44:47], v[216:219], v[168:171]
ds_read_b64_tr_b16 v[44:45], v117 offset:16384
s_waitcnt lgkmcnt(13)
v_mfma_f32_16x16x32_bf16 v[176:179], v[48:51], v[216:219], v[176:179]
ds_read_b64_tr_b16 v[46:47], v117 offset:20480
buffer_load_dwordx4 v[208:211], v18, s[12:15], s53 offen offset:0
v_mfma_f32_16x16x32_bf16 v[180:183], v[48:51], v[220:223], v[180:183]
ds_read_b64_tr_b16 v[48:49], v118 offset:16384
s_waitcnt lgkmcnt(13)
v_mfma_f32_16x16x32_bf16 v[188:191], v[52:55], v[220:223], v[188:191]
ds_read_b64_tr_b16 v[50:51], v118 offset:20480
s_waitcnt vmcnt(45)
v_mov_b32 v126, 32
s_mov_b64 exec, s[60:61]
ds_write_b32 v125, v126
s_mov_b64 exec, -1
v_mfma_f32_16x16x32_bf16 v[184:187], v[52:55], v[216:219], v[184:187]
ds_read_b64_tr_b16 v[52:53], v119 offset:16384
ds_read_b64_tr_b16 v[54:55], v119 offset:20480
buffer_load_dwordx4 v[212:215], v18, s[12:15], s53 offen offset:1024
s_waitcnt lgkmcnt(15)
v_mfma_f32_16x16x32_bf16 v[128:131], v[24:27], v[224:227], v[128:131]
s_add_u32 s53, s53, 2048
v_mfma_f32_16x16x32_bf16 v[132:135], v[24:27], v[228:231], v[132:135]
ds_read_b64_tr_b16 v[24:25], v112 offset:24576
s_waitcnt lgkmcnt(14)
v_mfma_f32_16x16x32_bf16 v[140:143], v[28:31], v[228:231], v[140:143]
ds_read_b64_tr_b16 v[26:27], v112 offset:28672
buffer_load_dwordx4 v[216:219], v18, s[12:15], s53 offen offset:0
v_mfma_f32_16x16x32_bf16 v[136:139], v[28:31], v[224:227], v[136:139]
ds_read_b64_tr_b16 v[28:29], v113 offset:24576
s_waitcnt lgkmcnt(14)
v_mfma_f32_16x16x32_bf16 v[144:147], v[32:35], v[224:227], v[144:147]
ds_read_b64_tr_b16 v[30:31], v113 offset:28672
v_mfma_f32_16x16x32_bf16 v[148:151], v[32:35], v[228:231], v[148:151]
ds_read_b64_tr_b16 v[32:33], v114 offset:24576
buffer_load_dwordx4 v[220:223], v18, s[12:15], s53 offen offset:1024
s_waitcnt lgkmcnt(14)
v_mfma_f32_16x16x32_bf16 v[156:159], v[36:39], v[228:231], v[156:159]
ds_read_b64_tr_b16 v[34:35], v114 offset:28672
s_add_u32 s53, s53, 2048
v_mfma_f32_16x16x32_bf16 v[152:155], v[36:39], v[224:227], v[152:155]
ds_read_b64_tr_b16 v[36:37], v115 offset:24576
s_waitcnt lgkmcnt(14)
v_mfma_f32_16x16x32_bf16 v[160:163], v[40:43], v[224:227], v[160:163]
ds_read_b64_tr_b16 v[38:39], v115 offset:28672
v_mfma_f32_16x16x32_bf16 v[164:167], v[40:43], v[228:231], v[164:167]
ds_read_b64_tr_b16 v[40:41], v116 offset:24576
ds_read_b32 v127, v125
s_waitcnt lgkmcnt(15)
v_mfma_f32_16x16x32_bf16 v[172:175], v[44:47], v[228:231], v[172:175]
ds_read_b64_tr_b16 v[42:43], v116 offset:28672
v_mfma_f32_16x16x32_bf16 v[168:171], v[44:47], v[224:227], v[168:171]
ds_read_b64_tr_b16 v[44:45], v117 offset:24576
s_waitcnt lgkmcnt(15)
v_mfma_f32_16x16x32_bf16 v[176:179], v[48:51], v[224:227], v[176:179]
ds_read_b64_tr_b16 v[46:47], v117 offset:28672
v_mfma_f32_16x16x32_bf16 v[180:183], v[48:51], v[228:231], v[180:183]
ds_read_b64_tr_b16 v[48:49], v118 offset:24576
s_waitcnt lgkmcnt(14)
v_mfma_f32_16x16x32_bf16 v[188:191], v[52:55], v[228:231], v[188:191]
ds_read_b64_tr_b16 v[50:51], v118 offset:28672
s_waitcnt lgkmcnt(5)
v_cmp_gt_u32 vcc, 32, v127
v_mfma_f32_16x16x32_bf16 v[184:187], v[52:55], v[224:227], v[184:187]
ds_read_b64_tr_b16 v[52:53], v119 offset:24576
ds_read_b64_tr_b16 v[54:55], v119 offset:28672
s_add_u32 m0, s52, 49152
s_cbranch_vccnz LC_s32
LC_b32:
v_mfma_f32_16x16x32_bf16 v[128:131], v[24:27], v[232:235], v[128:131]
buffer_load_dwordx4 v120, s[16:19], s50 offen offset:0 lds
v_mfma_f32_16x16x32_bf16 v[132:135], v[24:27], v[236:239], v[132:135]
ds_read_b64_tr_b16 v[24:25], v112 offset:49152
v_mfma_f32_16x16x32_bf16 v[140:143], v[28:31], v[236:239], v[140:143]
ds_read_b64_tr_b16 v[26:27], v112 offset:53248
v_mfma_f32_16x16x32_bf16 v[136:139], v[28:31], v[232:235], v[136:139]
ds_read_b64_tr_b16 v[28:29], v113 offset:49152
buffer_load_dwordx4 v121, s[16:19], s50 offen offset:1024 lds
v_mfma_f32_16x16x32_bf16 v[144:147], v[32:35], v[232:235], v[144:147]
ds_read_b64_tr_b16 v[30:31], v113 offset:53248
v_mfma_f32_16x16x32_bf16 v[148:151], v[32:35], v[236:239], v[148:151]
ds_read_b64_tr_b16 v[32:33], v114 offset:49152
v_mfma_f32_16x16x32_bf16 v[156:159], v[36:39], v[236:239], v[156:159]
ds_read_b64_tr_b16 v[34:35], v114 offset:53248
buffer_load_dwordx4 v122, s[16:19], s50 offen offset:2048 lds
v_mfma_f32_16x16x32_bf16 v[152:155], v[36:39], v[232:235], v[152:155]
ds_read_b64_tr_b16 v[36:37], v115 offset:49152
s_waitcnt lgkmcnt(13)
v_mfma_f32_16x16x32_bf16 v[160:163], v[40:43], v[232:235], v[160:163]
ds_read_b64_tr_b16 v[38:39], v115 offset:53248
v_mfma_f32_16x16x32_bf16 v[164:167], v[40:43], v[236:239], v[164:167]
ds_read_b64_tr_b16 v[40:41], v116 offset:49152
buffer_load_dwordx4 v123, s[16:19], s50 offen offset:3072 lds
s_waitcnt lgkmcnt(13)
v_mfma_f32_16x16x32_bf16 v[172:175], v[44:47], v[236:239], v[172:175]
ds_read_b64_tr_b16 v[42:43], v116 offset:53248
s_add_u32 s54, s54, 131072
s_cmp_ge_u32 s54, s51
s_cselect_b32 s39, 458752, 0
s_add_u32 s50, s54, s39
v_mfma_f32_16x16x32_bf16 v[168:171], v[44:47], v[232:235], v[168:171]
ds_read_b64_tr_b16 v[44:45], v117 offset:49152
s_waitcnt lgkmcnt(13)
v_mfma_f32_16x16x32_bf16 v[176:179], v[48:51], v[232:235], v[176:179]
ds_read_b64_tr_b16 v[46:47], v117 offset:53248
buffer_load_dwordx4 v[224:227], v18, s[12:15], s53 offen offset:0
v_mfma_f32_16x16x32_bf16 v[180:183], v[48:51], v[236:239], v[180:183]
ds_read_b64_tr_b16 v[48:49], v118 offset:49152
s_waitcnt lgkmcnt(13)
v_mfma_f32_16x16x32_bf16 v[188:191], v[52:55], v[236:239], v[188:191]
ds_read_b64_tr_b16 v[50:51], v118 offset:53248
s_waitcnt vmcnt(43)
v_mov_b32 v126, 34
s_mov_b64 exec, s[60:61]
ds_write_b32 v125, v126
s_mov_b64 exec, -1
v_mfma_f32_16x16x32_bf16 v[184:187], v[52:55], v[232:235], v[184:187]
ds_read_b64_tr_b16 v[52:53], v119 offset:49152
ds_read_b64_tr_b16 v[54:55], v119 offset:53248
buffer_load_dwordx4 v[228:231], v18, s[12:15], s53 offen offset:1024
s_waitcnt lgkmcnt(15)
v_mfma_f32_16x16x32_bf16 v[128:131], v[24:27], v[240:243], v[128:131]
s_add_u32 s53, s53, 2048
s_cmp_eq_u32 s53, s55
s_cselect_b32 s36, 14336, 0
s_add_u32 s53, s53, s36
v_mfma_f32_16x16x32_bf16 v[132:135], v[24:27], v[244:247], v[132:135]
ds_read_b64_tr_b16 v[24:25], v112 offset:57344
s_waitcnt lgkmcnt(14)
v_mfma_f32_16x16x32_bf16 v[140:143], v[28:31], v[244:247], v[140:143]
ds_read_b64_tr_b16 v[26:27], v112 offset:61440
buffer_load_dwordx4 v[232:235], v18, s[12:15], s53 offen offset:0
v_mfma_f32_16x16x32_bf16 v[136:139], v[28:31], v[240:243], v[136:139]
ds_read_b64_tr_b16 v[28:29], v113 offset:57344
s_waitcnt lgkmcnt(14)
v_mfma_f32_16x16x32_bf16 v[144:147], v[32:35], v[240:243], v[144:147]
ds_read_b64_tr_b16 v[30:31], v113 offset:61440
v_mfma_f32_16x16x32_bf16 v[148:151], v[32:35], v[244:247], v[148:151]
ds_read_b64_tr_b16 v[32:33], v114 offset:57344
buffer_load_dwordx4 v[236:239], v18, s[12:15], s53 offen offset:1024
s_waitcnt lgkmcnt(14)
v_mfma_f32_16x16x32_bf16 v[156:159], v[36:39], v[244:247], v[156:159]
ds_read_b64_tr_b16 v[34:35], v114 offset:61440
s_add_u32 s53, s53, 2048
v_mfma_f32_16x16x32_bf16 v[152:155], v[36:39], v[240:243], v[152:155]
ds_read_b64_tr_b16 v[36:37], v115 offset:57344
s_waitcnt lgkmcnt(14)
v_mfma_f32_16x16x32_bf16 v[160:163], v[40:43], v[240:243], v[160:163]
ds_read_b64_tr_b16 v[38:39], v115 offset:61440
v_mfma_f32_16x16x32_bf16 v[164:167], v[40:43], v[244:247], v[164:167]
ds_read_b64_tr_b16 v[40:41], v116 offset:57344
ds_read_b32 v127, v125
s_waitcnt lgkmcnt(15)
v_mfma_f32_16x16x32_bf16 v[172:175], v[44:47], v[244:247], v[172:175]
ds_read_b64_tr_b16 v[42:43], v116 offset:61440
v_mfma_f32_16x16x32_bf16 v[168:171], v[44:47], v[240:243], v[168:171]
ds_read_b64_tr_b16 v[44:45], v117 offset:57344
s_waitcnt lgkmcnt(15)
v_mfma_f32_16x16x32_bf16 v[176:179], v[48:51], v[240:243], v[176:179]
ds_read_b64_tr_b16 v[46:47], v117 offset:61440
v_mfma_f32_16x16x32_bf16 v[180:183], v[48:51], v[244:247], v[180:183]
ds_read_b64_tr_b16 v[48:49], v118 offset:57344
s_waitcnt lgkmcnt(14)
v_mfma_f32_16x16x32_bf16 v[188:191], v[52:55], v[244:247], v[188:191]
ds_read_b64_tr_b16 v[50:51], v118 offset:61440
s_waitcnt lgkmcnt(5)
v_cmp_gt_u32 vcc, 34, v127
v_mfma_f32_16x16x32_bf16 v[184:187], v[52:55], v[240:243], v[184:187]
ds_read_b64_tr_b16 v[52:53], v119 offset:57344
ds_read_b64_tr_b16 v[54:55], v119 offset:61440
s_add_u32 m0, s52, 114688
s_cbranch_vccnz LC_s34
LC_b34:
v_mfma_f32_16x16x32_bf16 v[128:131], v[24:27], v[248:251], v[128:131]
buffer_load_dwordx4 v120, s[16:19], s50 offen offset:0 lds
v_mfma_f32_16x16x32_bf16 v[132:135], v[24:27], v[252:255], v[132:135]
ds_read_b64_tr_b16 v[24:25], v112 offset:32768
v_mfma_f32_16x16x32_bf16 v[140:143], v[28:31], v[252:255], v[140:143]
ds_read_b64_tr_b16 v[26:27], v112 offset:36864
v_mfma_f32_16x16x32_bf16 v[136:139], v[28:31], v[248:251], v[136:139]
ds_read_b64_tr_b16 v[28:29], v113 offset:32768
buffer_load_dwordx4 v121, s[16:19], s50 offen offset:1024 lds
v_mfma_f32_16x16x32_bf16 v[144:147], v[32:35], v[248:251], v[144:147]
ds_read_b64_tr_b16 v[30:31], v113 offset:36864
v_mfma_f32_16x16x32_bf16 v[148:151], v[32:35], v[252:255], v[148:151]
ds_read_b64_tr_b16 v[32:33], v114 offset:32768
v_mfma_f32_16x16x32_bf16 v[156:159], v[36:39], v[252:255], v[156:159]
ds_read_b64_tr_b16 v[34:35], v114 offset:36864
buffer_load_dwordx4 v122, s[16:19], s50 offen offset:2048 lds
v_mfma_f32_16x16x32_bf16 v[152:155], v[36:39], v[248:251], v[152:155]
ds_read_b64_tr_b16 v[36:37], v115 offset:32768
s_waitcnt lgkmcnt(13)
v_mfma_f32_16x16x32_bf16 v[160:163], v[40:43], v[248:251], v[160:163]
ds_read_b64_tr_b16 v[38:39], v115 offset:36864
v_mfma_f32_16x16x32_bf16 v[164:167], v[40:43], v[252:255], v[164:167]
ds_read_b64_tr_b16 v[40:41], v116 offset:32768
buffer_load_dwordx4 v123, s[16:19], s50 offen offset:3072 lds
s_waitcnt lgkmcnt(13)
v_mfma_f32_16x16x32_bf16 v[172:175], v[44:47], v[252:255], v[172:175]
ds_read_b64_tr_b16 v[42:43], v116 offset:36864
s_add_u32 s54, s54, 131072
s_cmp_ge_u32 s54, s51
s_cselect_b32 s39, 458752, 0
s_add_u32 s50, s54, s39
v_mfma_f32_16x16x32_bf16 v[168:171], v[44:47], v[248:251], v[168:171]
ds_read_b64_tr_b16 v[44:45], v117 offset:32768
s_waitcnt lgkmcnt(13)
v_mfma_f32_16x16x32_bf16 v[176:179], v[48:51], v[248:251], v[176:179]
ds_read_b64_tr_b16 v[46:47], v117 offset:36864
buffer_load_dwordx4 v[240:243], v18, s[12:15], s53 offen offset:0
v_mfma_f32_16x16x32_bf16 v[180:183], v[48:51], v[252:255], v[180:183]
ds_read_b64_tr_b16 v[48:49], v118 offset:32768
s_waitcnt lgkmcnt(13)
v_mfma_f32_16x16x32_bf16 v[188:191], v[52:55], v[252:255], v[188:191]
ds_read_b64_tr_b16 v[50:51], v118 offset:36864
s_waitcnt vmcnt(41)
v_mov_b32 v126, 36
s_mov_b64 exec, s[60:61]
ds_write_b32 v125, v126
s_mov_b64 exec, -1
v_mfma_f32_16x16x32_bf16 v[184:187], v[52:55], v[248:251], v[184:187]
ds_read_b64_tr_b16 v[52:53], v119 offset:32768
ds_read_b64_tr_b16 v[54:55], v119 offset:36864
buffer_load_dwordx4 v[244:247], v18, s[12:15], s53 offen offset:1024
s_waitcnt lgkmcnt(15)
v_mfma_f32_16x16x32_bf16 v[128:131], v[24:27], v[56:59], v[128:131]
s_add_u32 s53, s53, 2048
v_mfma_f32_16x16x32_bf16 v[132:135], v[24:27], v[60:63], v[132:135]
ds_read_b64_tr_b16 v[24:25], v112 offset:40960
s_waitcnt lgkmcnt(14)
v_mfma_f32_16x16x32_bf16 v[140:143], v[28:31], v[60:63], v[140:143]
ds_read_b64_tr_b16 v[26:27], v112 offset:45056
buffer_load_dwordx4 v[248:251], v18, s[12:15], s53 offen offset:0
v_mfma_f32_16x16x32_bf16 v[136:139], v[28:31], v[56:59], v[136:139]
ds_read_b64_tr_b16 v[28:29], v113 offset:40960
s_waitcnt lgkmcnt(14)
v_mfma_f32_16x16x32_bf16 v[144:147], v[32:35], v[56:59], v[144:147]
ds_read_b64_tr_b16 v[30:31], v113 offset:45056
v_mfma_f32_16x16x32_bf16 v[148:151], v[32:35], v[60:63], v[148:151]
ds_read_b64_tr_b16 v[32:33], v114 offset:40960
buffer_load_dwordx4 v[252:255], v18, s[12:15], s53 offen offset:1024
s_waitcnt lgkmcnt(14)
v_mfma_f32_16x16x32_bf16 v[156:159], v[36:39], v[60:63], v[156:159]
ds_read_b64_tr_b16 v[34:35], v114 offset:45056
s_add_u32 s53, s53, 2048
v_mfma_f32_16x16x32_bf16 v[152:155], v[36:39], v[56:59], v[152:155]
ds_read_b64_tr_b16 v[36:37], v115 offset:40960
s_waitcnt lgkmcnt(14)
v_mfma_f32_16x16x32_bf16 v[160:163], v[40:43], v[56:59], v[160:163]
ds_read_b64_tr_b16 v[38:39], v115 offset:45056
v_mfma_f32_16x16x32_bf16 v[164:167], v[40:43], v[60:63], v[164:167]
ds_read_b64_tr_b16 v[40:41], v116 offset:40960
ds_read_b32 v127, v125
s_waitcnt lgkmcnt(15)
v_mfma_f32_16x16x32_bf16 v[172:175], v[44:47], v[60:63], v[172:175]
ds_read_b64_tr_b16 v[42:43], v116 offset:45056
v_mfma_f32_16x16x32_bf16 v[168:171], v[44:47], v[56:59], v[168:171]
ds_read_b64_tr_b16 v[44:45], v117 offset:40960
s_waitcnt lgkmcnt(15)
v_mfma_f32_16x16x32_bf16 v[176:179], v[48:51], v[56:59], v[176:179]
ds_read_b64_tr_b16 v[46:47], v117 offset:45056
v_mfma_f32_16x16x32_bf16 v[180:183], v[48:51], v[60:63], v[180:183]
ds_read_b64_tr_b16 v[48:49], v118 offset:40960
s_waitcnt lgkmcnt(14)
v_mfma_f32_16x16x32_bf16 v[188:191], v[52:55], v[60:63], v[188:191]
ds_read_b64_tr_b16 v[50:51], v118 offset:45056
s_waitcnt lgkmcnt(5)
v_cmp_gt_u32 vcc, 36, v127
v_mfma_f32_16x16x32_bf16 v[184:187], v[52:55], v[56:59], v[184:187]
ds_read_b64_tr_b16 v[52:53], v119 offset:40960
ds_read_b64_tr_b16 v[54:55], v119 offset:45056
s_add_u32 m0, s52, 147456
s_cbranch_vccnz LC_s36
LC_b36:
v_mfma_f32_16x16x32_bf16 v[128:131], v[24:27], v[64:67], v[128:131]
buffer_load_dwordx4 v120, s[16:19], s50 offen offset:0 lds
v_mfma_f32_16x16x32_bf16 v[132:135], v[24:27], v[68:71], v[132:135]
ds_read_b64_tr_b16 v[24:25], v104 offset:0
v_mfma_f32_16x16x32_bf16 v[140:143], v[28:31], v[68:71], v[140:143]
ds_read_b64_tr_b16 v[26:27], v104 offset:4096
v_mfma_f32_16x16x32_bf16 v[136:139], v[28:31], v[64:67], v[136:139]
ds_read_b64_tr_b16 v[28:29], v105 offset:0
buffer_load_dwordx4 v121, s[16:19], s50 offen offset:1024 lds
v_mfma_f32_16x16x32_bf16 v[144:147], v[32:35], v[64:67], v[144:147]
ds_read_b64_tr_b16 v[30:31], v105 offset:4096
v_mfma_f32_16x16x32_bf16 v[148:151], v[32:35], v[68:71], v[148:151]
ds_read_b64_tr_b16 v[32:33], v106 offset:0
v_mfma_f32_16x16x32_bf16 v[156:159], v[36:39], v[68:71], v[156:159]
ds_read_b64_tr_b16 v[34:35], v106 offset:4096
buffer_load_dwordx4 v122, s[16:19], s50 offen offset:2048 lds
v_mfma_f32_16x16x32_bf16 v[152:155], v[36:39], v[64:67], v[152:155]
ds_read_b64_tr_b16 v[36:37], v107 offset:0
s_waitcnt lgkmcnt(13)
v_mfma_f32_16x16x32_bf16 v[160:163], v[40:43], v[64:67], v[160:163]
ds_read_b64_tr_b16 v[38:39], v107 offset:4096
v_mfma_f32_16x16x32_bf16 v[164:167], v[40:43], v[68:71], v[164:167]
ds_read_b64_tr_b16 v[40:41], v108 offset:0
buffer_load_dwordx4 v123, s[16:19], s50 offen offset:3072 lds
s_waitcnt lgkmcnt(13)
v_mfma_f32_16x16x32_bf16 v[172:175], v[44:47], v[68:71], v[172:175]
ds_read_b64_tr_b16 v[42:43], v108 offset:4096
s_add_u32 s54, s54, 131072
s_cmp_ge_u32 s54, s51
s_cselect_b32 s39, 458752, 0
s_add_u32 s50, s54, s39
v_mfma_f32_16x16x32_bf16 v[168:171], v[44:47], v[64:67], v[168:171]
ds_read_b64_tr_b16 v[44:45], v109 offset:0
s_waitcnt lgkmcnt(13)
v_mfma_f32_16x16x32_bf16 v[176:179], v[48:51], v[64:67], v[176:179]
ds_read_b64_tr_b16 v[46:47], v109 offset:4096
buffer_load_dwordx4 v[56:59], v18, s[12:15], s53 offen offset:0
v_mfma_f32_16x16x32_bf16 v[180:183], v[48:51], v[68:71], v[180:183]
ds_read_b64_tr_b16 v[48:49], v110 offset:0
s_waitcnt lgkmcnt(13)
v_mfma_f32_16x16x32_bf16 v[188:191], v[52:55], v[68:71], v[188:191]
ds_read_b64_tr_b16 v[50:51], v110 offset:4096
s_waitcnt vmcnt(41)
v_mov_b32 v126, 38
s_mov_b64 exec, s[60:61]
ds_write_b32 v125, v126
s_mov_b64 exec, -1
v_mfma_f32_16x16x32_bf16 v[184:187], v[52:55], v[64:67], v[184:187]
ds_read_b64_tr_b16 v[52:53], v111 offset:0
ds_read_b64_tr_b16 v[54:55], v111 offset:4096
buffer_load_dwordx4 v[60:63], v18, s[12:15], s53 offen offset:1024
s_waitcnt lgkmcnt(15)
v_mfma_f32_16x16x32_bf16 v[128:131], v[24:27], v[72:75], v[128:131]
s_add_u32 s53, s53, 2048
v_mfma_f32_16x16x32_bf16 v[132:135], v[24:27], v[76:79], v[132:135]
ds_read_b64_tr_b16 v[24:25], v104 offset:8192
s_waitcnt lgkmcnt(14)
v_mfma_f32_16x16x32_bf16 v[140:143], v[28:31], v[76:79], v[140:143]
ds_read_b64_tr_b16 v[26:27], v104 offset:12288
buffer_load_dwordx4 v[64:67], v18, s[12:15], s53 offen offset:0
v_mfma_f32_16x16x32_bf16 v[136:139], v[28:31], v[72:75], v[136:139]
ds_read_b64_tr_b16 v[28:29], v105 offset:8192
s_waitcnt lgkmcnt(14)
v_mfma_f32_16x16x32_bf16 v[144:147], v[32:35], v[72:75], v[144:147]
ds_read_b64_tr_b16 v[30:31], v105 offset:12288
v_mfma_f32_16x16x32_bf16 v[148:151], v[32:35], v[76:79], v[148:151]
ds_read_b64_tr_b16 v[32:33], v106 offset:8192
buffer_load_dwordx4 v[68:71], v18, s[12:15], s53 offen offset:1024
s_waitcnt lgkmcnt(14)
v_mfma_f32_16x16x32_bf16 v[156:159], v[36:39], v[76:79], v[156:159]
ds_read_b64_tr_b16 v[34:35], v106 offset:12288
s_add_u32 s53, s53, 2048
v_mfma_f32_16x16x32_bf16 v[152:155], v[36:39], v[72:75], v[152:155]
ds_read_b64_tr_b16 v[36:37], v107 offset:8192
s_waitcnt lgkmcnt(14)
v_mfma_f32_16x16x32_bf16 v[160:163], v[40:43], v[72:75], v[160:163]
ds_read_b64_tr_b16 v[38:39], v107 offset:12288
v_mfma_f32_16x16x32_bf16 v[164:167], v[40:43], v[76:79], v[164:167]
ds_read_b64_tr_b16 v[40:41], v108 offset:8192
ds_read_b32 v127, v125
s_waitcnt lgkmcnt(15)
v_mfma_f32_16x16x32_bf16 v[172:175], v[44:47], v[76:79], v[172:175]
ds_read_b64_tr_b16 v[42:43], v108 offset:12288
v_mfma_f32_16x16x32_bf16 v[168:171], v[44:47], v[72:75], v[168:171]
ds_read_b64_tr_b16 v[44:45], v109 offset:8192
s_waitcnt lgkmcnt(15)
v_mfma_f32_16x16x32_bf16 v[176:179], v[48:51], v[72:75], v[176:179]
ds_read_b64_tr_b16 v[46:47], v109 offset:12288
v_mfma_f32_16x16x32_bf16 v[180:183], v[48:51], v[76:79], v[180:183]
ds_read_b64_tr_b16 v[48:49], v110 offset:8192
s_waitcnt lgkmcnt(14)
v_mfma_f32_16x16x32_bf16 v[188:191], v[52:55], v[76:79], v[188:191]
ds_read_b64_tr_b16 v[50:51], v110 offset:12288
s_waitcnt lgkmcnt(5)
v_cmp_gt_u32 vcc, 38, v127
v_mfma_f32_16x16x32_bf16 v[184:187], v[52:55], v[72:75], v[184:187]
ds_read_b64_tr_b16 v[52:53], v111 offset:8192
ds_read_b64_tr_b16 v[54:55], v111 offset:12288
s_add_u32 m0, s52, 131072
s_cbranch_vccnz LC_s38
LC_b38:
v_mfma_f32_16x16x32_bf16 v[128:131], v[24:27], v[80:83], v[128:131]
buffer_load_dwordx4 v120, s[16:19], s50 offen offset:0 lds
v_mfma_f32_16x16x32_bf16 v[132:135], v[24:27], v[84:87], v[132:135]
ds_read_b64_tr_b16 v[24:25], v104 offset:16384
v_mfma_f32_16x16x32_bf16 v[140:143], v[28:31], v[84:87], v[140:143]
ds_read_b64_tr_b16 v[26:27], v104 offset:20480
v_mfma_f32_16x16x32_bf16 v[136:139], v[28:31], v[80:83], v[136:139]
ds_read_b64_tr_b16 v[28:29], v105 offset:16384
buffer_load_dwordx4 v121, s[16:19], s50 offen offset:1024 lds
v_mfma_f32_16x16x32_bf16 v[144:147], v[32:35], v[80:83], v[144:147]
ds_read_b64_tr_b16 v[30:31], v105 offset:20480
v_mfma_f32_16x16x32_bf16 v[148:151], v[32:35], v[84:87], v[148:151]
ds_read_b64_tr_b16 v[32:33], v106 offset:16384
v_mfma_f32_16x16x32_bf16 v[156:159], v[36:39], v[84:87], v[156:159]
ds_read_b64_tr_b16 v[34:35], v106 offset:20480
buffer_load_dwordx4 v122, s[16:19], s50 offen offset:2048 lds
v_mfma_f32_16x16x32_bf16 v[152:155], v[36:39], v[80:83], v[152:155]
ds_read_b64_tr_b16 v[36:37], v107 offset:16384
s_waitcnt lgkmcnt(13)
v_mfma_f32_16x16x32_bf16 v[160:163], v[40:43], v[80:83], v[160:163]
ds_read_b64_tr_b16 v[38:39], v107 offset:20480
v_mfma_f32_16x16x32_bf16 v[164:167], v[40:43], v[84:87], v[164:167]
ds_read_b64_tr_b16 v[40:41], v108 offset:16384
buffer_load_dwordx4 v123, s[16:19], s50 offen offset:3072 lds
s_waitcnt lgkmcnt(13)
v_mfma_f32_16x16x32_bf16 v[172:175], v[44:47], v[84:87], v[172:175]
ds_read_b64_tr_b16 v[42:43], v108 offset:20480
s_add_u32 s54, s54, 131072
s_cmp_ge_u32 s54, s51
s_cselect_b32 s39, 458752, 0
s_add_u32 s50, s54, s39
v_mfma_f32_16x16x32_bf16 v[168:171], v[44:47], v[80:83], v[168:171]
ds_read_b64_tr_b16 v[44:45], v109 offset:16384
s_waitcnt lgkmcnt(13)
v_mfma_f32_16x16x32_bf16 v[176:179], v[48:51], v[80:83], v[176:179]
ds_read_b64_tr_b16 v[46:47], v109 offset:20480
buffer_load_dwordx4 v[72:75], v18, s[12:15], s53 offen offset:0
v_mfma_f32_16x16x32_bf16 v[180:183], v[48:51], v[84:87], v[180:183]
ds_read_b64_tr_b16 v[48:49], v110 offset:16384
s_waitcnt lgkmcnt(13)
v_mfma_f32_16x16x32_bf16 v[188:191], v[52:55], v[84:87], v[188:191]
ds_read_b64_tr_b16 v[50:51], v110 offset:20480
s_waitcnt vmcnt(41)
v_mov_b32 v126, 40
s_mov_b64 exec, s[60:61]
ds_write_b32 v125, v126
s_mov_b64 exec, -1
v_mfma_f32_16x16x32_bf16 v[184:187], v[52:55], v[80:83], v[184:187]
ds_read_b64_tr_b16 v[52:53], v111 offset:16384
ds_read_b64_tr_b16 v[54:55], v111 offset:20480
buffer_load_dwordx4 v[76:79], v18, s[12:15], s53 offen offset:1024
s_waitcnt lgkmcnt(15)
v_mfma_f32_16x16x32_bf16 v[128:131], v[24:27], v[88:91], v[128:131]
s_add_u32 s53, s53, 2048
v_mfma_f32_16x16x32_bf16 v[132:135], v[24:27], v[92:95], v[132:135]
ds_read_b64_tr_b16 v[24:25], v104 offset:24576
s_waitcnt lgkmcnt(14)
v_mfma_f32_16x16x32_bf16 v[140:143], v[28:31], v[92:95], v[140:143]
ds_read_b64_tr_b16 v[26:27], v104 offset:28672
buffer_load_dwordx4 v[80:83], v18, s[12:15], s53 offen offset:0
v_mfma_f32_16x16x32_bf16 v[136:139], v[28:31], v[88:91], v[136:139]
ds_read_b64_tr_b16 v[28:29], v105 offset:24576
s_waitcnt lgkmcnt(14)
v_mfma_f32_16x16x32_bf16 v[144:147], v[32:35], v[88:91], v[144:147]
ds_read_b64_tr_b16 v[30:31], v105 offset:28672
v_mfma_f32_16x16x32_bf16 v[148:151], v[32:35], v[92:95], v[148:151]
ds_read_b64_tr_b16 v[32:33], v106 offset:24576
buffer_load_dwordx4 v[84:87], v18, s[12:15], s53 offen offset:1024
s_waitcnt lgkmcnt(14)
v_mfma_f32_16x16x32_bf16 v[156:159], v[36:39], v[92:95], v[156:159]
ds_read_b64_tr_b16 v[34:35], v106 offset:28672
s_add_u32 s53, s53, 2048
s_cmp_eq_u32 s53, s55
s_cselect_b32 s36, 14336, 0
s_add_u32 s53, s53, s36
v_mfma_f32_16x16x32_bf16 v[152:155], v[36:39], v[88:91], v[152:155]
ds_read_b64_tr_b16 v[36:37], v107 offset:24576
s_waitcnt lgkmcnt(14)
v_mfma_f32_16x16x32_bf16 v[160:163], v[40:43], v[88:91], v[160:163]
ds_read_b64_tr_b16 v[38:39], v107 offset:28672
v_mfma_f32_16x16x32_bf16 v[164:167], v[40:43], v[92:95], v[164:167]
ds_read_b64_tr_b16 v[40:41], v108 offset:24576
ds_read_b32 v127, v125
s_waitcnt lgkmcnt(15)
v_mfma_f32_16x16x32_bf16 v[172:175], v[44:47], v[92:95], v[172:175]
ds_read_b64_tr_b16 v[42:43], v108 offset:28672
v_mfma_f32_16x16x32_bf16 v[168:171], v[44:47], v[88:91], v[168:171]
ds_read_b64_tr_b16 v[44:45], v109 offset:24576
s_waitcnt lgkmcnt(15)
v_mfma_f32_16x16x32_bf16 v[176:179], v[48:51], v[88:91], v[176:179]
ds_read_b64_tr_b16 v[46:47], v109 offset:28672
v_mfma_f32_16x16x32_bf16 v[180:183], v[48:51], v[92:95], v[180:183]
ds_read_b64_tr_b16 v[48:49], v110 offset:24576
s_waitcnt lgkmcnt(14)
v_mfma_f32_16x16x32_bf16 v[188:191], v[52:55], v[92:95], v[188:191]
ds_read_b64_tr_b16 v[50:51], v110 offset:28672
s_waitcnt lgkmcnt(5)
v_cmp_gt_u32 vcc, 40, v127
v_mfma_f32_16x16x32_bf16 v[184:187], v[52:55], v[88:91], v[184:187]
ds_read_b64_tr_b16 v[52:53], v111 offset:24576
ds_read_b64_tr_b16 v[54:55], v111 offset:28672
s_add_u32 m0, s52, 0
s_cbranch_vccnz LC_s40
LC_b40:
v_mfma_f32_16x16x32_bf16 v[128:131], v[24:27], v[96:99], v[128:131]
buffer_load_dwordx4 v120, s[16:19], s50 offen offset:0 lds
v_mfma_f32_16x16x32_bf16 v[132:135], v[24:27], v[100:103], v[132:135]
ds_read_b64_tr_b16 v[24:25], v112 offset:0
v_mfma_f32_16x16x32_bf16 v[140:143], v[28:31], v[100:103], v[140:143]
ds_read_b64_tr_b16 v[26:27], v112 offset:4096
v_mfma_f32_16x16x32_bf16 v[136:139], v[28:31], v[96:99], v[136:139]
ds_read_b64_tr_b16 v[28:29], v113 offset:0
buffer_load_dwordx4 v121, s[16:19], s50 offen offset:1024 lds
v_mfma_f32_16x16x32_bf16 v[144:147], v[32:35], v[96:99], v[144:147]
ds_read_b64_tr_b16 v[30:31], v113 offset:4096
v_mfma_f32_16x16x32_bf16 v[148:151], v[32:35], v[100:103], v[148:151]
ds_read_b64_tr_b16 v[32:33], v114 offset:0
v_mfma_f32_16x16x32_bf16 v[156:159], v[36:39], v[100:103], v[156:159]
ds_read_b64_tr_b16 v[34:35], v114 offset:4096
buffer_load_dwordx4 v122, s[16:19], s50 offen offset:2048 lds
v_mfma_f32_16x16x32_bf16 v[152:155], v[36:39], v[96:99], v[152:155]
ds_read_b64_tr_b16 v[36:37], v115 offset:0
s_waitcnt lgkmcnt(13)
v_mfma_f32_16x16x32_bf16 v[160:163], v[40:43], v[96:99], v[160:163]
ds_read_b64_tr_b16 v[38:39], v115 offset:4096
v_mfma_f32_16x16x32_bf16 v[164:167], v[40:43], v[100:103], v[164:167]
ds_read_b64_tr_b16 v[40:41], v116 offset:0
buffer_load_dwordx4 v123, s[16:19], s50 offen offset:3072 lds
s_waitcnt lgkmcnt(13)
v_mfma_f32_16x16x32_bf16 v[172:175], v[44:47], v[100:103], v[172:175]
ds_read_b64_tr_b16 v[42:43], v116 offset:4096
s_add_u32 s54, s54, 131072
s_cmp_ge_u32 s54, s51
s_cselect_b32 s39, 458752, 0
s_add_u32 s50, s54, s39
v_mfma_f32_16x16x32_bf16 v[168:171], v[44:47], v[96:99], v[168:171]
ds_read_b64_tr_b16 v[44:45], v117 offset:0
s_waitcnt lgkmcnt(13)
v_mfma_f32_16x16x32_bf16 v[176:179], v[48:51], v[96:99], v[176:179]
ds_read_b64_tr_b16 v[46:47], v117 offset:4096
v_mfma_f32_16x16x32_bf16 v[180:183], v[48:51], v[100:103], v[180:183]
ds_read_b64_tr_b16 v[48:49], v118 offset:0
s_waitcnt lgkmcnt(13)
v_mfma_f32_16x16x32_bf16 v[188:191], v[52:55], v[100:103], v[188:191]
ds_read_b64_tr_b16 v[50:51], v118 offset:4096
s_waitcnt vmcnt(40)
v_mov_b32 v126, 42
s_mov_b64 exec, s[60:61]
ds_write_b32 v125, v126
s_mov_b64 exec, -1
v_mfma_f32_16x16x32_bf16 v[184:187], v[52:55], v[96:99], v[184:187]
ds_read_b64_tr_b16 v[52:53], v119 offset:0
ds_read_b64_tr_b16 v[54:55], v119 offset:4096
s_waitcnt lgkmcnt(15)
v_mfma_f32_16x16x32_bf16 v[128:131], v[24:27], v[2:5], v[128:131]
v_mfma_f32_16x16x32_bf16 v[132:135], v[24:27], v[6:9], v[132:135]
ds_read_b64_tr_b16 v[24:25], v112 offset:8192
s_waitcnt lgkmcnt(14)
v_mfma_f32_16x16x32_bf16 v[140:143], v[28:31], v[6:9], v[140:143]
ds_read_b64_tr_b16 v[26:27], v112 offset:12288
v_mfma_f32_16x16x32_bf16 v[136:139], v[28:31], v[2:5], v[136:139]
ds_read_b64_tr_b16 v[28:29], v113 offset:8192
s_waitcnt lgkmcnt(14)
v_mfma_f32_16x16x32_bf16 v[144:147], v[32:35], v[2:5], v[144:147]
ds_read_b64_tr_b16 v[30:31], v113 offset:12288
v_mfma_f32_16x16x32_bf16 v[148:151], v[32:35], v[6:9], v[148:151]
ds_read_b64_tr_b16 v[32:33], v114 offset:8192
s_waitcnt lgkmcnt(14)
v_mfma_f32_16x16x32_bf16 v[156:159], v[36:39], v[6:9], v[156:159]
ds_read_b64_tr_b16 v[34:35], v114 offset:12288
v_mfma_f32_16x16x32_bf16 v[152:155], v[36:39], v[2:5], v[152:155]
ds_read_b64_tr_b16 v[36:37], v115 offset:8192
s_waitcnt lgkmcnt(14)
v_mfma_f32_16x16x32_bf16 v[160:163], v[40:43], v[2:5], v[160:163]
ds_read_b64_tr_b16 v[38:39], v115 offset:12288
v_mfma_f32_16x16x32_bf16 v[164:167], v[40:43], v[6:9], v[164:167]
ds_read_b64_tr_b16 v[40:41], v116 offset:8192
ds_read_b32 v127, v125
s_waitcnt lgkmcnt(15)
v_mfma_f32_16x16x32_bf16 v[172:175], v[44:47], v[6:9], v[172:175]
ds_read_b64_tr_b16 v[42:43], v116 offset:12288
v_mfma_f32_16x16x32_bf16 v[168:171], v[44:47], v[2:5], v[168:171]
ds_read_b64_tr_b16 v[44:45], v117 offset:8192
s_waitcnt lgkmcnt(15)
v_mfma_f32_16x16x32_bf16 v[176:179], v[48:51], v[2:5], v[176:179]
ds_read_b64_tr_b16 v[46:47], v117 offset:12288
v_mfma_f32_16x16x32_bf16 v[180:183], v[48:51], v[6:9], v[180:183]
ds_read_b64_tr_b16 v[48:49], v118 offset:8192
s_waitcnt lgkmcnt(14)
v_mfma_f32_16x16x32_bf16 v[188:191], v[52:55], v[6:9], v[188:191]
ds_read_b64_tr_b16 v[50:51], v118 offset:12288
s_waitcnt vmcnt(32)
v_mov_b32 v126, 43
s_mov_b64 exec, s[60:61]
ds_write_b32 v125, v126
s_mov_b64 exec, -1
s_waitcnt lgkmcnt(6)
v_cmp_gt_u32 vcc, 42, v127
v_mfma_f32_16x16x32_bf16 v[184:187], v[52:55], v[2:5], v[184:187]
ds_read_b64_tr_b16 v[52:53], v119 offset:8192
ds_read_b64_tr_b16 v[54:55], v119 offset:12288
s_cbranch_vccnz LC_s42
LC_b42:
v_mfma_f32_16x16x32_bf16 v[128:131], v[24:27], v[10:13], v[128:131]
v_mfma_f32_16x16x32_bf16 v[132:135], v[24:27], v[14:17], v[132:135]
ds_read_b64_tr_b16 v[24:25], v108 offset:32768
v_mfma_f32_16x16x32_bf16 v[140:143], v[28:31], v[14:17], v[140:143]
ds_read_b64_tr_b16 v[26:27], v108 offset:36864
v_mfma_f32_16x16x32_bf16 v[136:139], v[28:31], v[10:13], v[136:139]
ds_read_b64_tr_b16 v[28:29], v109 offset:32768
v_mfma_f32_16x16x32_bf16 v[144:147], v[32:35], v[10:13], v[144:147]
ds_read_b64_tr_b16 v[30:31], v109 offset:36864
v_mfma_f32_16x16x32_bf16 v[148:151], v[32:35], v[14:17], v[148:151]
ds_read_b64_tr_b16 v[32:33], v110 offset:32768
v_mfma_f32_16x16x32_bf16 v[156:159], v[36:39], v[14:17], v[156:159]
ds_read_b64_tr_b16 v[34:35], v110 offset:36864
v_mfma_f32_16x16x32_bf16 v[152:155], v[36:39], v[10:13], v[152:155]
ds_read_b64_tr_b16 v[36:37], v111 offset:32768
s_waitcnt lgkmcnt(14)
v_mfma_f32_16x16x32_bf16 v[160:163], v[40:43], v[10:13], v[160:163]
ds_read_b64_tr_b16 v[38:39], v111 offset:36864
v_mfma_f32_16x16x32_bf16 v[164:167], v[40:43], v[14:17], v[164:167]
ds_read_b64_tr_b16 v[40:41], v108 offset:40960
ds_read_b32 v127, v125
s_waitcnt lgkmcnt(15)
v_mfma_f32_16x16x32_bf16 v[172:175], v[44:47], v[14:17], v[172:175]
ds_read_b64_tr_b16 v[42:43], v108 offset:45056
v_mfma_f32_16x16x32_bf16 v[168:171], v[44:47], v[10:13], v[168:171]
ds_read_b64_tr_b16 v[44:45], v109 offset:40960
s_waitcnt lgkmcnt(15)
v_mfma_f32_16x16x32_bf16 v[176:179], v[48:51], v[10:13], v[176:179]
ds_read_b64_tr_b16 v[46:47], v109 offset:45056
v_mfma_f32_16x16x32_bf16 v[180:183], v[48:51], v[14:17], v[180:183]
ds_read_b64_tr_b16 v[48:49], v110 offset:40960
s_waitcnt lgkmcnt(14)
v_mfma_f32_16x16x32_bf16 v[188:191], v[52:55], v[14:17], v[188:191]
ds_read_b64_tr_b16 v[50:51], v110 offset:45056
s_waitcnt vmcnt(24)
v_mov_b32 v126, 44
s_mov_b64 exec, s[60:61]
ds_write_b32 v125, v126
s_mov_b64 exec, -1
s_waitcnt lgkmcnt(6)
v_cmp_gt_u32 vcc, 43, v127
v_mfma_f32_16x16x32_bf16 v[184:187], v[52:55], v[10:13], v[184:187]
ds_read_b64_tr_b16 v[52:53], v111 offset:40960
ds_read_b64_tr_b16 v[54:55], v111 offset:45056
s_cbranch_vccnz LC_s43
LC_b43:
v_mfma_f32_16x16x32_bf16 v[160:163], v[24:27], v[192:195], v[160:163]
v_mfma_f32_16x16x32_bf16 v[164:167], v[24:27], v[196:199], v[164:167]
ds_read_b64_tr_b16 v[24:25], v108 offset:49152
v_mfma_f32_16x16x32_bf16 v[172:175], v[28:31], v[196:199], v[172:175]
ds_read_b64_tr_b16 v[26:27], v108 offset:53248
v_mfma_f32_16x16x32_bf16 v[168:171], v[28:31], v[192:195], v[168:171]
ds_read_b64_tr_b16 v[28:29], v109 offset:49152
v_mfma_f32_16x16x32_bf16 v[176:179], v[32:35], v[192:195], v[176:179]
ds_read_b64_tr_b16 v[30:31], v109 offset:53248
v_mfma_f32_16x16x32_bf16 v[180:183], v[32:35], v[196:199], v[180:183]
ds_read_b64_tr_b16 v[32:33], v110 offset:49152
v_mfma_f32_16x16x32_bf16 v[188:191], v[36:39], v[196:199], v[188:191]
ds_read_b64_tr_b16 v[34:35], v110 offset:53248
v_mfma_f32_16x16x32_bf16 v[184:187], v[36:39], v[192:195], v[184:187]
ds_read_b64_tr_b16 v[36:37], v111 offset:49152
s_waitcnt lgkmcnt(14)
v_mfma_f32_16x16x32_bf16 v[160:163], v[40:43], v[200:203], v[160:163]
ds_read_b64_tr_b16 v[38:39], v111 offset:53248
v_mfma_f32_16x16x32_bf16 v[164:167], v[40:43], v[204:207], v[164:167]
ds_read_b64_tr_b16 v[40:41], v108 offset:57344
ds_read_b32 v127, v125
s_waitcnt lgkmcnt(15)
v_mfma_f32_16x16x32_bf16 v[172:175], v[44:47], v[204:207], v[172:175]
ds_read_b64_tr_b16 v[42:43], v108 offset:61440
v_mfma_f32_16x16x32_bf16 v[168:171], v[44:47], v[200:203], v[168:171]
ds_read_b64_tr_b16 v[44:45], v109 offset:57344
s_waitcnt lgkmcnt(15)
v_mfma_f32_16x16x32_bf16 v[176:179], v[48:51], v[200:203], v[176:179]
ds_read_b64_tr_b16 v[46:47], v109 offset:61440
v_mfma_f32_16x16x32_bf16 v[180:183], v[48:51], v[204:207], v[180:183]
ds_read_b64_tr_b16 v[48:49], v110 offset:57344
s_waitcnt lgkmcnt(14)
v_mfma_f32_16x16x32_bf16 v[188:191], v[52:55], v[204:207], v[188:191]
ds_read_b64_tr_b16 v[50:51], v110 offset:61440
s_waitcnt vmcnt(16)
v_mov_b32 v126, 45
s_mov_b64 exec, s[60:61]
ds_write_b32 v125, v126
s_mov_b64 exec, -1
s_waitcnt lgkmcnt(6)
v_cmp_gt_u32 vcc, 44, v127
v_mfma_f32_16x16x32_bf16 v[184:187], v[52:55], v[200:203], v[184:187]
ds_read_b64_tr_b16 v[52:53], v111 offset:57344
ds_read_b64_tr_b16 v[54:55], v111 offset:61440
s_cbranch_vccnz LC_s44
LC_b44:
v_mfma_f32_16x16x32_bf16 v[160:163], v[24:27], v[208:211], v[160:163]
v_mfma_f32_16x16x32_bf16 v[164:167], v[24:27], v[212:215], v[164:167]
ds_read_b64_tr_b16 v[24:25], v116 offset:16384
v_mfma_f32_16x16x32_bf16 v[172:175], v[28:31], v[212:215], v[172:175]
ds_read_b64_tr_b16 v[26:27], v116 offset:20480
v_mfma_f32_16x16x32_bf16 v[168:171], v[28:31], v[208:211], v[168:171]
ds_read_b64_tr_b16 v[28:29], v117 offset:16384
v_mfma_f32_16x16x32_bf16 v[176:179], v[32:35], v[208:211], v[176:179]
ds_read_b64_tr_b16 v[30:31], v117 offset:20480
v_mfma_f32_16x16x32_bf16 v[180:183], v[32:35], v[212:215], v[180:183]
ds_read_b64_tr_b16 v[32:33], v118 offset:16384
v_mfma_f32_16x16x32_bf16 v[188:191], v[36:39], v[212:215], v[188:191]
ds_read_b64_tr_b16 v[34:35], v118 offset:20480
v_mfma_f32_16x16x32_bf16 v[184:187], v[36:39], v[208:211], v[184:187]
ds_read_b64_tr_b16 v[36:37], v119 offset:16384
s_waitcnt lgkmcnt(14)
v_mfma_f32_16x16x32_bf16 v[160:163], v[40:43], v[216:219], v[160:163]
ds_read_b64_tr_b16 v[38:39], v119 offset:20480
v_mfma_f32_16x16x32_bf16 v[164:167], v[40:43], v[220:223], v[164:167]
ds_read_b64_tr_b16 v[40:41], v116 offset:24576
ds_read_b32 v127, v125
s_waitcnt lgkmcnt(15)
v_mfma_f32_16x16x32_bf16 v[172:175], v[44:47], v[220:223], v[172:175]
ds_read_b64_tr_b16 v[42:43], v116 offset:28672
v_mfma_f32_16x16x32_bf16 v[168:171], v[44:47], v[216:219], v[168:171]
ds_read_b64_tr_b16 v[44:45], v117 offset:24576
s_waitcnt lgkmcnt(15)
v_mfma_f32_16x16x32_bf16 v[176:179], v[48:51], v[216:219], v[176:179]
ds_read_b64_tr_b16 v[46:47], v117 offset:28672
v_mfma_f32_16x16x32_bf16 v[180:183], v[48:51], v[220:223], v[180:183]
ds_read_b64_tr_b16 v[48:49], v118 offset:24576
s_waitcnt lgkmcnt(14)
v_mfma_f32_16x16x32_bf16 v[188:191], v[52:55], v[220:223], v[188:191]
ds_read_b64_tr_b16 v[50:51], v118 offset:28672
s_waitcnt vmcnt(8)
v_mov_b32 v126, 46
s_mov_b64 exec, s[60:61]
ds_write_b32 v125, v126
s_mov_b64 exec, -1
s_waitcnt lgkmcnt(6)
v_cmp_gt_u32 vcc, 45, v127
v_mfma_f32_16x16x32_bf16 v[184:187], v[52:55], v[216:219], v[184:187]
ds_read_b64_tr_b16 v[52:53], v119 offset:24576
ds_read_b64_tr_b16 v[54:55], v119 offset:28672
s_cbranch_vccnz LC_s45
LC_b45:
v_mfma_f32_16x16x32_bf16 v[160:163], v[24:27], v[224:227], v[160:163]
v_mfma_f32_16x16x32_bf16 v[164:167], v[24:27], v[228:231], v[164:167]
ds_read_b64_tr_b16 v[24:25], v116 offset:49152
v_mfma_f32_16x16x32_bf16 v[172:175], v[28:31], v[228:231], v[172:175]
ds_read_b64_tr_b16 v[26:27], v116 offset:53248
v_mfma_f32_16x16x32_bf16 v[168:171], v[28:31], v[224:227], v[168:171]
ds_read_b64_tr_b16 v[28:29], v117 offset:49152
v_mfma_f32_16x16x32_bf16 v[176:179], v[32:35], v[224:227], v[176:179]
ds_read_b64_tr_b16 v[30:31], v117 offset:53248
v_mfma_f32_16x16x32_bf16 v[180:183], v[32:35], v[228:231], v[180:183]
ds_read_b64_tr_b16 v[32:33], v118 offset:49152
v_mfma_f32_16x16x32_bf16 v[188:191], v[36:39], v[228:231], v[188:191]
ds_read_b64_tr_b16 v[34:35], v118 offset:53248
v_mfma_f32_16x16x32_bf16 v[184:187], v[36:39], v[224:227], v[184:187]
ds_read_b64_tr_b16 v[36:37], v119 offset:49152
s_waitcnt lgkmcnt(14)
v_mfma_f32_16x16x32_bf16 v[160:163], v[40:43], v[232:235], v[160:163]
ds_read_b64_tr_b16 v[38:39], v119 offset:53248
v_mfma_f32_16x16x32_bf16 v[164:167], v[40:43], v[236:239], v[164:167]
ds_read_b64_tr_b16 v[40:41], v116 offset:57344
ds_read_b32 v127, v125
s_waitcnt lgkmcnt(15)
v_mfma_f32_16x16x32_bf16 v[172:175], v[44:47], v[236:239], v[172:175]
ds_read_b64_tr_b16 v[42:43], v116 offset:61440
v_mfma_f32_16x16x32_bf16 v[168:171], v[44:47], v[232:235], v[168:171]
ds_read_b64_tr_b16 v[44:45], v117 offset:57344
s_waitcnt lgkmcnt(15)
v_mfma_f32_16x16x32_bf16 v[176:179], v[48:51], v[232:235], v[176:179]
ds_read_b64_tr_b16 v[46:47], v117 offset:61440
v_mfma_f32_16x16x32_bf16 v[180:183], v[48:51], v[236:239], v[180:183]
ds_read_b64_tr_b16 v[48:49], v118 offset:57344
s_waitcnt lgkmcnt(14)
v_mfma_f32_16x16x32_bf16 v[188:191], v[52:55], v[236:239], v[188:191]
ds_read_b64_tr_b16 v[50:51], v118 offset:61440
s_waitcnt vmcnt(0)
v_mov_b32 v126, 47
s_mov_b64 exec, s[60:61]
ds_write_b32 v125, v126
s_mov_b64 exec, -1
s_waitcnt lgkmcnt(6)
v_cmp_gt_u32 vcc, 46, v127
v_mfma_f32_16x16x32_bf16 v[184:187], v[52:55], v[232:235], v[184:187]
ds_read_b64_tr_b16 v[52:53], v119 offset:57344
ds_read_b64_tr_b16 v[54:55], v119 offset:61440
s_cbranch_vccnz LC_s46
LC_b46:
v_mfma_f32_16x16x32_bf16 v[160:163], v[24:27], v[240:243], v[160:163]
v_mfma_f32_16x16x32_bf16 v[164:167], v[24:27], v[244:247], v[164:167]
ds_read_b64_tr_b16 v[24:25], v116 offset:32768
v_mfma_f32_16x16x32_bf16 v[172:175], v[28:31], v[244:247], v[172:175]
ds_read_b64_tr_b16 v[26:27], v116 offset:36864
v_mfma_f32_16x16x32_bf16 v[168:171], v[28:31], v[240:243], v[168:171]
ds_read_b64_tr_b16 v[28:29], v117 offset:32768
v_mfma_f32_16x16x32_bf16 v[176:179], v[32:35], v[240:243], v[176:179]
ds_read_b64_tr_b16 v[30:31], v117 offset:36864
v_mfma_f32_16x16x32_bf16 v[180:183], v[32:35], v[244:247], v[180:183]
ds_read_b64_tr_b16 v[32:33], v118 offset:32768
v_mfma_f32_16x16x32_bf16 v[188:191], v[36:39], v[244:247], v[188:191]
ds_read_b64_tr_b16 v[34:35], v118 offset:36864
v_mfma_f32_16x16x32_bf16 v[184:187], v[36:39], v[240:243], v[184:187]
ds_read_b64_tr_b16 v[36:37], v119 offset:32768
s_waitcnt lgkmcnt(14)
v_mfma_f32_16x16x32_bf16 v[160:163], v[40:43], v[248:251], v[160:163]
ds_read_b64_tr_b16 v[38:39], v119 offset:36864
v_mfma_f32_16x16x32_bf16 v[164:167], v[40:43], v[252:255], v[164:167]
ds_read_b64_tr_b16 v[40:41], v116 offset:40960
ds_read_b32 v127, v125
s_waitcnt lgkmcnt(15)
v_mfma_f32_16x16x32_bf16 v[172:175], v[44:47], v[252:255], v[172:175]
ds_read_b64_tr_b16 v[42:43], v116 offset:45056
v_mfma_f32_16x16x32_bf16 v[168:171], v[44:47], v[248:251], v[168:171]
ds_read_b64_tr_b16 v[44:45], v117 offset:40960
s_waitcnt lgkmcnt(15)
v_mfma_f32_16x16x32_bf16 v[176:179], v[48:51], v[248:251], v[176:179]
ds_read_b64_tr_b16 v[46:47], v117 offset:45056
v_mfma_f32_16x16x32_bf16 v[180:183], v[48:51], v[252:255], v[180:183]
ds_read_b64_tr_b16 v[48:49], v118 offset:40960
s_waitcnt lgkmcnt(14)
v_mfma_f32_16x16x32_bf16 v[188:191], v[52:55], v[252:255], v[188:191]
ds_read_b64_tr_b16 v[50:51], v118 offset:45056
s_waitcnt lgkmcnt(5)
v_cmp_gt_u32 vcc, 47, v127
v_mfma_f32_16x16x32_bf16 v[184:187], v[52:55], v[248:251], v[184:187]
ds_read_b64_tr_b16 v[52:53], v119 offset:40960
ds_read_b64_tr_b16 v[54:55], v119 offset:45056
s_cbranch_vccnz LC_s47
LC_b47:
v_mfma_f32_16x16x32_bf16 v[160:163], v[24:27], v[56:59], v[160:163]
v_mfma_f32_16x16x32_bf16 v[164:167], v[24:27], v[60:63], v[164:167]
ds_read_b64_tr_b16 v[24:25], v108 offset:0
v_mfma_f32_16x16x32_bf16 v[172:175], v[28:31], v[60:63], v[172:175]
ds_read_b64_tr_b16 v[26:27], v108 offset:4096
v_mfma_f32_16x16x32_bf16 v[168:171], v[28:31], v[56:59], v[168:171]
ds_read_b64_tr_b16 v[28:29], v109 offset:0
v_mfma_f32_16x16x32_bf16 v[176:179], v[32:35], v[56:59], v[176:179]
ds_read_b64_tr_b16 v[30:31], v109 offset:4096
v_mfma_f32_16x16x32_bf16 v[180:183], v[32:35], v[60:63], v[180:183]
ds_read_b64_tr_b16 v[32:33], v110 offset:0
v_mfma_f32_16x16x32_bf16 v[188:191], v[36:39], v[60:63], v[188:191]
ds_read_b64_tr_b16 v[34:35], v110 offset:4096
v_mfma_f32_16x16x32_bf16 v[184:187], v[36:39], v[56:59], v[184:187]
ds_read_b64_tr_b16 v[36:37], v111 offset:0
s_waitcnt lgkmcnt(13)
v_mfma_f32_16x16x32_bf16 v[160:163], v[40:43], v[64:67], v[160:163]
ds_read_b64_tr_b16 v[38:39], v111 offset:4096
v_mfma_f32_16x16x32_bf16 v[164:167], v[40:43], v[68:71], v[164:167]
ds_read_b64_tr_b16 v[40:41], v108 offset:8192
s_waitcnt lgkmcnt(13)
v_mfma_f32_16x16x32_bf16 v[172:175], v[44:47], v[68:71], v[172:175]
ds_read_b64_tr_b16 v[42:43], v108 offset:12288
v_mfma_f32_16x16x32_bf16 v[168:171], v[44:47], v[64:67], v[168:171]
ds_read_b64_tr_b16 v[44:45], v109 offset:8192
s_waitcnt lgkmcnt(13)
v_mfma_f32_16x16x32_bf16 v[176:179], v[48:51], v[64:67], v[176:179]
ds_read_b64_tr_b16 v[46:47], v109 offset:12288
v_mfma_f32_16x16x32_bf16 v[180:183], v[48:51], v[68:71], v[180:183]
ds_read_b64_tr_b16 v[48:49], v110 offset:8192
s_waitcnt lgkmcnt(13)
v_mfma_f32_16x16x32_bf16 v[188:191], v[52:55], v[68:71], v[188:191]
ds_read_b64_tr_b16 v[50:51], v110 offset:12288
v_mfma_f32_16x16x32_bf16 v[184:187], v[52:55], v[64:67], v[184:187]
ds_read_b64_tr_b16 v[52:53], v111 offset:8192
ds_read_b64_tr_b16 v[54:55], v111 offset:12288
s_waitcnt lgkmcnt(14)
v_mfma_f32_16x16x32_bf16 v[160:163], v[24:27], v[72:75], v[160:163]
v_mfma_f32_16x16x32_bf16 v[164:167], v[24:27], v[76:79], v[164:167]
ds_read_b64_tr_b16 v[24:25], v104 offset:32768
s_waitcnt lgkmcnt(13)
v_mfma_f32_16x16x32_bf16 v[172:175], v[28:31], v[76:79], v[172:175]
ds_read_b64_tr_b16 v[26:27], v104 offset:36864
v_mfma_f32_16x16x32_bf16 v[168:171], v[28:31], v[72:75], v[168:171]
ds_read_b64_tr_b16 v[28:29], v104 offset:40960
s_waitcnt lgkmcnt(13)
v_mfma_f32_16x16x32_bf16 v[176:179], v[32:35], v[72:75], v[176:179]
ds_read_b64_tr_b16 v[30:31], v104 offset:45056
v_mfma_f32_16x16x32_bf16 v[180:183], v[32:35], v[76:79], v[180:183]
ds_read_b64_tr_b16 v[32:33], v104 offset:49152
s_waitcnt lgkmcnt(13)
v_mfma_f32_16x16x32_bf16 v[188:191], v[36:39], v[76:79], v[188:191]
ds_read_b64_tr_b16 v[34:35], v104 offset:53248
v_mfma_f32_16x16x32_bf16 v[184:187], v[36:39], v[72:75], v[184:187]
ds_read_b64_tr_b16 v[36:37], v104 offset:57344
s_waitcnt lgkmcnt(13)
v_mfma_f32_16x16x32_bf16 v[160:163], v[40:43], v[80:83], v[160:163]
ds_read_b64_tr_b16 v[38:39], v104 offset:61440
v_mfma_f32_16x16x32_bf16 v[164:167], v[40:43], v[84:87], v[164:167]
ds_read_b64_tr_b16 v[40:41], v112 offset:16384
s_waitcnt lgkmcnt(13)
v_mfma_f32_16x16x32_bf16 v[172:175], v[44:47], v[84:87], v[172:175]
ds_read_b64_tr_b16 v[42:43], v112 offset:20480
v_mfma_f32_16x16x32_bf16 v[168:171], v[44:47], v[80:83], v[168:171]
ds_read_b64_tr_b16 v[44:45], v112 offset:24576
s_waitcnt lgkmcnt(13)
v_mfma_f32_16x16x32_bf16 v[176:179], v[48:51], v[80:83], v[176:179]
ds_read_b64_tr_b16 v[46:47], v112 offset:28672
v_mfma_f32_16x16x32_bf16 v[180:183], v[48:51], v[84:87], v[180:183]
ds_read_b64_tr_b16 v[48:49], v112 offset:49152
v_perm_b32 v160, v160, v0, s40
v_perm_b32 v161, v161, v0, s41
s_waitcnt lgkmcnt(13)
v_mfma_f32_16x16x32_bf16 v[188:191], v[52:55], v[84:87], v[188:191]
ds_read_b64_tr_b16 v[50:51], v112 offset:53248
v_perm_b32 v162, v162, v0, s42
v_perm_b32 v163, v163, v0, s43
buffer_store_dwordx4 v[160:163], v18, s[12:15], s67 offen offset:0 sc0 sc1
v_mfma_f32_16x16x32_bf16 v[184:187], v[52:55], v[80:83], v[184:187]
ds_read_b64_tr_b16 v[52:53], v112 offset:57344
ds_read_b64_tr_b16 v[54:55], v112 offset:61440
v_perm_b32 v164, v164, v0, s40
v_perm_b32 v165, v165, v0, s41
s_waitcnt lgkmcnt(14)
v_mfma_f32_16x16x32_bf16 v[128:131], v[24:27], v[192:195], v[128:131]
v_perm_b32 v166, v166, v0, s42
v_perm_b32 v167, v167, v0, s43
buffer_store_dwordx4 v[164:167], v18, s[12:15], s67 offen offset:1024 sc0 sc1
v_mfma_f32_16x16x32_bf16 v[132:135], v[24:27], v[196:199], v[132:135]
ds_read_b64_tr_b16 v[24:25], v112 offset:32768
v_perm_b32 v168, v168, v0, s40
v_perm_b32 v169, v169, v0, s41
s_waitcnt lgkmcnt(13)
v_mfma_f32_16x16x32_bf16 v[128:131], v[28:31], v[200:203], v[128:131]
ds_read_b64_tr_b16 v[26:27], v112 offset:36864
v_perm_b32 v170, v170, v0, s42
v_perm_b32 v171, v171, v0, s43
buffer_store_dwordx4 v[168:171], v18, s[12:15], s67 offen offset:2048 sc0 sc1
v_mfma_f32_16x16x32_bf16 v[132:135], v[28:31], v[204:207], v[132:135]
ds_read_b64_tr_b16 v[28:29], v112 offset:40960
v_perm_b32 v172, v172, v0, s40
v_perm_b32 v173, v173, v0, s41
s_waitcnt lgkmcnt(13)
v_mfma_f32_16x16x32_bf16 v[128:131], v[32:35], v[208:211], v[128:131]
ds_read_b64_tr_b16 v[30:31], v112 offset:45056
v_perm_b32 v174, v174, v0, s42
v_perm_b32 v175, v175, v0, s43
buffer_store_dwordx4 v[172:175], v18, s[12:15], s67 offen offset:3072 sc0 sc1
v_mfma_f32_16x16x32_bf16 v[132:135], v[32:35], v[212:215], v[132:135]
ds_read_b64_tr_b16 v[32:33], v104 offset:0
v_perm_b32 v176, v176, v0, s40
v_perm_b32 v177, v177, v0, s41
s_waitcnt lgkmcnt(13)
v_mfma_f32_16x16x32_bf16 v[128:131], v[36:39], v[216:219], v[128:131]
ds_read_b64_tr_b16 v[34:35], v104 offset:4096
v_perm_b32 v178, v178, v0, s42
v_perm_b32 v179, v179, v0, s43
s_add_u32 s67, s67, 4096
buffer_store_dwordx4 v[176:179], v18, s[12:15], s67 offen offset:0 sc0 sc1
v_mfma_f32_16x16x32_bf16 v[132:135], v[36:39], v[220:223], v[132:135]
ds_read_b64_tr_b16 v[36:37], v104 offset:8192
v_perm_b32 v180, v180, v0, s40
v_perm_b32 v181, v181, v0, s41
s_waitcnt lgkmcnt(13)
v_mfma_f32_16x16x32_bf16 v[128:131], v[40:43], v[224:227], v[128:131]
ds_read_b64_tr_b16 v[38:39], v104 offset:12288
v_perm_b32 v182, v182, v0, s42
v_perm_b32 v183, v183, v0, s43
buffer_store_dwordx4 v[180:183], v18, s[12:15], s67 offen offset:1024 sc0 sc1
v_mfma_f32_16x16x32_bf16 v[132:135], v[40:43], v[228:231], v[132:135]
ds_read_b64_tr_b16 v[40:41], v105 offset:32768
v_perm_b32 v184, v184, v0, s40
v_perm_b32 v185, v185, v0, s41
s_waitcnt lgkmcnt(13)
v_mfma_f32_16x16x32_bf16 v[128:131], v[44:47], v[232:235], v[128:131]
ds_read_b64_tr_b16 v[42:43], v105 offset:36864
v_perm_b32 v186, v186, v0, s42
v_perm_b32 v187, v187, v0, s43
buffer_store_dwordx4 v[184:187], v18, s[12:15], s67 offen offset:2048 sc0 sc1
v_mfma_f32_16x16x32_bf16 v[132:135], v[44:47], v[236:239], v[132:135]
ds_read_b64_tr_b16 v[44:45], v105 offset:40960
v_perm_b32 v188, v188, v0, s40
v_perm_b32 v189, v189, v0, s41
s_waitcnt lgkmcnt(13)
v_mfma_f32_16x16x32_bf16 v[128:131], v[48:51], v[240:243], v[128:131]
ds_read_b64_tr_b16 v[46:47], v105 offset:45056
v_perm_b32 v190, v190, v0, s42
v_perm_b32 v191, v191, v0, s43
buffer_store_dwordx4 v[188:191], v18, s[12:15], s67 offen offset:3072 sc0 sc1
v_mfma_f32_16x16x32_bf16 v[132:135], v[48:51], v[244:247], v[132:135]
ds_read_b64_tr_b16 v[48:49], v105 offset:49152
s_waitcnt lgkmcnt(13)
v_mfma_f32_16x16x32_bf16 v[128:131], v[52:55], v[248:251], v[128:131]
ds_read_b64_tr_b16 v[50:51], v105 offset:53248
s_cmp_lt_u32 s28, 2
s_cselect_b32 s36, 0, 81920
s_lshl_b32 s37, s32, 13
s_add_u32 s36, s36, s37
s_add_u32 s36, s36, 16384
v_add_u32 v124, s36, v18
v_mfma_f32_16x16x32_bf16 v[132:135], v[52:55], v[252:255], v[132:135]
ds_read_b64_tr_b16 v[52:53], v105 offset:57344
ds_read_b64_tr_b16 v[54:55], v105 offset:61440
s_waitcnt lgkmcnt(14)
v_mfma_f32_16x16x32_bf16 v[128:131], v[24:27], v[56:59], v[128:131]
v_mfma_f32_16x16x32_bf16 v[132:135], v[24:27], v[60:63], v[132:135]
ds_read_b64_tr_b16 v[24:25], v113 offset:16384
s_waitcnt lgkmcnt(13)
v_mfma_f32_16x16x32_bf16 v[128:131], v[28:31], v[64:67], v[128:131]
ds_read_b64_tr_b16 v[26:27], v113 offset:20480
v_mfma_f32_16x16x32_bf16 v[132:135], v[28:31], v[68:71], v[132:135]
ds_read_b64_tr_b16 v[28:29], v113 offset:24576
s_waitcnt lgkmcnt(13)
v_mfma_f32_16x16x32_bf16 v[128:131], v[32:35], v[72:75], v[128:131]
ds_read_b64_tr_b16 v[30:31], v113 offset:28672
v_mfma_f32_16x16x32_bf16 v[132:135], v[32:35], v[76:79], v[132:135]
ds_read_b64_tr_b16 v[32:33], v113 offset:49152
s_waitcnt lgkmcnt(13)
v_mfma_f32_16x16x32_bf16 v[128:131], v[36:39], v[80:83], v[128:131]
ds_read_b64_tr_b16 v[34:35], v113 offset:53248
v_mfma_f32_16x16x32_bf16 v[132:135], v[36:39], v[84:87], v[132:135]
ds_read_b64_tr_b16 v[36:37], v113 offset:57344
s_waitcnt lgkmcnt(13)
v_mfma_f32_16x16x32_bf16 v[136:139], v[40:43], v[192:195], v[136:139]
ds_read_b64_tr_b16 v[38:39], v113 offset:61440
v_mfma_f32_16x16x32_bf16 v[140:143], v[40:43], v[196:199], v[140:143]
ds_read_b64_tr_b16 v[40:41], v113 offset:32768
s_waitcnt lgkmcnt(13)
v_mfma_f32_16x16x32_bf16 v[136:139], v[44:47], v[200:203], v[136:139]
ds_read_b64_tr_b16 v[42:43], v113 offset:36864
ds_write_b128 v124, v[128:131] offset:0
v_mfma_f32_16x16x32_bf16 v[140:143], v[44:47], v[204:207], v[140:143]
ds_read_b64_tr_b16 v[44:45], v113 offset:40960
ds_write_b128 v124, v[132:135] offset:1024
s_waitcnt lgkmcnt(15)
v_mfma_f32_16x16x32_bf16 v[136:139], v[48:51], v[208:211], v[136:139]
ds_read_b64_tr_b16 v[46:47], v113 offset:45056
v_mov_b32 v126, 100
s_mov_b64 exec, s[60:61]
ds_write_b32 v125, v126
s_mov_b64 exec, -1
v_mfma_f32_16x16x32_bf16 v[140:143], v[48:51], v[212:215], v[140:143]
ds_read_b64_tr_b16 v[48:49], v105 offset:0
s_waitcnt lgkmcnt(15)
v_mfma_f32_16x16x32_bf16 v[136:139], v[52:55], v[216:219], v[136:139]
ds_read_b64_tr_b16 v[50:51], v105 offset:4096
v_mfma_f32_16x16x32_bf16 v[140:143], v[52:55], v[220:223], v[140:143]
ds_read_b64_tr_b16 v[52:53], v105 offset:8192
ds_read_b64_tr_b16 v[54:55], v105 offset:12288
s_waitcnt lgkmcnt(15)
v_mfma_f32_16x16x32_bf16 v[136:139], v[24:27], v[224:227], v[136:139]
v_mfma_f32_16x16x32_bf16 v[140:143], v[24:27], v[228:231], v[140:143]
ds_read_b64_tr_b16 v[24:25], v106 offset:32768
v_mfma_f32_16x16x32_bf16 v[136:139], v[28:31], v[232:235], v[136:139]
ds_read_b64_tr_b16 v[26:27], v106 offset:36864
v_mfma_f32_16x16x32_bf16 v[140:143], v[28:31], v[236:239], v[140:143]
ds_read_b64_tr_b16 v[28:29], v106 offset:40960
s_waitcnt lgkmcnt(15)
v_mfma_f32_16x16x32_bf16 v[136:139], v[32:35], v[240:243], v[136:139]
ds_read_b64_tr_b16 v[30:31], v106 offset:45056
v_mfma_f32_16x16x32_bf16 v[140:143], v[32:35], v[244:247], v[140:143]
ds_read_b64_tr_b16 v[32:33], v106 offset:49152
s_waitcnt lgkmcnt(15)
v_mfma_f32_16x16x32_bf16 v[136:139], v[36:39], v[248:251], v[136:139]
ds_read_b64_tr_b16 v[34:35], v106 offset:53248
v_mfma_f32_16x16x32_bf16 v[140:143], v[36:39], v[252:255], v[140:143]
ds_read_b64_tr_b16 v[36:37], v106 offset:57344
s_waitcnt lgkmcnt(15)
v_mfma_f32_16x16x32_bf16 v[136:139], v[40:43], v[56:59], v[136:139]
ds_read_b64_tr_b16 v[38:39], v106 offset:61440
v_mfma_f32_16x16x32_bf16 v[140:143], v[40:43], v[60:63], v[140:143]
ds_read_b64_tr_b16 v[40:41], v114 offset:16384
s_waitcnt lgkmcnt(14)
v_mfma_f32_16x16x32_bf16 v[136:139], v[44:47], v[64:67], v[136:139]
ds_read_b64_tr_b16 v[42:43], v114 offset:20480
v_mfma_f32_16x16x32_bf16 v[140:143], v[44:47], v[68:71], v[140:143]
ds_read_b64_tr_b16 v[44:45], v114 offset:24576
s_waitcnt lgkmcnt(13)
v_mfma_f32_16x16x32_bf16 v[136:139], v[48:51], v[72:75], v[136:139]
ds_read_b64_tr_b16 v[46:47], v114 offset:28672
v_mfma_f32_16x16x32_bf16 v[140:143], v[48:51], v[76:79], v[140:143]
ds_read_b64_tr_b16 v[48:49], v114 offset:49152
s_waitcnt lgkmcnt(13)
v_mfma_f32_16x16x32_bf16 v[136:139], v[52:55], v[80:83], v[136:139]
ds_read_b64_tr_b16 v[50:51], v114 offset:53248
v_mfma_f32_16x16x32_bf16 v[140:143], v[52:55], v[84:87], v[140:143]
ds_read_b64_tr_b16 v[52:53], v114 offset:57344
ds_read_b64_tr_b16 v[54:55], v114 offset:61440
s_waitcnt lgkmcnt(14)
v_mfma_f32_16x16x32_bf16 v[144:147], v[24:27], v[192:195], v[144:147]
v_mfma_f32_16x16x32_bf16 v[148:151], v[24:27], v[196:199], v[148:151]
ds_read_b64_tr_b16 v[24:25], v114 offset:32768
s_waitcnt lgkmcnt(13)
v_mfma_f32_16x16x32_bf16 v[144:147], v[28:31], v[200:203], v[144:147]
ds_read_b64_tr_b16 v[26:27], v114 offset:36864
ds_write_b128 v124, v[136:139] offset:2048
v_mfma_f32_16x16x32_bf16 v[148:151], v[28:31], v[204:207], v[148:151]
ds_read_b64_tr_b16 v[28:29], v114 offset:40960
ds_write_b128 v124, v[140:143] offset:3072
s_waitcnt lgkmcnt(15)
v_mfma_f32_16x16x32_bf16 v[144:147], v[32:35], v[208:211], v[144:147]
ds_read_b64_tr_b16 v[30:31], v114 offset:45056
v_mov_b32 v126, 101
s_mov_b64 exec, s[60:61]
ds_write_b32 v125, v126
s_mov_b64 exec, -1
v_mfma_f32_16x16x32_bf16 v[148:151], v[32:35], v[212:215], v[148:151]
ds_read_b64_tr_b16 v[32:33], v106 offset:0
s_waitcnt lgkmcnt(15)
v_mfma_f32_16x16x32_bf16 v[144:147], v[36:39], v[216:219], v[144:147]
ds_read_b64_tr_b16 v[34:35], v106 offset:4096
v_mfma_f32_16x16x32_bf16 v[148:151], v[36:39], v[220:223], v[148:151]
ds_read_b64_tr_b16 v[36:37], v106 offset:8192
s_waitcnt lgkmcnt(15)
v_mfma_f32_16x16x32_bf16 v[144:147], v[40:43], v[224:227], v[144:147]
ds_read_b64_tr_b16 v[38:39], v106 offset:12288
v_mfma_f32_16x16x32_bf16 v[148:151], v[40:43], v[228:231], v[148:151]
ds_read_b64_tr_b16 v[40:41], v107 offset:32768
s_waitcnt lgkmcnt(15)
v_mfma_f32_16x16x32_bf16 v[144:147], v[44:47], v[232:235], v[144:147]
ds_read_b64_tr_b16 v[42:43], v107 offset:36864
v_mfma_f32_16x16x32_bf16 v[148:151], v[44:47], v[236:239], v[148:151]
ds_read_b64_tr_b16 v[44:45], v107 offset:40960
s_waitcnt lgkmcnt(15)
v_mfma_f32_16x16x32_bf16 v[144:147], v[48:51], v[240:243], v[144:147]
ds_read_b64_tr_b16 v[46:47], v107 offset:45056
v_mfma_f32_16x16x32_bf16 v[148:151], v[48:51], v[244:247], v[148:151]
ds_read_b64_tr_b16 v[48:49], v107 offset:49152
s_waitcnt lgkmcnt(15)
v_mfma_f32_16x16x32_bf16 v[144:147], v[52:55], v[248:251], v[144:147]
ds_read_b64_tr_b16 v[50:51], v107 offset:53248
v_mfma_f32_16x16x32_bf16 v[148:151], v[52:55], v[252:255], v[148:151]
ds_read_b64_tr_b16 v[52:53], v107 offset:57344
ds_read_b64_tr_b16 v[54:55], v107 offset:61440
s_waitcnt lgkmcnt(15)
v_mfma_f32_16x16x32_bf16 v[144:147], v[24:27], v[56:59], v[144:147]
v_mfma_f32_16x16x32_bf16 v[148:151], v[24:27], v[60:63], v[148:151]
ds_read_b64_tr_b16 v[24:25], v115 offset:16384
s_waitcnt lgkmcnt(14)
v_mfma_f32_16x16x32_bf16 v[144:147], v[28:31], v[64:67], v[144:147]
ds_read_b64_tr_b16 v[26:27], v115 offset:20480
v_mfma_f32_16x16x32_bf16 v[148:151], v[28:31], v[68:71], v[148:151]
ds_read_b64_tr_b16 v[28:29], v115 offset:24576
s_waitcnt lgkmcnt(13)
v_mfma_f32_16x16x32_bf16 v[144:147], v[32:35], v[72:75], v[144:147]
ds_read_b64_tr_b16 v[30:31], v115 offset:28672
v_mfma_f32_16x16x32_bf16 v[148:151], v[32:35], v[76:79], v[148:151]
ds_read_b64_tr_b16 v[32:33], v115 offset:49152
s_waitcnt lgkmcnt(13)
v_mfma_f32_16x16x32_bf16 v[144:147], v[36:39], v[80:83], v[144:147]
ds_read_b64_tr_b16 v[34:35], v115 offset:53248
v_mfma_f32_16x16x32_bf16 v[148:151], v[36:39], v[84:87], v[148:151]
ds_read_b64_tr_b16 v[36:37], v115 offset:57344
s_waitcnt lgkmcnt(13)
v_mfma_f32_16x16x32_bf16 v[152:155], v[40:43], v[192:195], v[152:155]
ds_read_b64_tr_b16 v[38:39], v115 offset:61440
v_mfma_f32_16x16x32_bf16 v[156:159], v[40:43], v[196:199], v[156:159]
ds_read_b64_tr_b16 v[40:41], v115 offset:32768
s_waitcnt lgkmcnt(13)
v_mfma_f32_16x16x32_bf16 v[152:155], v[44:47], v[200:203], v[152:155]
ds_read_b64_tr_b16 v[42:43], v115 offset:36864
ds_write_b128 v124, v[144:147] offset:4096
v_mfma_f32_16x16x32_bf16 v[156:159], v[44:47], v[204:207], v[156:159]
ds_read_b64_tr_b16 v[44:45], v115 offset:40960
ds_write_b128 v124, v[148:151] offset:5120
s_waitcnt lgkmcnt(15)
v_mfma_f32_16x16x32_bf16 v[152:155], v[48:51], v[208:211], v[152:155]
ds_read_b64_tr_b16 v[46:47], v115 offset:45056
v_mov_b32 v126, 102
s_mov_b64 exec, s[60:61]
ds_write_b32 v125, v126
s_mov_b64 exec, -1
v_mfma_f32_16x16x32_bf16 v[156:159], v[48:51], v[212:215], v[156:159]
ds_read_b64_tr_b16 v[48:49], v107 offset:0
s_waitcnt lgkmcnt(15)
v_mfma_f32_16x16x32_bf16 v[152:155], v[52:55], v[216:219], v[152:155]
ds_read_b64_tr_b16 v[50:51], v107 offset:4096
v_mfma_f32_16x16x32_bf16 v[156:159], v[52:55], v[220:223], v[156:159]
ds_read_b64_tr_b16 v[52:53], v107 offset:8192
ds_read_b64_tr_b16 v[54:55], v107 offset:12288
s_waitcnt lgkmcnt(15)
v_mfma_f32_16x16x32_bf16 v[152:155], v[24:27], v[224:227], v[152:155]
v_mfma_f32_16x16x32_bf16 v[156:159], v[24:27], v[228:231], v[156:159]
v_mfma_f32_16x16x32_bf16 v[152:155], v[28:31], v[232:235], v[152:155]
v_mfma_f32_16x16x32_bf16 v[156:159], v[28:31], v[236:239], v[156:159]
s_waitcnt lgkmcnt(13)
v_mfma_f32_16x16x32_bf16 v[152:155], v[32:35], v[240:243], v[152:155]
v_mfma_f32_16x16x32_bf16 v[156:159], v[32:35], v[244:247], v[156:159]
s_waitcnt lgkmcnt(11)
v_mfma_f32_16x16x32_bf16 v[152:155], v[36:39], v[248:251], v[152:155]
v_mfma_f32_16x16x32_bf16 v[156:159], v[36:39], v[252:255], v[156:159]
s_waitcnt lgkmcnt(9)
v_mfma_f32_16x16x32_bf16 v[152:155], v[40:43], v[56:59], v[152:155]
v_mfma_f32_16x16x32_bf16 v[156:159], v[40:43], v[60:63], v[156:159]
s_waitcnt lgkmcnt(5)
v_mfma_f32_16x16x32_bf16 v[152:155], v[44:47], v[64:67], v[152:155]
v_mfma_f32_16x16x32_bf16 v[156:159], v[44:47], v[68:71], v[156:159]
s_waitcnt lgkmcnt(2)
v_mfma_f32_16x16x32_bf16 v[152:155], v[48:51], v[72:75], v[152:155]
v_mfma_f32_16x16x32_bf16 v[156:159], v[48:51], v[76:79], v[156:159]
s_waitcnt lgkmcnt(0)
v_mfma_f32_16x16x32_bf16 v[152:155], v[52:55], v[80:83], v[152:155]
v_mfma_f32_16x16x32_bf16 v[156:159], v[52:55], v[84:87], v[156:159]
s_nop 7
ds_write_b128 v124, v[152:155] offset:6144
ds_write_b128 v124, v[156:159] offset:7168
v_mov_b32 v126, 103
s_mov_b64 exec, s[60:61]
ds_write_b32 v125, v126
s_mov_b64 exec, -1
s_endpgm
LC_s2:
s_mov_b32 s69, 100000
LC_l2:
ds_read_b32 v127, v125
s_waitcnt lgkmcnt(0)
v_cmp_gt_u32 vcc, 2, v127
s_cbranch_vccz LC_b2
s_sub_u32 s69, s69, 1
s_cmp_lg_u32 s69, 0
s_cbranch_scc1 LC_l2
s_branch LC_b2
LC_s4:
s_mov_b32 s69, 100000
LC_l4:
ds_read_b32 v127, v125
s_waitcnt lgkmcnt(0)
v_cmp_gt_u32 vcc, 4, v127
s_cbranch_vccz LC_b4
s_sub_u32 s69, s69, 1
s_cmp_lg_u32 s69, 0
s_cbranch_scc1 LC_l4
s_branch LC_b4
LC_s6:
s_mov_b32 s69, 100000
LC_l6:
ds_read_b32 v127, v125
s_waitcnt lgkmcnt(0)
v_cmp_gt_u32 vcc, 6, v127
s_cbranch_vccz LC_b6
s_sub_u32 s69, s69, 1
s_cmp_lg_u32 s69, 0
s_cbranch_scc1 LC_l6
s_branch LC_b6
LC_s8:
s_mov_b32 s69, 100000
LC_l8:
ds_read_b32 v127, v125
s_waitcnt lgkmcnt(0)
v_cmp_gt_u32 vcc, 8, v127
s_cbranch_vccz LC_b8
s_sub_u32 s69, s69, 1
s_cmp_lg_u32 s69, 0
s_cbranch_scc1 LC_l8
s_branch LC_b8
LC_s10:
s_mov_b32 s69, 100000
LC_l10:
ds_read_b32 v127, v125
s_waitcnt lgkmcnt(0)
v_cmp_gt_u32 vcc, 10, v127
s_cbranch_vccz LC_b10
s_sub_u32 s69, s69, 1
s_cmp_lg_u32 s69, 0
s_cbranch_scc1 LC_l10
s_branch LC_b10
LC_s12:
s_mov_b32 s69, 100000
LC_l12:
ds_read_b32 v127, v125
s_waitcnt lgkmcnt(0)
v_cmp_gt_u32 vcc, 12, v127
s_cbranch_vccz LC_b12
s_sub_u32 s69, s69, 1
s_cmp_lg_u32 s69, 0
s_cbranch_scc1 LC_l12
s_branch LC_b12
LC_s14:
s_mov_b32 s69, 100000
LC_l14:
ds_read_b32 v127, v125
s_waitcnt lgkmcnt(0)
v_cmp_gt_u32 vcc, 14, v127
s_cbranch_vccz LC_b14
s_sub_u32 s69, s69, 1
s_cmp_lg_u32 s69, 0
s_cbranch_scc1 LC_l14
s_branch LC_b14
LC_s16:
s_mov_b32 s69, 100000
LC_l16:
ds_read_b32 v127, v125
s_waitcnt lgkmcnt(0)
v_cmp_gt_u32 vcc, 16, v127
s_cbranch_vccz LC_b16
s_sub_u32 s69, s69, 1
s_cmp_lg_u32 s69, 0
s_cbranch_scc1 LC_l16
s_branch LC_b16
LC_s18:
s_mov_b32 s69, 100000
LC_l18:
ds_read_b32 v127, v125
s_waitcnt lgkmcnt(0)
v_cmp_gt_u32 vcc, 18, v127
s_cbranch_vccz LC_b18
s_sub_u32 s69, s69, 1
s_cmp_lg_u32 s69, 0
s_cbranch_scc1 LC_l18
s_branch LC_b18
LC_s20:
s_mov_b32 s69, 100000
LC_l20:
ds_read_b32 v127, v125
s_waitcnt lgkmcnt(0)
v_cmp_gt_u32 vcc, 20, v127
s_cbranch_vccz LC_b20
s_sub_u32 s69, s69, 1
s_cmp_lg_u32 s69, 0
s_cbranch_scc1 LC_l20
s_branch LC_b20
LC_s22:
s_mov_b32 s69, 100000
LC_l22:
ds_read_b32 v127, v125
s_waitcnt lgkmcnt(0)
v_cmp_gt_u32 vcc, 22, v127
s_cbranch_vccz LC_b22
s_sub_u32 s69, s69, 1
s_cmp_lg_u32 s69, 0
s_cbranch_scc1 LC_l22
s_branch LC_b22
LC_s24:
s_mov_b32 s69, 100000
LC_l24:
ds_read_b32 v127, v125
s_waitcnt lgkmcnt(0)
v_cmp_gt_u32 vcc, 24, v127
s_cbranch_vccz LC_b24
s_sub_u32 s69, s69, 1
s_cmp_lg_u32 s69, 0
s_cbranch_scc1 LC_l24
s_branch LC_b24
LC_s26:
s_mov_b32 s69, 100000
LC_l26:
ds_read_b32 v127, v125
s_waitcnt lgkmcnt(0)
v_cmp_gt_u32 vcc, 26, v127
s_cbranch_vccz LC_b26
s_sub_u32 s69, s69, 1
s_cmp_lg_u32 s69, 0
s_cbranch_scc1 LC_l26
s_branch LC_b26
LC_s28:
s_mov_b32 s69, 100000
LC_l28:
ds_read_b32 v127, v125
s_waitcnt lgkmcnt(0)
v_cmp_gt_u32 vcc, 28, v127
s_cbranch_vccz LC_b28
s_sub_u32 s69, s69, 1
s_cmp_lg_u32 s69, 0
s_cbranch_scc1 LC_l28
s_branch LC_b28
LC_s30:
s_mov_b32 s69, 100000
LC_l30:
ds_read_b32 v127, v125
s_waitcnt lgkmcnt(0)
v_cmp_gt_u32 vcc, 30, v127
s_cbranch_vccz LC_b30
s_sub_u32 s69, s69, 1
s_cmp_lg_u32 s69, 0
s_cbranch_scc1 LC_l30
s_branch LC_b30
LC_s32:
s_mov_b32 s69, 100000
LC_l32:
ds_read_b32 v127, v125
s_waitcnt lgkmcnt(0)
v_cmp_gt_u32 vcc, 32, v127
s_cbranch_vccz LC_b32
s_sub_u32 s69, s69, 1
s_cmp_lg_u32 s69, 0
s_cbranch_scc1 LC_l32
s_branch LC_b32
LC_s34:
s_mov_b32 s69, 100000
LC_l34:
ds_read_b32 v127, v125
s_waitcnt lgkmcnt(0)
v_cmp_gt_u32 vcc, 34, v127
s_cbranch_vccz LC_b34
s_sub_u32 s69, s69, 1
s_cmp_lg_u32 s69, 0
s_cbranch_scc1 LC_l34
s_branch LC_b34
LC_s36:
s_mov_b32 s69, 100000
LC_l36:
ds_read_b32 v127, v125
s_waitcnt lgkmcnt(0)
v_cmp_gt_u32 vcc, 36, v127
s_cbranch_vccz LC_b36
s_sub_u32 s69, s69, 1
s_cmp_lg_u32 s69, 0
s_cbranch_scc1 LC_l36
s_branch LC_b36
LC_s38:
s_mov_b32 s69, 100000
LC_l38:
ds_read_b32 v127, v125
s_waitcnt lgkmcnt(0)
v_cmp_gt_u32 vcc, 38, v127
s_cbranch_vccz LC_b38
s_sub_u32 s69, s69, 1
s_cmp_lg_u32 s69, 0
s_cbranch_scc1 LC_l38
s_branch LC_b38
LC_s40:
s_mov_b32 s69, 100000
LC_l40:
ds_read_b32 v127, v125
s_waitcnt lgkmcnt(0)
v_cmp_gt_u32 vcc, 40, v127
s_cbranch_vccz LC_b40
s_sub_u32 s69, s69, 1
s_cmp_lg_u32 s69, 0
s_cbranch_scc1 LC_l40
s_branch LC_b40
LC_s42:
s_mov_b32 s69, 100000
LC_l42:
ds_read_b32 v127, v125
s_waitcnt lgkmcnt(0)
v_cmp_gt_u32 vcc, 42, v127
s_cbranch_vccz LC_b42
s_sub_u32 s69, s69, 1
s_cmp_lg_u32 s69, 0
s_cbranch_scc1 LC_l42
s_branch LC_b42
LC_s43:
s_mov_b32 s69, 100000
LC_l43:
ds_read_b32 v127, v125
s_waitcnt lgkmcnt(0)
v_cmp_gt_u32 vcc, 43, v127
s_cbranch_vccz LC_b43
s_sub_u32 s69, s69, 1
s_cmp_lg_u32 s69, 0
s_cbranch_scc1 LC_l43
s_branch LC_b43
LC_s44:
s_mov_b32 s69, 100000
LC_l44:
ds_read_b32 v127, v125
s_waitcnt lgkmcnt(0)
v_cmp_gt_u32 vcc, 44, v127
s_cbranch_vccz LC_b44
s_sub_u32 s69, s69, 1
s_cmp_lg_u32 s69, 0
s_cbranch_scc1 LC_l44
s_branch LC_b44
LC_s45:
s_mov_b32 s69, 100000
LC_l45:
ds_read_b32 v127, v125
s_waitcnt lgkmcnt(0)
v_cmp_gt_u32 vcc, 45, v127
s_cbranch_vccz LC_b45
s_sub_u32 s69, s69, 1
s_cmp_lg_u32 s69, 0
s_cbranch_scc1 LC_l45
s_branch LC_b45
LC_s46:
s_mov_b32 s69, 100000
LC_l46:
ds_read_b32 v127, v125
s_waitcnt lgkmcnt(0)
v_cmp_gt_u32 vcc, 46, v127
s_cbranch_vccz LC_b46
s_sub_u32 s69, s69, 1
s_cmp_lg_u32 s69, 0
s_cbranch_scc1 LC_l46
s_branch LC_b46
LC_s47:
s_mov_b32 s69, 100000
LC_l47:
ds_read_b32 v127, v125
s_waitcnt lgkmcnt(0)
v_cmp_gt_u32 vcc, 47, v127
s_cbranch_vccz LC_b47
s_sub_u32 s69, s69, 1
s_cmp_lg_u32 s69, 0
s_cbranch_scc1 LC_l47
s_branch LC_b47
L_spec:
s_setprio 2
v_mov_b32 v36, 0x05040100
v_mov_b32 v37, 0x07060302
v_mov_b32 v38, 0xbf803f80
v_mov_b32 v39, 0x3f80bf80
s_cmp_eq_u32 s34, 8
s_cselect_b32 s56, 0x00010001, 0
s_mov_b32 s57, s56
s_waitcnt vmcnt(8)
s_barrier
ds_read_b128 v[56:59], v16 offset:0
s_add_u32 m0, s42, 32768
ds_read_b128 v[60:63], v16 offset:2048
buffer_load_dwordx4 v2, s[4:7], s40 offen offset:0 lds
ds_read_b128 v[64:67], v16 offset:4096
ds_read_b64_tr_b16 v[40:41], v8 offset:0
ds_read_b64_tr_b16 v[42:43], v8 offset:1792
ds_read_b128 v[68:71], v16 offset:6144
ds_read_b128 v[72:75], v17 offset:0
buffer_load_dwordx4 v3, s[4:7], s40 offen offset:1024 lds
ds_read_b64_tr_b16 v[44:45], v9 offset:0
ds_read_b64_tr_b16 v[46:47], v9 offset:1792
ds_read_b128 v[76:79], v17 offset:2048
ds_read_b128 v[80:83], v17 offset:4096
s_add_u32 m0, s43, 65536
ds_read_b64_tr_b16 v[48:49], v8 offset:14336
buffer_load_dwordx4 v4, s[8:11], s41 offen offset:0 lds
ds_read_b64_tr_b16 v[50:51], v8 offset:16128
ds_read_b128 v[84:87], v17 offset:6144
ds_read_b64_tr_b16 v[52:53], v9 offset:14336
ds_read_b64_tr_b16 v[54:55], v9 offset:16128
s_waitcnt lgkmcnt(10)
v_mfma_f32_16x16x32_bf16 v[128:131], v[40:43], v[56:59], 0
v_perm_b32 v88, v57, v56, v36
v_perm_b32 v89, v59, v58, v36
v_mfma_f32_16x16x32_bf16 v[132:135], v[40:43], v[60:63], 0
v_mfma_f32_16x16x32_bf16 v[224:227], v[124:127], v[40:43], 0
v_perm_b32 v104, v57, v56, v37
v_perm_b32 v105, v59, v58, v37
buffer_load_dwordx4 v5, s[8:11], s41 offen offset:1024 lds
v_mfma_f32_16x16x32_bf16 v[136:139], v[40:43], v[64:67], 0
v_perm_b32 v92, v61, v60, v36
v_perm_b32 v93, v63, v62, v36
v_mfma_f32_16x16x32_bf16 v[140:143], v[40:43], v[68:71], 0
v_perm_b32 v108, v61, v60, v37
v_perm_b32 v109, v63, v62, v37
ds_read_b64_tr_b16 v[40:41], v10 offset:0
s_waitcnt lgkmcnt(8)
v_mfma_f32_16x16x32_bf16 v[156:159], v[44:47], v[68:71], 0
v_perm_b32 v96, v65, v64, v36
v_perm_b32 v97, v67, v66, v36
ds_read_b64_tr_b16 v[42:43], v10 offset:1024
v_mfma_f32_16x16x32_bf16 v[152:155], v[44:47], v[64:67], 0
v_mfma_f32_16x16x32_bf16 v[228:231], v[124:127], v[44:47], 0
v_perm_b32 v112, v65, v64, v37
v_perm_b32 v113, v67, v66, v37
v_mfma_f32_16x16x32_bf16 v[148:151], v[44:47], v[60:63], 0
v_perm_b32 v100, v69, v68, v36
v_perm_b32 v101, v71, v70, v36
buffer_load_dwordx4 v6, s[8:11], s41 offen offset:2048 lds
v_mfma_f32_16x16x32_bf16 v[144:147], v[44:47], v[56:59], 0
v_perm_b32 v116, v69, v68, v37
v_perm_b32 v117, v71, v70, v37
ds_read_b64_tr_b16 v[44:45], v11 offset:0
s_waitcnt lgkmcnt(5)
v_mfma_f32_16x16x32_bf16 v[128:131], v[48:51], v[72:75], v[128:131]
v_perm_b32 v90, v73, v72, v36
v_perm_b32 v91, v75, v74, v36
ds_read_b64_tr_b16 v[46:47], v11 offset:1024
v_mfma_f32_16x16x32_bf16 v[132:135], v[48:51], v[76:79], v[132:135]
v_mfma_f32_16x16x32_bf16 v[224:227], v[124:127], v[48:51], v[224:227]
v_perm_b32 v106, v73, v72, v37
v_perm_b32 v107, v75, v74, v37
v_mfma_f32_16x16x32_bf16 v[136:139], v[48:51], v[80:83], v[136:139]
v_perm_b32 v94, v77, v76, v36
v_perm_b32 v95, v79, v78, v36
v_mfma_f32_16x16x32_bf16 v[140:143], v[48:51], v[84:87], v[140:143]
v_perm_b32 v110, v77, v76, v37
v_perm_b32 v111, v79, v78, v37
ds_read_b64_tr_b16 v[48:49], v10 offset:2048
buffer_load_dwordx4 v7, s[8:11], s41 offen offset:3072 lds
s_waitcnt lgkmcnt(5)
v_mfma_f32_16x16x32_bf16 v[156:159], v[52:55], v[84:87], v[156:159]
v_perm_b32 v98, v81, v80, v36
v_perm_b32 v99, v83, v82, v36
ds_read_b64_tr_b16 v[50:51], v10 offset:3072
s_and_b32 s98, s96, 15
s_lshr_b64 s[96:97], s[96:97], 4
s_lshl_b32 s40, s98, 7
s_mul_i32 s41, s98, s46
v_mfma_f32_16x16x32_bf16 v[152:155], v[52:55], v[80:83], v[152:155]
v_mfma_f32_16x16x32_bf16 v[228:231], v[124:127], v[52:55], v[228:231]
v_perm_b32 v114, v81, v80, v37
v_perm_b32 v115, v83, v82, v37
v_mfma_f32_16x16x32_bf16 v[148:151], v[52:55], v[76:79], v[148:151]
v_perm_b32 v102, v85, v84, v36
v_perm_b32 v103, v87, v86, v36
v_mfma_f32_16x16x32_bf16 v[144:147], v[52:55], v[72:75], v[144:147]
v_perm_b32 v118, v85, v84, v37
v_perm_b32 v119, v87, v86, v37
ds_read_b64_tr_b16 v[52:53], v11 offset:2048
ds_read_b64_tr_b16 v[54:55], v11 offset:3072
s_waitcnt vmcnt(6)
s_waitcnt lgkmcnt(0)
s_barrier
v_cndmask_b32 v40, v40, v38, s[56:57]
v_cndmask_b32 v41, v41, v38, s[56:57]
v_cndmask_b32 v42, v42, v38, s[56:57]
v_cndmask_b32 v43, v43, v38, s[56:57]
s_nop 1
v_mfma_f32_16x16x32_bf16 v[160:163], v[88:91], v[40:43], 0
ds_read_b128 v[56:59], v16 offset:16384
s_add_u32 m0, s42, 0
s_add_u32 s24, s24, 1
v_mov_b32 v0, s24
v_mfma_f32_16x16x32_bf16 v[164:167], v[92:95], v[40:43], 0
ds_read_b128 v[60:63], v16 offset:18432
buffer_load_dwordx4 v2, s[4:7], s40 offen offset:0 lds
v_dot2c_f32_bf16 v28, v232, v124
v_mfma_f32_16x16x32_bf16 v[168:171], v[96:99], v[40:43], 0
ds_read_b128 v[64:67], v16 offset:20480
v_dot2c_f32_bf16 v29, v232, v232
v_mfma_f32_16x16x32_bf16 v[172:175], v[100:103], v[40:43], 0
ds_read_b64_tr_b16 v[40:41], v8 offset:32768
v_dot2c_f32_bf16 v28, v233, v124
v_mfma_f32_16x16x32_bf16 v[188:191], v[100:103], v[44:47], 0
ds_read_b64_tr_b16 v[42:43], v8 offset:34560
v_dot2c_f32_bf16 v29, v233, v233
v_mfma_f32_16x16x32_bf16 v[184:187], v[96:99], v[44:47], 0
ds_read_b128 v[68:71], v16 offset:22528
v_dot2c_f32_bf16 v28, v234, v124
v_mfma_f32_16x16x32_bf16 v[180:183], v[92:95], v[44:47], 0
ds_read_b128 v[72:75], v17 offset:16384
buffer_load_dwordx4 v3, s[4:7], s40 offen offset:1024 lds
v_dot2c_f32_bf16 v29, v234, v234
v_mfma_f32_16x16x32_bf16 v[176:179], v[88:91], v[44:47], 0
ds_read_b64_tr_b16 v[44:45], v9 offset:32768
v_dot2c_f32_bf16 v28, v235, v124
v_cndmask_b32 v48, v48, v39, s[56:57]
v_cndmask_b32 v49, v49, v39, s[56:57]
v_cndmask_b32 v50, v50, v39, s[56:57]
v_cndmask_b32 v51, v51, v39, s[56:57]
s_nop 1
v_mfma_f32_16x16x32_bf16 v[192:195], v[104:107], v[48:51], 0
ds_read_b64_tr_b16 v[46:47], v9 offset:34560
v_dot2c_f32_bf16 v29, v235, v235
v_mfma_f32_16x16x32_bf16 v[196:199], v[108:111], v[48:51], 0
ds_read_b128 v[76:79], v17 offset:18432
v_dot2c_f32_bf16 v28, v236, v124
v_mfma_f32_16x16x32_bf16 v[200:203], v[112:115], v[48:51], 0
ds_read_b128 v[80:83], v17 offset:20480
s_add_u32 m0, s43, 0
v_dot2c_f32_bf16 v29, v236, v236
v_mfma_f32_16x16x32_bf16 v[204:207], v[116:119], v[48:51], 0
ds_read_b64_tr_b16 v[48:49], v8 offset:47104
buffer_load_dwordx4 v4, s[8:11], s41 offen offset:0 lds
v_mfma_f32_16x16x32_bf16 v[220:223], v[116:119], v[52:55], 0
ds_read_b64_tr_b16 v[50:51], v8 offset:48896
v_dot2c_f32_bf16 v28, v237, v124
v_mfma_f32_16x16x32_bf16 v[216:219], v[112:115], v[52:55], 0
ds_read_b128 v[84:87], v17 offset:22528
v_dot2c_f32_bf16 v29, v237, v237
v_mfma_f32_16x16x32_bf16 v[212:215], v[108:111], v[52:55], 0
v_dot2c_f32_bf16 v28, v238, v124
v_mfma_f32_16x16x32_bf16 v[208:211], v[104:107], v[52:55], 0
ds_read_b64_tr_b16 v[52:53], v9 offset:47104
ds_read_b64_tr_b16 v[54:55], v9 offset:48896
v_dot2c_f32_bf16 v29, v238, v238
s_waitcnt lgkmcnt(10)
v_mfma_f32_16x16x32_bf16 v[128:131], v[40:43], v[56:59], v[128:131]
v_perm_b32 v88, v57, v56, v36
v_perm_b32 v89, v59, v58, v36
v_mfma_f32_16x16x32_bf16 v[132:135], v[40:43], v[60:63], v[132:135]
v_perm_b32 v104, v57, v56, v37
v_perm_b32 v105, v59, v58, v37
buffer_load_dwordx4 v5, s[8:11], s41 offen offset:1024 lds
v_mfma_f32_16x16x32_bf16 v[136:139], v[40:43], v[64:67], v[136:139]
v_perm_b32 v92, v61, v60, v36
v_perm_b32 v93, v63, v62, v36
v_dot2c_f32_bf16 v28, v239, v124
v_mfma_f32_16x16x32_bf16 v[140:143], v[40:43], v[68:71], v[140:143]
v_perm_b32 v108, v61, v60, v37
v_perm_b32 v109, v63, v62, v37
ds_read_b64_tr_b16 v[40:41], v10 offset:32768
s_waitcnt lgkmcnt(8)
v_mfma_f32_16x16x32_bf16 v[156:159], v[44:47], v[68:71], v[156:159]
v_perm_b32 v96, v65, v64, v36
v_perm_b32 v97, v67, v66, v36
ds_read_b64_tr_b16 v[42:43], v10 offset:33792
v_mfma_f32_16x16x32_bf16 v[152:155], v[44:47], v[64:67], v[152:155]
v_perm_b32 v112, v65, v64, v37
v_perm_b32 v113, v67, v66, v37
v_mfma_f32_16x16x32_bf16 v[148:151], v[44:47], v[60:63], v[148:151]
v_perm_b32 v100, v69, v68, v36
v_perm_b32 v101, v71, v70, v36
buffer_load_dwordx4 v6, s[8:11], s41 offen offset:2048 lds
v_dot2c_f32_bf16 v29, v239, v239
v_mfma_f32_16x16x32_bf16 v[144:147], v[44:47], v[56:59], v[144:147]
v_perm_b32 v116, v69, v68, v37
v_perm_b32 v117, v71, v70, v37
ds_read_b64_tr_b16 v[44:45], v11 offset:32768
s_waitcnt lgkmcnt(5)
v_mfma_f32_16x16x32_bf16 v[128:131], v[48:51], v[72:75], v[128:131]
v_perm_b32 v90, v73, v72, v36
v_perm_b32 v91, v75, v74, v36
ds_read_b64_tr_b16 v[46:47], v11 offset:33792
v_mfma_f32_16x16x32_bf16 v[132:135], v[48:51], v[76:79], v[132:135]
v_perm_b32 v106, v73, v72, v37
v_perm_b32 v107, v75, v74, v37
v_mfma_f32_16x16x32_bf16 v[136:139], v[48:51], v[80:83], v[136:139]
v_perm_b32 v94, v77, v76, v36
v_perm_b32 v95, v79, v78, v36
v_cndmask_b32 v224, v228, v224, vcc
v_mfma_f32_16x16x32_bf16 v[140:143], v[48:51], v[84:87], v[140:143]
v_perm_b32 v110, v77, v76, v37
v_perm_b32 v111, v79, v78, v37
ds_read_b64_tr_b16 v[48:49], v10 offset:34816
buffer_load_dwordx4 v7, s[8:11], s41 offen offset:3072 lds
s_waitcnt lgkmcnt(5)
v_mfma_f32_16x16x32_bf16 v[156:159], v[52:55], v[84:87], v[156:159]
v_perm_b32 v98, v81, v80, v36
v_perm_b32 v99, v83, v82, v36
ds_read_b64_tr_b16 v[50:51], v10 offset:35840
s_and_b32 s98, s96, 15
s_lshr_b64 s[96:97], s[96:97], 4
s_lshl_b32 s40, s98, 7
s_mul_i32 s41, s98, s46
v_mfma_f32_16x16x32_bf16 v[152:155], v[52:55], v[80:83], v[152:155]
v_perm_b32 v114, v81, v80, v37
v_perm_b32 v115, v83, v82, v37
v_mfma_f32_16x16x32_bf16 v[148:151], v[52:55], v[76:79], v[148:151]
v_perm_b32 v102, v85, v84, v36
v_perm_b32 v103, v87, v86, v36
v_mfma_f32_16x16x32_bf16 v[144:147], v[52:55], v[72:75], v[144:147]
v_perm_b32 v118, v85, v84, v37
v_perm_b32 v119, v87, v86, v37
ds_read_b64_tr_b16 v[52:53], v11 offset:34816
ds_read_b64_tr_b16 v[54:55], v11 offset:35840
s_waitcnt vmcnt(6)
s_barrier
s_waitcnt lgkmcnt(6)
v_cndmask_b32 v40, v40, v38, s[56:57]
v_cndmask_b32 v41, v41, v38, s[56:57]
v_cndmask_b32 v42, v42, v38, s[56:57]
v_cndmask_b32 v43, v43, v38, s[56:57]
s_nop 1
v_mfma_f32_16x16x32_bf16 v[160:163], v[88:91], v[40:43], v[160:163]
ds_read_b128 v[56:59], v16 offset:32768
s_add_u32 m0, s42, 16384
v_cvt_pk_bf16_f32 v225, v224, v224
v_mfma_f32_16x16x32_bf16 v[164:167], v[92:95], v[40:43], v[164:167]
ds_read_b128 v[60:63], v16 offset:34816
buffer_load_dwordx4 v2, s[4:7], s40 offen offset:0 lds
v_lshlrev_b32 v225, 16, v225
v_mfma_f32_16x16x32_bf16 v[168:171], v[96:99], v[40:43], v[168:171]
ds_read_b128 v[64:67], v16 offset:36864
v_sub_f32 v225, v224, v225
v_mfma_f32_16x16x32_bf16 v[172:175], v[100:103], v[40:43], v[172:175]
ds_read_b64_tr_b16 v[40:41], v12 offset:0
s_waitcnt lgkmcnt(8)
v_mfma_f32_16x16x32_bf16 v[188:191], v[100:103], v[44:47], v[188:191]
ds_read_b64_tr_b16 v[42:43], v12 offset:1792
v_cvt_pk_bf16_f32 v225, v224, v225
v_mfma_f32_16x16x32_bf16 v[184:187], v[96:99], v[44:47], v[184:187]
ds_read_b128 v[68:71], v16 offset:38912
buffer_store_dword v225, v20, s[12:15], s73 offen sc0 sc1
v_mfma_f32_16x16x32_bf16 v[180:183], v[92:95], v[44:47], v[180:183]
ds_read_b128 v[72:75], v17 offset:32768
buffer_load_dwordx4 v3, s[4:7], s40 offen offset:1024 lds
s_nop 0
v_add_f32_dpp v28, v28, v28 quad_perm:[1,0,3,2] row_mask:0xf bank_mask:0xf
v_mfma_f32_16x16x32_bf16 v[176:179], v[88:91], v[44:47], v[176:179]
ds_read_b64_tr_b16 v[44:45], v13 offset:0
s_nop 0
v_add_f32_dpp v29, v29, v29 quad_perm:[1,0,3,2] row_mask:0xf bank_mask:0xf
s_waitcnt lgkmcnt(10)
v_cndmask_b32 v48, v48, v39, s[56:57]
v_cndmask_b32 v49, v49, v39, s[56:57]
v_cndmask_b32 v50, v50, v39, s[56:57]
v_cndmask_b32 v51, v51, v39, s[56:57]
s_nop 1
v_mfma_f32_16x16x32_bf16 v[192:195], v[104:107], v[48:51], v[192:195]
ds_read_b64_tr_b16 v[46:47], v13 offset:1792
s_nop 0
v_add_f32_dpp v28, v28, v28 quad_perm:[2,3,0,1] row_mask:0xf bank_mask:0xf
v_mfma_f32_16x16x32_bf16 v[196:199], v[108:111], v[48:51], v[196:199]
ds_read_b128 v[76:79], v17 offset:34816
s_nop 0
v_add_f32_dpp v29, v29, v29 quad_perm:[2,3,0,1] row_mask:0xf bank_mask:0xf
v_mfma_f32_16x16x32_bf16 v[200:203], v[112:115], v[48:51], v[200:203]
ds_read_b128 v[80:83], v17 offset:36864
s_add_u32 m0, s43, 32768
s_nop 0
v_add_f32_dpp v28, v28, v28 row_half_mirror row_mask:0xf bank_mask:0xf
v_mfma_f32_16x16x32_bf16 v[204:207], v[116:119], v[48:51], v[204:207]
ds_read_b64_tr_b16 v[48:49], v12 offset:14336
buffer_load_dwordx4 v4, s[8:11], s41 offen offset:0 lds
s_nop 0
v_add_f32_dpp v29, v29, v29 row_half_mirror row_mask:0xf bank_mask:0xf
s_waitcnt lgkmcnt(12)
v_mfma_f32_16x16x32_bf16 v[220:223], v[116:119], v[52:55], v[220:223]
ds_read_b64_tr_b16 v[50:51], v12 offset:16128
s_nop 0
v_add_f32_dpp v28, v28, v28 row_mirror row_mask:0xf bank_mask:0xf
v_mfma_f32_16x16x32_bf16 v[216:219], v[112:115], v[52:55], v[216:219]
ds_read_b128 v[84:87], v17 offset:38912
s_nop 0
v_add_f32_dpp v29, v29, v29 row_mirror row_mask:0xf bank_mask:0xf
v_mfma_f32_16x16x32_bf16 v[212:215], v[108:111], v[52:55], v[212:215]
s_nop 0
v_add_f32_dpp v28, v28, v28 row_bcast:15 row_mask:0xa bank_mask:0xf
v_mfma_f32_16x16x32_bf16 v[208:211], v[104:107], v[52:55], v[208:211]
ds_read_b64_tr_b16 v[52:53], v13 offset:14336
ds_read_b64_tr_b16 v[54:55], v13 offset:16128
s_waitcnt lgkmcnt(10)
v_mfma_f32_16x16x32_bf16 v[128:131], v[40:43], v[56:59], v[128:131]
v_perm_b32 v88, v57, v56, v36
v_perm_b32 v89, v59, v58, v36
v_mfma_f32_16x16x32_bf16 v[132:135], v[40:43], v[60:63], v[132:135]
v_perm_b32 v104, v57, v56, v37
v_perm_b32 v105, v59, v58, v37
buffer_load_dwordx4 v5, s[8:11], s41 offen offset:1024 lds
v_mfma_f32_16x16x32_bf16 v[136:139], v[40:43], v[64:67], v[136:139]
v_perm_b32 v92, v61, v60, v36
v_perm_b32 v93, v63, v62, v36
s_nop 0
v_add_f32_dpp v29, v29, v29 row_bcast:15 row_mask:0xa bank_mask:0xf
v_mfma_f32_16x16x32_bf16 v[140:143], v[40:43], v[68:71], v[140:143]
v_perm_b32 v108, v61, v60, v37
v_perm_b32 v109, v63, v62, v37
ds_read_b64_tr_b16 v[40:41], v14 offset:0
s_waitcnt lgkmcnt(8)
v_mfma_f32_16x16x32_bf16 v[156:159], v[44:47], v[68:71], v[156:159]
v_perm_b32 v96, v65, v64, v36
v_perm_b32 v97, v67, v66, v36
ds_read_b64_tr_b16 v[42:43], v14 offset:1024
v_mfma_f32_16x16x32_bf16 v[152:155], v[44:47], v[64:67], v[152:155]
v_perm_b32 v112, v65, v64, v37
v_perm_b32 v113, v67, v66, v37
v_mfma_f32_16x16x32_bf16 v[148:151], v[44:47], v[60:63], v[148:151]
v_perm_b32 v100, v69, v68, v36
v_perm_b32 v101, v71, v70, v36
buffer_load_dwordx4 v6, s[8:11], s41 offen offset:2048 lds
s_nop 0
v_add_f32_dpp v28, v28, v28 row_bcast:31 row_mask:0xc bank_mask:0xf
v_mfma_f32_16x16x32_bf16 v[144:147], v[44:47], v[56:59], v[144:147]
v_perm_b32 v116, v69, v68, v37
v_perm_b32 v117, v71, v70, v37
ds_read_b64_tr_b16 v[44:45], v15 offset:0
s_waitcnt lgkmcnt(5)
v_mfma_f32_16x16x32_bf16 v[128:131], v[48:51], v[72:75], v[128:131]
v_perm_b32 v90, v73, v72, v36
v_perm_b32 v91, v75, v74, v36
ds_read_b64_tr_b16 v[46:47], v15 offset:1024
v_mfma_f32_16x16x32_bf16 v[132:135], v[48:51], v[76:79], v[132:135]
v_perm_b32 v106, v73, v72, v37
v_perm_b32 v107, v75, v74, v37
v_mfma_f32_16x16x32_bf16 v[136:139], v[48:51], v[80:83], v[136:139]
v_perm_b32 v94, v77, v76, v36
v_perm_b32 v95, v79, v78, v36
s_nop 0
v_add_f32_dpp v29, v29, v29 row_bcast:31 row_mask:0xc bank_mask:0xf
v_mfma_f32_16x16x32_bf16 v[140:143], v[48:51], v[84:87], v[140:143]
v_perm_b32 v110, v77, v76, v37
v_perm_b32 v111, v79, v78, v37
ds_read_b64_tr_b16 v[48:49], v14 offset:2048
buffer_load_dwordx4 v7, s[8:11], s41 offen offset:3072 lds
s_waitcnt lgkmcnt(5)
v_mfma_f32_16x16x32_bf16 v[156:159], v[52:55], v[84:87], v[156:159]
v_perm_b32 v98, v81, v80, v36
v_perm_b32 v99, v83, v82, v36
ds_read_b64_tr_b16 v[50:51], v14 offset:3072
s_and_b32 s98, s96, 15
s_lshr_b64 s[96:97], s[96:97], 4
s_lshl_b32 s40, s98, 7
s_mul_i32 s41, s98, s46
v_mfma_f32_16x16x32_bf16 v[152:155], v[52:55], v[80:83], v[152:155]
v_perm_b32 v114, v81, v80, v37
v_perm_b32 v115, v83, v82, v37
v_mfma_f32_16x16x32_bf16 v[148:151], v[52:55], v[76:79], v[148:151]
v_perm_b32 v102, v85, v84, v36
v_perm_b32 v103, v87, v86, v36
v_mfma_f32_16x16x32_bf16 v[144:147], v[52:55], v[72:75], v[144:147]
v_perm_b32 v118, v85, v84, v37
v_perm_b32 v119, v87, v86, v37
ds_read_b64_tr_b16 v[52:53], v15 offset:2048
ds_read_b64_tr_b16 v[54:55], v15 offset:3072
s_waitcnt vmcnt(7)
s_barrier
s_waitcnt lgkmcnt(6)
v_cndmask_b32 v40, v40, v38, s[56:57]
v_cndmask_b32 v41, v41, v38, s[56:57]
v_cndmask_b32 v42, v42, v38, s[56:57]
v_cndmask_b32 v43, v43, v38, s[56:57]
s_nop 1
v_mfma_f32_16x16x32_bf16 v[160:163], v[88:91], v[40:43], v[160:163]
ds_read_b128 v[56:59], v16 offset:0
s_add_u32 m0, s42, 32768
v_mul_f32 v28, 0x3a800000, v28
v_mfma_f32_16x16x32_bf16 v[164:167], v[92:95], v[40:43], v[164:167]
ds_read_b128 v[60:63], v16 offset:2048
buffer_load_dwordx4 v2, s[4:7], s40 offen offset:0 lds
v_mul_f32 v29, 0x3a800000, v29
v_mfma_f32_16x16x32_bf16 v[168:171], v[96:99], v[40:43], v[168:171]
ds_read_b128 v[64:67], v16 offset:4096
v_fma_f32 v29, -v28, v28, v29
v_mfma_f32_16x16x32_bf16 v[172:175], v[100:103], v[40:43], v[172:175]
ds_read_b64_tr_b16 v[40:41], v8 offset:0
v_cvt_pk_bf16_f32 v29, v29, v29
s_waitcnt lgkmcnt(8)
v_mfma_f32_16x16x32_bf16 v[188:191], v[100:103], v[44:47], v[188:191]
ds_read_b64_tr_b16 v[42:43], v8 offset:1792
v_lshlrev_b32 v29, 16, v29
v_mfma_f32_16x16x32_bf16 v[184:187], v[96:99], v[44:47], v[184:187]
ds_read_b128 v[68:71], v16 offset:6144
v_add_f32 v29, 0x3727c5ac, v29
v_mfma_f32_16x16x32_bf16 v[180:183], v[92:95], v[44:47], v[180:183]
ds_read_b128 v[72:75], v17 offset:0
buffer_load_dwordx4 v3, s[4:7], s40 offen offset:1024 lds
v_cvt_pk_bf16_f32 v29, v29, v29
v_mfma_f32_16x16x32_bf16 v[176:179], v[88:91], v[44:47], v[176:179]
ds_read_b64_tr_b16 v[44:45], v9 offset:0
s_waitcnt lgkmcnt(10)
v_cndmask_b32 v48, v48, v39, s[56:57]
v_cndmask_b32 v49, v49, v39, s[56:57]
v_cndmask_b32 v50, v50, v39, s[56:57]
v_cndmask_b32 v51, v51, v39, s[56:57]
s_nop 1
v_mfma_f32_16x16x32_bf16 v[192:195], v[104:107], v[48:51], v[192:195]
ds_read_b64_tr_b16 v[46:47], v9 offset:1792
v_lshlrev_b32 v29, 16, v29
v_mfma_f32_16x16x32_bf16 v[196:199], v[108:111], v[48:51], v[196:199]
ds_read_b128 v[76:79], v17 offset:2048
v_sqrt_f32 v29, v29
v_mfma_f32_16x16x32_bf16 v[200:203], v[112:115], v[48:51], v[200:203]
ds_read_b128 v[80:83], v17 offset:4096
s_add_u32 m0, s43, 65536
v_cvt_pk_bf16_f32 v32, -v28, -v28
v_mfma_f32_16x16x32_bf16 v[204:207], v[116:119], v[48:51], v[204:207]
ds_read_b64_tr_b16 v[48:49], v8 offset:14336
buffer_load_dwordx4 v4, s[8:11], s41 offen offset:0 lds
v_cvt_pk_bf16_f32 v28, v28, v28
s_waitcnt lgkmcnt(12)
v_mfma_f32_16x16x32_bf16 v[220:223], v[116:119], v[52:55], v[220:223]
ds_read_b64_tr_b16 v[50:51], v8 offset:16128
v_lshlrev_b32 v28, 16, v28
v_mfma_f32_16x16x32_bf16 v[216:219], v[112:115], v[52:55], v[216:219]
ds_read_b128 v[84:87], v17 offset:6144
v_cvt_pk_bf16_f32 v29, v29, v29
v_mfma_f32_16x16x32_bf16 v[212:215], v[108:111], v[52:55], v[212:215]
v_lshlrev_b32 v29, 16, v29
v_mfma_f32_16x16x32_bf16 v[208:211], v[104:107], v[52:55], v[208:211]
ds_read_b64_tr_b16 v[52:53], v9 offset:14336
ds_read_b64_tr_b16 v[54:55], v9 offset:16128
v_rcp_f32 v29, v29
s_waitcnt lgkmcnt(10)
v_mfma_f32_16x16x32_bf16 v[128:131], v[40:43], v[56:59], v[128:131]
v_perm_b32 v88, v57, v56, v36
v_perm_b32 v89, v59, v58, v36
v_mfma_f32_16x16x32_bf16 v[132:135], v[40:43], v[60:63], v[132:135]
v_perm_b32 v104, v57, v56, v37
v_perm_b32 v105, v59, v58, v37
buffer_load_dwordx4 v5, s[8:11], s41 offen offset:1024 lds
v_mfma_f32_16x16x32_bf16 v[136:139], v[40:43], v[64:67], v[136:139]
v_perm_b32 v92, v61, v60, v36
v_perm_b32 v93, v63, v62, v36
v_mov_b32 v30, s3
v_mfma_f32_16x16x32_bf16 v[140:143], v[40:43], v[68:71], v[140:143]
v_perm_b32 v108, v61, v60, v37
v_perm_b32 v109, v63, v62, v37
ds_read_b64_tr_b16 v[40:41], v10 offset:0
s_waitcnt lgkmcnt(8)
v_mfma_f32_16x16x32_bf16 v[156:159], v[44:47], v[68:71], v[156:159]
v_perm_b32 v96, v65, v64, v36
v_perm_b32 v97, v67, v66, v36
ds_read_b64_tr_b16 v[42:43], v10 offset:1024
v_mfma_f32_16x16x32_bf16 v[152:155], v[44:47], v[64:67], v[152:155]
v_perm_b32 v112, v65, v64, v37
v_perm_b32 v113, v67, v66, v37
v_mfma_f32_16x16x32_bf16 v[148:151], v[44:47], v[60:63], v[148:151]
v_perm_b32 v100, v69, v68, v36
v_perm_b32 v101, v71, v70, v36
buffer_load_dwordx4 v6, s[8:11], s41 offen offset:2048 lds
s_mov_b32 exec_lo, 0
s_brev_b32 exec_hi, 1
buffer_store_dword v32, v19, s[12:15], s36 offen sc0 sc1
buffer_store_dword v28, v19, s[12:15], s38 offen sc0 sc1
buffer_store_dword v29, v19, s[12:15], s37 offen sc0 sc1
buffer_store_dword v30, v19, s[12:15], s48 offen offset:96 sc0 sc1
s_add_u32 s36, s36, 0x4000
buffer_store_dword v29, v19, s[12:15], s36 offen sc0 sc1
s_mov_b64 exec, -1
v_mfma_f32_16x16x32_bf16 v[144:147], v[44:47], v[56:59], v[144:147]
v_perm_b32 v116, v69, v68, v37
v_perm_b32 v117, v71, v70, v37
ds_read_b64_tr_b16 v[44:45], v11 offset:0
s_waitcnt lgkmcnt(5)
v_mfma_f32_16x16x32_bf16 v[128:131], v[48:51], v[72:75], v[128:131]
v_perm_b32 v90, v73, v72, v36
v_perm_b32 v91, v75, v74, v36
ds_read_b64_tr_b16 v[46:47], v11 offset:1024
v_mfma_f32_16x16x32_bf16 v[132:135], v[48:51], v[76:79], v[132:135]
v_perm_b32 v106, v73, v72, v37
v_perm_b32 v107, v75, v74, v37
v_mfma_f32_16x16x32_bf16 v[136:139], v[48:51], v[80:83], v[136:139]
v_perm_b32 v94, v77, v76, v36
v_perm_b32 v95, v79, v78, v36
v_mfma_f32_16x16x32_bf16 v[140:143], v[48:51], v[84:87], v[140:143]
v_perm_b32 v110, v77, v76, v37
v_perm_b32 v111, v79, v78, v37
ds_read_b64_tr_b16 v[48:49], v10 offset:2048
buffer_load_dwordx4 v7, s[8:11], s41 offen offset:3072 lds
s_waitcnt lgkmcnt(5)
v_mfma_f32_16x16x32_bf16 v[156:159], v[52:55], v[84:87], v[156:159]
v_perm_b32 v98, v81, v80, v36
v_perm_b32 v99, v83, v82, v36
ds_read_b64_tr_b16 v[50:51], v10 offset:3072
s_and_b32 s98, s96, 15
s_lshr_b64 s[96:97], s[96:97], 4
s_lshl_b32 s40, s98, 7
s_mul_i32 s41, s98, s46
v_mfma_f32_16x16x32_bf16 v[152:155], v[52:55], v[80:83], v[152:155]
v_perm_b32 v114, v81, v80, v37
v_perm_b32 v115, v83, v82, v37
v_mfma_f32_16x16x32_bf16 v[148:151], v[52:55], v[76:79], v[148:151]
v_perm_b32 v102, v85, v84, v36
v_perm_b32 v103, v87, v86, v36
v_mfma_f32_16x16x32_bf16 v[144:147], v[52:55], v[72:75], v[144:147]
v_perm_b32 v118, v85, v84, v37
v_perm_b32 v119, v87, v86, v37
ds_read_b64_tr_b16 v[52:53], v11 offset:2048
ds_read_b64_tr_b16 v[54:55], v11 offset:3072
s_mov_b32 s44, 3
.p2align 3
LS_loop:
s_waitcnt vmcnt(6)
s_barrier
s_waitcnt lgkmcnt(6)
v_cndmask_b32 v40, v40, v38, s[56:57]
v_cndmask_b32 v41, v41, v38, s[56:57]
v_cndmask_b32 v42, v42, v38, s[56:57]
v_cndmask_b32 v43, v43, v38, s[56:57]
s_nop 1
v_mfma_f32_16x16x32_bf16 v[160:163], v[88:91], v[40:43], v[160:163]
ds_read_b128 v[56:59], v16 offset:16384
s_add_u32 m0, s42, 0
v_mfma_f32_16x16x32_bf16 v[164:167], v[92:95], v[40:43], v[164:167]
ds_read_b128 v[60:63], v16 offset:18432
buffer_load_dwordx4 v2, s[4:7], s40 offen offset:0 lds
v_mfma_f32_16x16x32_bf16 v[168:171], v[96:99], v[40:43], v[168:171]
ds_read_b128 v[64:67], v16 offset:20480
v_mfma_f32_16x16x32_bf16 v[172:175], v[100:103], v[40:43], v[172:175]
ds_read_b64_tr_b16 v[40:41], v8 offset:32768
s_waitcnt lgkmcnt(8)
v_mfma_f32_16x16x32_bf16 v[188:191], v[100:103], v[44:47], v[188:191]
ds_read_b64_tr_b16 v[42:43], v8 offset:34560
v_mfma_f32_16x16x32_bf16 v[184:187], v[96:99], v[44:47], v[184:187]
ds_read_b128 v[68:71], v16 offset:22528
v_mfma_f32_16x16x32_bf16 v[180:183], v[92:95], v[44:47], v[180:183]
ds_read_b128 v[72:75], v17 offset:16384
buffer_load_dwordx4 v3, s[4:7], s40 offen offset:1024 lds
v_mfma_f32_16x16x32_bf16 v[176:179], v[88:91], v[44:47], v[176:179]
ds_read_b64_tr_b16 v[44:45], v9 offset:32768
s_waitcnt lgkmcnt(10)
v_cndmask_b32 v48, v48, v39, s[56:57]
v_cndmask_b32 v49, v49, v39, s[56:57]
v_cndmask_b32 v50, v50, v39, s[56:57]
v_cndmask_b32 v51, v51, v39, s[56:57]
s_nop 1
v_mfma_f32_16x16x32_bf16 v[192:195], v[104:107], v[48:51], v[192:195]
ds_read_b64_tr_b16 v[46:47], v9 offset:34560
v_mfma_f32_16x16x32_bf16 v[196:199], v[108:111], v[48:51], v[196:199]
ds_read_b128 v[76:79], v17 offset:18432
v_mfma_f32_16x16x32_bf16 v[200:203], v[112:115], v[48:51], v[200:203]
ds_read_b128 v[80:83], v17 offset:20480
s_add_u32 m0, s43, 0
v_mfma_f32_16x16x32_bf16 v[204:207], v[116:119], v[48:51], v[204:207]
ds_read_b64_tr_b16 v[48:49], v8 offset:47104
buffer_load_dwordx4 v4, s[8:11], s41 offen offset:0 lds
s_waitcnt lgkmcnt(12)
v_mfma_f32_16x16x32_bf16 v[220:223], v[116:119], v[52:55], v[220:223]
ds_read_b64_tr_b16 v[50:51], v8 offset:48896
v_mfma_f32_16x16x32_bf16 v[216:219], v[112:115], v[52:55], v[216:219]
ds_read_b128 v[84:87], v17 offset:22528
v_mfma_f32_16x16x32_bf16 v[212:215], v[108:111], v[52:55], v[212:215]
v_mfma_f32_16x16x32_bf16 v[208:211], v[104:107], v[52:55], v[208:211]
ds_read_b64_tr_b16 v[52:53], v9 offset:47104
ds_read_b64_tr_b16 v[54:55], v9 offset:48896
s_waitcnt lgkmcnt(10)
v_mfma_f32_16x16x32_bf16 v[128:131], v[40:43], v[56:59], v[128:131]
v_perm_b32 v88, v57, v56, v36
v_perm_b32 v89, v59, v58, v36
v_mfma_f32_16x16x32_bf16 v[132:135], v[40:43], v[60:63], v[132:135]
v_perm_b32 v104, v57, v56, v37
v_perm_b32 v105, v59, v58, v37
buffer_load_dwordx4 v5, s[8:11], s41 offen offset:1024 lds
v_mfma_f32_16x16x32_bf16 v[136:139], v[40:43], v[64:67], v[136:139]
v_perm_b32 v92, v61, v60, v36
v_perm_b32 v93, v63, v62, v36
v_mfma_f32_16x16x32_bf16 v[140:143], v[40:43], v[68:71], v[140:143]
v_perm_b32 v108, v61, v60, v37
v_perm_b32 v109, v63, v62, v37
ds_read_b64_tr_b16 v[40:41], v10 offset:32768
s_waitcnt lgkmcnt(8)
v_mfma_f32_16x16x32_bf16 v[156:159], v[44:47], v[68:71], v[156:159]
v_perm_b32 v96, v65, v64, v36
v_perm_b32 v97, v67, v66, v36
ds_read_b64_tr_b16 v[42:43], v10 offset:33792
v_mfma_f32_16x16x32_bf16 v[152:155], v[44:47], v[64:67], v[152:155]
v_perm_b32 v112, v65, v64, v37
v_perm_b32 v113, v67, v66, v37
v_mfma_f32_16x16x32_bf16 v[148:151], v[44:47], v[60:63], v[148:151]
v_perm_b32 v100, v69, v68, v36
v_perm_b32 v101, v71, v70, v36
buffer_load_dwordx4 v6, s[8:11], s41 offen offset:2048 lds
v_mfma_f32_16x16x32_bf16 v[144:147], v[44:47], v[56:59], v[144:147]
v_perm_b32 v116, v69, v68, v37
v_perm_b32 v117, v71, v70, v37
ds_read_b64_tr_b16 v[44:45], v11 offset:32768
s_waitcnt lgkmcnt(5)
v_mfma_f32_16x16x32_bf16 v[128:131], v[48:51], v[72:75], v[128:131]
v_perm_b32 v90, v73, v72, v36
v_perm_b32 v91, v75, v74, v36
ds_read_b64_tr_b16 v[46:47], v11 offset:33792
v_mfma_f32_16x16x32_bf16 v[132:135], v[48:51], v[76:79], v[132:135]
v_perm_b32 v106, v73, v72, v37
v_perm_b32 v107, v75, v74, v37
v_mfma_f32_16x16x32_bf16 v[136:139], v[48:51], v[80:83], v[136:139]
v_perm_b32 v94, v77, v76, v36
v_perm_b32 v95, v79, v78, v36
v_mfma_f32_16x16x32_bf16 v[140:143], v[48:51], v[84:87], v[140:143]
v_perm_b32 v110, v77, v76, v37
v_perm_b32 v111, v79, v78, v37
ds_read_b64_tr_b16 v[48:49], v10 offset:34816
buffer_load_dwordx4 v7, s[8:11], s41 offen offset:3072 lds
s_waitcnt lgkmcnt(5)
v_mfma_f32_16x16x32_bf16 v[156:159], v[52:55], v[84:87], v[156:159]
v_perm_b32 v98, v81, v80, v36
v_perm_b32 v99, v83, v82, v36
ds_read_b64_tr_b16 v[50:51], v10 offset:35840
s_and_b32 s98, s96, 15
s_lshr_b64 s[96:97], s[96:97], 4
s_lshl_b32 s40, s98, 7
s_mul_i32 s41, s98, s46
v_mfma_f32_16x16x32_bf16 v[152:155], v[52:55], v[80:83], v[152:155]
v_perm_b32 v114, v81, v80, v37
v_perm_b32 v115, v83, v82, v37
v_mfma_f32_16x16x32_bf16 v[148:151], v[52:55], v[76:79], v[148:151]
v_perm_b32 v102, v85, v84, v36
v_perm_b32 v103, v87, v86, v36
v_mfma_f32_16x16x32_bf16 v[144:147], v[52:55], v[72:75], v[144:147]
v_perm_b32 v118, v85, v84, v37
v_perm_b32 v119, v87, v86, v37
ds_read_b64_tr_b16 v[52:53], v11 offset:34816
ds_read_b64_tr_b16 v[54:55], v11 offset:35840
s_waitcnt vmcnt(6)
s_barrier
s_waitcnt lgkmcnt(6)
v_cndmask_b32 v40, v40, v38, s[56:57]
v_cndmask_b32 v41, v41, v38, s[56:57]
v_cndmask_b32 v42, v42, v38, s[56:57]
v_cndmask_b32 v43, v43, v38, s[56:57]
s_nop 1
v_mfma_f32_16x16x32_bf16 v[160:163], v[88:91], v[40:43], v[160:163]
ds_read_b128 v[56:59], v16 offset:32768
s_add_u32 m0, s42, 16384
v_mfma_f32_16x16x32_bf16 v[164:167], v[92:95], v[40:43], v[164:167]
ds_read_b128 v[60:63], v16 offset:34816
buffer_load_dwordx4 v2, s[4:7], s40 offen offset:0 lds
v_mfma_f32_16x16x32_bf16 v[168:171], v[96:99], v[40:43], v[168:171]
ds_read_b128 v[64:67], v16 offset:36864
v_mfma_f32_16x16x32_bf16 v[172:175], v[100:103], v[40:43], v[172:175]
ds_read_b64_tr_b16 v[40:41], v12 offset:0
s_waitcnt lgkmcnt(8)
v_mfma_f32_16x16x32_bf16 v[188:191], v[100:103], v[44:47], v[188:191]
ds_read_b64_tr_b16 v[42:43], v12 offset:1792
v_mfma_f32_16x16x32_bf16 v[184:187], v[96:99], v[44:47], v[184:187]
ds_read_b128 v[68:71], v16 offset:38912
v_mfma_f32_16x16x32_bf16 v[180:183], v[92:95], v[44:47], v[180:183]
ds_read_b128 v[72:75], v17 offset:32768
buffer_load_dwordx4 v3, s[4:7], s40 offen offset:1024 lds
v_mfma_f32_16x16x32_bf16 v[176:179], v[88:91], v[44:47], v[176:179]
ds_read_b64_tr_b16 v[44:45], v13 offset:0
s_waitcnt lgkmcnt(10)
v_cndmask_b32 v48, v48, v39, s[56:57]
v_cndmask_b32 v49, v49, v39, s[56:57]
v_cndmask_b32 v50, v50, v39, s[56:57]
v_cndmask_b32 v51, v51, v39, s[56:57]
s_nop 1
v_mfma_f32_16x16x32_bf16 v[192:195], v[104:107], v[48:51], v[192:195]
ds_read_b64_tr_b16 v[46:47], v13 offset:1792
v_mfma_f32_16x16x32_bf16 v[196:199], v[108:111], v[48:51], v[196:199]
ds_read_b128 v[76:79], v17 offset:34816
v_mfma_f32_16x16x32_bf16 v[200:203], v[112:115], v[48:51], v[200:203]
ds_read_b128 v[80:83], v17 offset:36864
s_add_u32 m0, s43, 32768
v_mfma_f32_16x16x32_bf16 v[204:207], v[116:119], v[48:51], v[204:207]
ds_read_b64_tr_b16 v[48:49], v12 offset:14336
buffer_load_dwordx4 v4, s[8:11], s41 offen offset:0 lds
s_waitcnt lgkmcnt(12)
v_mfma_f32_16x16x32_bf16 v[220:223], v[116:119], v[52:55], v[220:223]
ds_read_b64_tr_b16 v[50:51], v12 offset:16128
v_mfma_f32_16x16x32_bf16 v[216:219], v[112:115], v[52:55], v[216:219]
ds_read_b128 v[84:87], v17 offset:38912
v_mfma_f32_16x16x32_bf16 v[212:215], v[108:111], v[52:55], v[212:215]
v_mfma_f32_16x16x32_bf16 v[208:211], v[104:107], v[52:55], v[208:211]
ds_read_b64_tr_b16 v[52:53], v13 offset:14336
ds_read_b64_tr_b16 v[54:55], v13 offset:16128
s_waitcnt lgkmcnt(10)
v_mfma_f32_16x16x32_bf16 v[128:131], v[40:43], v[56:59], v[128:131]
v_perm_b32 v88, v57, v56, v36
v_perm_b32 v89, v59, v58, v36
v_mfma_f32_16x16x32_bf16 v[132:135], v[40:43], v[60:63], v[132:135]
v_perm_b32 v104, v57, v56, v37
v_perm_b32 v105, v59, v58, v37
buffer_load_dwordx4 v5, s[8:11], s41 offen offset:1024 lds
v_mfma_f32_16x16x32_bf16 v[136:139], v[40:43], v[64:67], v[136:139]
v_perm_b32 v92, v61, v60, v36
v_perm_b32 v93, v63, v62, v36
v_mfma_f32_16x16x32_bf16 v[140:143], v[40:43], v[68:71], v[140:143]
v_perm_b32 v108, v61, v60, v37
v_perm_b32 v109, v63, v62, v37
ds_read_b64_tr_b16 v[40:41], v14 offset:0
s_waitcnt lgkmcnt(8)
v_mfma_f32_16x16x32_bf16 v[156:159], v[44:47], v[68:71], v[156:159]
v_perm_b32 v96, v65, v64, v36
v_perm_b32 v97, v67, v66, v36
ds_read_b64_tr_b16 v[42:43], v14 offset:1024
v_mfma_f32_16x16x32_bf16 v[152:155], v[44:47], v[64:67], v[152:155]
v_perm_b32 v112, v65, v64, v37
v_perm_b32 v113, v67, v66, v37
v_mfma_f32_16x16x32_bf16 v[148:151], v[44:47], v[60:63], v[148:151]
v_perm_b32 v100, v69, v68, v36
v_perm_b32 v101, v71, v70, v36
buffer_load_dwordx4 v6, s[8:11], s41 offen offset:2048 lds
v_mfma_f32_16x16x32_bf16 v[144:147], v[44:47], v[56:59], v[144:147]
v_perm_b32 v116, v69, v68, v37
v_perm_b32 v117, v71, v70, v37
ds_read_b64_tr_b16 v[44:45], v15 offset:0
s_waitcnt lgkmcnt(5)
v_mfma_f32_16x16x32_bf16 v[128:131], v[48:51], v[72:75], v[128:131]
v_perm_b32 v90, v73, v72, v36
v_perm_b32 v91, v75, v74, v36
ds_read_b64_tr_b16 v[46:47], v15 offset:1024
v_mfma_f32_16x16x32_bf16 v[132:135], v[48:51], v[76:79], v[132:135]
v_perm_b32 v106, v73, v72, v37
v_perm_b32 v107, v75, v74, v37
v_mfma_f32_16x16x32_bf16 v[136:139], v[48:51], v[80:83], v[136:139]
v_perm_b32 v94, v77, v76, v36
v_perm_b32 v95, v79, v78, v36
v_mfma_f32_16x16x32_bf16 v[140:143], v[48:51], v[84:87], v[140:143]
v_perm_b32 v110, v77, v76, v37
v_perm_b32 v111, v79, v78, v37
ds_read_b64_tr_b16 v[48:49], v14 offset:2048
buffer_load_dwordx4 v7, s[8:11], s41 offen offset:3072 lds
s_waitcnt lgkmcnt(5)
v_mfma_f32_16x16x32_bf16 v[156:159], v[52:55], v[84:87], v[156:159]
v_perm_b32 v98, v81, v80, v36
v_perm_b32 v99, v83, v82, v36
ds_read_b64_tr_b16 v[50:51], v14 offset:3072
s_and_b32 s98, s96, 15
s_lshr_b64 s[96:97], s[96:97], 4
s_lshl_b32 s40, s98, 7
s_mul_i32 s41, s98, s46
v_mfma_f32_16x16x32_bf16 v[152:155], v[52:55], v[80:83], v[152:155]
v_perm_b32 v114, v81, v80, v37
v_perm_b32 v115, v83, v82, v37
v_mfma_f32_16x16x32_bf16 v[148:151], v[52:55], v[76:79], v[148:151]
v_perm_b32 v102, v85, v84, v36
v_perm_b32 v103, v87, v86, v36
v_mfma_f32_16x16x32_bf16 v[144:147], v[52:55], v[72:75], v[144:147]
v_perm_b32 v118, v85, v84, v37
v_perm_b32 v119, v87, v86, v37
ds_read_b64_tr_b16 v[52:53], v15 offset:2048
ds_read_b64_tr_b16 v[54:55], v15 offset:3072
s_waitcnt vmcnt(6)
s_barrier
s_waitcnt lgkmcnt(6)
v_cndmask_b32 v40, v40, v38, s[56:57]
v_cndmask_b32 v41, v41, v38, s[56:57]
v_cndmask_b32 v42, v42, v38, s[56:57]
v_cndmask_b32 v43, v43, v38, s[56:57]
s_nop 1
v_mfma_f32_16x16x32_bf16 v[160:163], v[88:91], v[40:43], v[160:163]
ds_read_b128 v[56:59], v16 offset:0
s_add_u32 m0, s42, 32768
v_mfma_f32_16x16x32_bf16 v[164:167], v[92:95], v[40:43], v[164:167]
ds_read_b128 v[60:63], v16 offset:2048
buffer_load_dwordx4 v2, s[4:7], s40 offen offset:0 lds
v_mfma_f32_16x16x32_bf16 v[168:171], v[96:99], v[40:43], v[168:171]
ds_read_b128 v[64:67], v16 offset:4096
v_mfma_f32_16x16x32_bf16 v[172:175], v[100:103], v[40:43], v[172:175]
ds_read_b64_tr_b16 v[40:41], v8 offset:0
s_waitcnt lgkmcnt(8)
v_mfma_f32_16x16x32_bf16 v[188:191], v[100:103], v[44:47], v[188:191]
ds_read_b64_tr_b16 v[42:43], v8 offset:1792
v_mfma_f32_16x16x32_bf16 v[184:187], v[96:99], v[44:47], v[184:187]
ds_read_b128 v[68:71], v16 offset:6144
v_mfma_f32_16x16x32_bf16 v[180:183], v[92:95], v[44:47], v[180:183]
ds_read_b128 v[72:75], v17 offset:0
buffer_load_dwordx4 v3, s[4:7], s40 offen offset:1024 lds
v_mfma_f32_16x16x32_bf16 v[176:179], v[88:91], v[44:47], v[176:179]
ds_read_b64_tr_b16 v[44:45], v9 offset:0
s_waitcnt lgkmcnt(10)
v_cndmask_b32 v48, v48, v39, s[56:57]
v_cndmask_b32 v49, v49, v39, s[56:57]
v_cndmask_b32 v50, v50, v39, s[56:57]
v_cndmask_b32 v51, v51, v39, s[56:57]
s_nop 1
v_mfma_f32_16x16x32_bf16 v[192:195], v[104:107], v[48:51], v[192:195]
ds_read_b64_tr_b16 v[46:47], v9 offset:1792
v_mfma_f32_16x16x32_bf16 v[196:199], v[108:111], v[48:51], v[196:199]
ds_read_b128 v[76:79], v17 offset:2048
v_mfma_f32_16x16x32_bf16 v[200:203], v[112:115], v[48:51], v[200:203]
ds_read_b128 v[80:83], v17 offset:4096
s_add_u32 m0, s43, 65536
v_mfma_f32_16x16x32_bf16 v[204:207], v[116:119], v[48:51], v[204:207]
ds_read_b64_tr_b16 v[48:49], v8 offset:14336
buffer_load_dwordx4 v4, s[8:11], s41 offen offset:0 lds
s_waitcnt lgkmcnt(12)
v_mfma_f32_16x16x32_bf16 v[220:223], v[116:119], v[52:55], v[220:223]
ds_read_b64_tr_b16 v[50:51], v8 offset:16128
v_mfma_f32_16x16x32_bf16 v[216:219], v[112:115], v[52:55], v[216:219]
ds_read_b128 v[84:87], v17 offset:6144
v_mfma_f32_16x16x32_bf16 v[212:215], v[108:111], v[52:55], v[212:215]
v_mfma_f32_16x16x32_bf16 v[208:211], v[104:107], v[52:55], v[208:211]
ds_read_b64_tr_b16 v[52:53], v9 offset:14336
ds_read_b64_tr_b16 v[54:55], v9 offset:16128
s_waitcnt lgkmcnt(10)
v_mfma_f32_16x16x32_bf16 v[128:131], v[40:43], v[56:59], v[128:131]
v_perm_b32 v88, v57, v56, v36
v_perm_b32 v89, v59, v58, v36
v_mfma_f32_16x16x32_bf16 v[132:135], v[40:43], v[60:63], v[132:135]
v_perm_b32 v104, v57, v56, v37
v_perm_b32 v105, v59, v58, v37
buffer_load_dwordx4 v5, s[8:11], s41 offen offset:1024 lds
v_mfma_f32_16x16x32_bf16 v[136:139], v[40:43], v[64:67], v[136:139]
v_perm_b32 v92, v61, v60, v36
v_perm_b32 v93, v63, v62, v36
v_mfma_f32_16x16x32_bf16 v[140:143], v[40:43], v[68:71], v[140:143]
v_perm_b32 v108, v61, v60, v37
v_perm_b32 v109, v63, v62, v37
ds_read_b64_tr_b16 v[40:41], v10 offset:0
s_waitcnt lgkmcnt(8)
v_mfma_f32_16x16x32_bf16 v[156:159], v[44:47], v[68:71], v[156:159]
v_perm_b32 v96, v65, v64, v36
v_perm_b32 v97, v67, v66, v36
ds_read_b64_tr_b16 v[42:43], v10 offset:1024
v_mfma_f32_16x16x32_bf16 v[152:155], v[44:47], v[64:67], v[152:155]
v_perm_b32 v112, v65, v64, v37
v_perm_b32 v113, v67, v66, v37
v_mfma_f32_16x16x32_bf16 v[148:151], v[44:47], v[60:63], v[148:151]
v_perm_b32 v100, v69, v68, v36
v_perm_b32 v101, v71, v70, v36
buffer_load_dwordx4 v6, s[8:11], s41 offen offset:2048 lds
v_mfma_f32_16x16x32_bf16 v[144:147], v[44:47], v[56:59], v[144:147]
v_perm_b32 v116, v69, v68, v37
v_perm_b32 v117, v71, v70, v37
ds_read_b64_tr_b16 v[44:45], v11 offset:0
s_waitcnt lgkmcnt(5)
v_mfma_f32_16x16x32_bf16 v[128:131], v[48:51], v[72:75], v[128:131]
v_perm_b32 v90, v73, v72, v36
v_perm_b32 v91, v75, v74, v36
ds_read_b64_tr_b16 v[46:47], v11 offset:1024
v_mfma_f32_16x16x32_bf16 v[132:135], v[48:51], v[76:79], v[132:135]
v_perm_b32 v106, v73, v72, v37
v_perm_b32 v107, v75, v74, v37
v_mfma_f32_16x16x32_bf16 v[136:139], v[48:51], v[80:83], v[136:139]
v_perm_b32 v94, v77, v76, v36
v_perm_b32 v95, v79, v78, v36
v_mfma_f32_16x16x32_bf16 v[140:143], v[48:51], v[84:87], v[140:143]
v_perm_b32 v110, v77, v76, v37
v_perm_b32 v111, v79, v78, v37
ds_read_b64_tr_b16 v[48:49], v10 offset:2048
buffer_load_dwordx4 v7, s[8:11], s41 offen offset:3072 lds
s_waitcnt lgkmcnt(5)
v_mfma_f32_16x16x32_bf16 v[156:159], v[52:55], v[84:87], v[156:159]
v_perm_b32 v98, v81, v80, v36
v_perm_b32 v99, v83, v82, v36
ds_read_b64_tr_b16 v[50:51], v10 offset:3072
s_and_b32 s98, s96, 15
s_lshr_b64 s[96:97], s[96:97], 4
s_lshl_b32 s40, s98, 7
s_mul_i32 s41, s98, s46
v_mfma_f32_16x16x32_bf16 v[152:155], v[52:55], v[80:83], v[152:155]
v_perm_b32 v114, v81, v80, v37
v_perm_b32 v115, v83, v82, v37
v_mfma_f32_16x16x32_bf16 v[148:151], v[52:55], v[76:79], v[148:151]
v_perm_b32 v102, v85, v84, v36
v_perm_b32 v103, v87, v86, v36
v_mfma_f32_16x16x32_bf16 v[144:147], v[52:55], v[72:75], v[144:147]
v_perm_b32 v118, v85, v84, v37
v_perm_b32 v119, v87, v86, v37
ds_read_b64_tr_b16 v[52:53], v11 offset:2048
ds_read_b64_tr_b16 v[54:55], v11 offset:3072
s_sub_u32 s44, s44, 1
s_cmp_gt_i32 s44, 0
s_cbranch_scc1 LS_loop
s_waitcnt vmcnt(6)
s_barrier
s_waitcnt lgkmcnt(6)
v_cndmask_b32 v40, v40, v38, s[56:57]
v_cndmask_b32 v41, v41, v38, s[56:57]
v_cndmask_b32 v42, v42, v38, s[56:57]
v_cndmask_b32 v43, v43, v38, s[56:57]
s_nop 1
v_mfma_f32_16x16x32_bf16 v[160:163], v[88:91], v[40:43], v[160:163]
ds_read_b128 v[56:59], v16 offset:16384
s_add_u32 m0, s42, 0
v_lshrrev_b32 v25, 4, v1
v_mfma_f32_16x16x32_bf16 v[164:167], v[92:95], v[40:43], v[164:167]
ds_read_b128 v[60:63], v16 offset:18432
buffer_load_dwordx4 v2, s[4:7], s40 offen offset:0 lds
v_and_b32 v24, 15, v1
v_mfma_f32_16x16x32_bf16 v[168:171], v[96:99], v[40:43], v[168:171]
ds_read_b128 v[64:67], v16 offset:20480
v_lshlrev_b32 v24, 4, v24
s_lshr_b32 s98, s28, 2
s_lshl_b32 s99, s98, 14
s_add_u32 s99, s99, s50
s_lshl_b32 s98, s98, 11
s_add_u32 s98, s98, s52
v_mfma_f32_16x16x32_bf16 v[172:175], v[100:103], v[40:43], v[172:175]
ds_read_b64_tr_b16 v[40:41], v8 offset:32768
buffer_load_dwordx4 v3, s[4:7], s40 offen offset:1024 lds
v_lshl_add_u32 v23, v25, 12, v24
s_waitcnt lgkmcnt(8)
v_mfma_f32_16x16x32_bf16 v[188:191], v[100:103], v[44:47], v[188:191]
ds_read_b64_tr_b16 v[42:43], v8 offset:34560
s_lshl_b32 s36, s28, 1
v_mfma_f32_16x16x32_bf16 v[184:187], v[96:99], v[44:47], v[184:187]
ds_read_b128 v[68:71], v16 offset:22528
s_add_u32 m0, s43, 0
s_min_u32 s36, s36, 12
v_mfma_f32_16x16x32_bf16 v[180:183], v[92:95], v[44:47], v[180:183]
ds_read_b128 v[72:75], v17 offset:16384
buffer_load_dwordx4 v4, s[8:11], s41 offen offset:0 lds
s_lshl_b32 s36, s36, 8
v_mfma_f32_16x16x32_bf16 v[176:179], v[88:91], v[44:47], v[176:179]
ds_read_b64_tr_b16 v[44:45], v9 offset:32768
s_add_u32 s73, s72, s36
s_waitcnt lgkmcnt(10)
v_cndmask_b32 v48, v48, v39, s[56:57]
v_cndmask_b32 v49, v49, v39, s[56:57]
v_cndmask_b32 v50, v50, v39, s[56:57]
v_cndmask_b32 v51, v51, v39, s[56:57]
s_nop 1
v_mfma_f32_16x16x32_bf16 v[192:195], v[104:107], v[48:51], v[192:195]
ds_read_b64_tr_b16 v[46:47], v9 offset:34560
s_xor_b32 s74, s73, 512
v_mfma_f32_16x16x32_bf16 v[196:199], v[108:111], v[48:51], v[196:199]
ds_read_b128 v[76:79], v17 offset:18432
buffer_load_dwordx4 v5, s[8:11], s41 offen offset:1024 lds
s_lshl_b32 s36, s29, 1
v_mfma_f32_16x16x32_bf16 v[200:203], v[112:115], v[48:51], v[200:203]
ds_read_b128 v[80:83], v17 offset:20480
s_add_u32 s36, s36, s32
v_mfma_f32_16x16x32_bf16 v[204:207], v[116:119], v[48:51], v[204:207]
ds_read_b64_tr_b16 v[48:49], v8 offset:47104
s_lshl_b32 s75, s36, 8
s_waitcnt lgkmcnt(12)
v_mfma_f32_16x16x32_bf16 v[220:223], v[116:119], v[52:55], v[220:223]
ds_read_b64_tr_b16 v[50:51], v8 offset:48896
buffer_load_dwordx4 v6, s[8:11], s41 offen offset:2048 lds
s_add_u32 s75, s75, 33554432
v_mfma_f32_16x16x32_bf16 v[216:219], v[112:115], v[52:55], v[216:219]
ds_read_b128 v[84:87], v17 offset:22528
s_lshl_b32 s76, s36, 8
v_mfma_f32_16x16x32_bf16 v[212:215], v[108:111], v[52:55], v[212:215]
s_add_u32 s76, s76, 33587200
v_mfma_f32_16x16x32_bf16 v[208:211], v[104:107], v[52:55], v[208:211]
ds_read_b64_tr_b16 v[52:53], v9 offset:47104
ds_read_b64_tr_b16 v[54:55], v9 offset:48896
buffer_load_dwordx4 v7, s[8:11], s41 offen offset:3072 lds
v_lshlrev_b32 v25, 4, v25
s_waitcnt lgkmcnt(10)
v_mfma_f32_16x16x32_bf16 v[128:131], v[40:43], v[56:59], v[128:131]
v_perm_b32 v88, v57, v56, v36
v_perm_b32 v89, v59, v58, v36
v_mfma_f32_16x16x32_bf16 v[132:135], v[40:43], v[60:63], v[132:135]
v_perm_b32 v104, v57, v56, v37
v_perm_b32 v105, v59, v58, v37
v_mfma_f32_16x16x32_bf16 v[136:139], v[40:43], v[64:67], v[136:139]
v_perm_b32 v92, v61, v60, v36
v_perm_b32 v93, v63, v62, v36
buffer_load_dwordx4 v[224:227], v23, s[12:15], s73 offen offset:0 sc0 sc1
v_mfma_f32_16x16x32_bf16 v[140:143], v[40:43], v[68:71], v[140:143]
v_perm_b32 v108, v61, v60, v37
v_perm_b32 v109, v63, v62, v37
ds_read_b64_tr_b16 v[40:41], v10 offset:32768
s_waitcnt lgkmcnt(8)
v_mfma_f32_16x16x32_bf16 v[156:159], v[44:47], v[68:71], v[156:159]
v_perm_b32 v96, v65, v64, v36
v_perm_b32 v97, v67, v66, v36
ds_read_b64_tr_b16 v[42:43], v10 offset:33792
v_mfma_f32_16x16x32_bf16 v[152:155], v[44:47], v[64:67], v[152:155]
v_perm_b32 v112, v65, v64, v37
v_perm_b32 v113, v67, v66, v37
buffer_load_dwordx4 v[228:231], v23, s[12:15], s73 offen offset:256 sc0 sc1
v_mfma_f32_16x16x32_bf16 v[148:151], v[44:47], v[60:63], v[148:151]
v_perm_b32 v100, v69, v68, v36
v_perm_b32 v101, v71, v70, v36
v_mfma_f32_16x16x32_bf16 v[144:147], v[44:47], v[56:59], v[144:147]
v_perm_b32 v116, v69, v68, v37
v_perm_b32 v117, v71, v70, v37
ds_read_b64_tr_b16 v[44:45], v11 offset:32768
s_waitcnt lgkmcnt(5)
v_mfma_f32_16x16x32_bf16 v[128:131], v[48:51], v[72:75], v[128:131]
v_perm_b32 v90, v73, v72, v36
v_perm_b32 v91, v75, v74, v36
ds_read_b64_tr_b16 v[46:47], v11 offset:33792
buffer_load_dwordx4 v[252:255], v24, s[12:15], s75 offen sc0 sc1
v_mfma_f32_16x16x32_bf16 v[132:135], v[48:51], v[76:79], v[132:135]
v_perm_b32 v106, v73, v72, v37
v_perm_b32 v107, v75, v74, v37
v_mfma_f32_16x16x32_bf16 v[136:139], v[48:51], v[80:83], v[136:139]
v_perm_b32 v94, v77, v76, v36
v_perm_b32 v95, v79, v78, v36
s_add_u32 m0, s98, 147456
s_add_u32 s97, s99, 131072
v_mfma_f32_16x16x32_bf16 v[140:143], v[48:51], v[84:87], v[140:143]
v_perm_b32 v110, v77, v76, v37
v_perm_b32 v111, v79, v78, v37
ds_read_b64_tr_b16 v[48:49], v10 offset:34816
buffer_load_dwordx4 v120, s[16:19], s97 offen offset:0 lds
s_waitcnt lgkmcnt(5)
v_mfma_f32_16x16x32_bf16 v[156:159], v[52:55], v[84:87], v[156:159]
v_perm_b32 v98, v81, v80, v36
v_perm_b32 v99, v83, v82, v36
ds_read_b64_tr_b16 v[50:51], v10 offset:35840
v_mfma_f32_16x16x32_bf16 v[152:155], v[52:55], v[80:83], v[152:155]
v_perm_b32 v114, v81, v80, v37
v_perm_b32 v115, v83, v82, v37
v_mfma_f32_16x16x32_bf16 v[148:151], v[52:55], v[76:79], v[148:151]
v_perm_b32 v102, v85, v84, v36
v_perm_b32 v103, v87, v86, v36
buffer_load_dwordx4 v121, s[16:19], s97 offen offset:1024 lds
v_mfma_f32_16x16x32_bf16 v[144:147], v[52:55], v[72:75], v[144:147]
v_perm_b32 v118, v85, v84, v37
v_perm_b32 v119, v87, v86, v37
ds_read_b64_tr_b16 v[52:53], v11 offset:34816
ds_read_b64_tr_b16 v[54:55], v11 offset:35840
s_waitcnt vmcnt(11)
s_barrier
v_bfe_u32 v6, v1, 4, 1
v_lshl_add_u32 v6, v6, 8, v24
s_lshl_b32 s77, s29, 9
s_add_u32 s77, s77, 33570816
s_waitcnt lgkmcnt(6)
v_cndmask_b32 v40, v40, v38, s[56:57]
v_cndmask_b32 v41, v41, v38, s[56:57]
v_cndmask_b32 v42, v42, v38, s[56:57]
v_cndmask_b32 v43, v43, v38, s[56:57]
s_nop 1
v_mfma_f32_16x16x32_bf16 v[160:163], v[88:91], v[40:43], v[160:163]
ds_read_b128 v[56:59], v16 offset:32768
s_add_u32 m0, s98, 114688
s_add_u32 s97, s99, 0
v_mfma_f32_16x16x32_bf16 v[164:167], v[92:95], v[40:43], v[164:167]
ds_read_b128 v[60:63], v16 offset:34816
buffer_load_dwordx4 v120, s[16:19], s97 offen offset:0 lds
v_mfma_f32_16x16x32_bf16 v[168:171], v[96:99], v[40:43], v[168:171]
ds_read_b128 v[64:67], v16 offset:36864
v_mfma_f32_16x16x32_bf16 v[172:175], v[100:103], v[40:43], v[172:175]
ds_read_b64_tr_b16 v[40:41], v12 offset:0
s_waitcnt lgkmcnt(8)
v_mfma_f32_16x16x32_bf16 v[188:191], v[100:103], v[44:47], v[188:191]
ds_read_b64_tr_b16 v[42:43], v12 offset:1792
v_mfma_f32_16x16x32_bf16 v[184:187], v[96:99], v[44:47], v[184:187]
ds_read_b128 v[68:71], v16 offset:38912
v_mfma_f32_16x16x32_bf16 v[180:183], v[92:95], v[44:47], v[180:183]
ds_read_b128 v[72:75], v17 offset:32768
v_mfma_f32_16x16x32_bf16 v[176:179], v[88:91], v[44:47], v[176:179]
ds_read_b64_tr_b16 v[44:45], v13 offset:0
s_waitcnt lgkmcnt(10)
v_cndmask_b32 v48, v48, v39, s[56:57]
v_cndmask_b32 v49, v49, v39, s[56:57]
v_cndmask_b32 v50, v50, v39, s[56:57]
v_cndmask_b32 v51, v51, v39, s[56:57]
s_nop 1
v_mfma_f32_16x16x32_bf16 v[192:195], v[104:107], v[48:51], v[192:195]
ds_read_b64_tr_b16 v[46:47], v13 offset:1792
v_mfma_f32_16x16x32_bf16 v[196:199], v[108:111], v[48:51], v[196:199]
ds_read_b128 v[76:79], v17 offset:34816
buffer_load_dwordx4 v121, s[16:19], s97 offen offset:1024 lds
v_mfma_f32_16x16x32_bf16 v[200:203], v[112:115], v[48:51], v[200:203]
ds_read_b128 v[80:83], v17 offset:36864
v_mfma_f32_16x16x32_bf16 v[204:207], v[116:119], v[48:51], v[204:207]
ds_read_b64_tr_b16 v[48:49], v12 offset:14336
s_waitcnt lgkmcnt(12)
v_mfma_f32_16x16x32_bf16 v[220:223], v[116:119], v[52:55], v[220:223]
ds_read_b64_tr_b16 v[50:51], v12 offset:16128
v_mfma_f32_16x16x32_bf16 v[216:219], v[112:115], v[52:55], v[216:219]
ds_read_b128 v[84:87], v17 offset:38912
v_mfma_f32_16x16x32_bf16 v[212:215], v[108:111], v[52:55], v[212:215]
v_mfma_f32_16x16x32_bf16 v[208:211], v[104:107], v[52:55], v[208:211]
ds_read_b64_tr_b16 v[52:53], v13 offset:14336
ds_read_b64_tr_b16 v[54:55], v13 offset:16128
s_waitcnt lgkmcnt(10)
v_mfma_f32_16x16x32_bf16 v[128:131], v[40:43], v[56:59], v[128:131]
v_perm_b32 v88, v57, v56, v36
v_perm_b32 v89, v59, v58, v36
v_mfma_f32_16x16x32_bf16 v[132:135], v[40:43], v[60:63], v[132:135]
v_perm_b32 v104, v57, v56, v37
v_perm_b32 v105, v59, v58, v37
buffer_load_dword v22, v21, s[12:15], s26 offen offset:32 sc0 sc1
v_mfma_f32_16x16x32_bf16 v[136:139], v[40:43], v[64:67], v[136:139]
v_perm_b32 v92, v61, v60, v36
v_perm_b32 v93, v63, v62, v36
v_mfma_f32_16x16x32_bf16 v[140:143], v[40:43], v[68:71], v[140:143]
v_perm_b32 v108, v61, v60, v37
v_perm_b32 v109, v63, v62, v37
ds_read_b64_tr_b16 v[40:41], v14 offset:0
s_waitcnt lgkmcnt(8)
v_mfma_f32_16x16x32_bf16 v[156:159], v[44:47], v[68:71], v[156:159]
v_perm_b32 v96, v65, v64, v36
v_perm_b32 v97, v67, v66, v36
ds_read_b64_tr_b16 v[42:43], v14 offset:1024
v_mfma_f32_16x16x32_bf16 v[152:155], v[44:47], v[64:67], v[152:155]
v_perm_b32 v112, v65, v64, v37
v_perm_b32 v113, v67, v66, v37
v_mfma_f32_16x16x32_bf16 v[148:151], v[44:47], v[60:63], v[148:151]
v_perm_b32 v100, v69, v68, v36
v_perm_b32 v101, v71, v70, v36
v_mfma_f32_16x16x32_bf16 v[144:147], v[44:47], v[56:59], v[144:147]
v_perm_b32 v116, v69, v68, v37
v_perm_b32 v117, v71, v70, v37
ds_read_b64_tr_b16 v[44:45], v15 offset:0
s_waitcnt lgkmcnt(5)
v_mfma_f32_16x16x32_bf16 v[128:131], v[48:51], v[72:75], v[128:131]
v_perm_b32 v90, v73, v72, v36
v_perm_b32 v91, v75, v74, v36
ds_read_b64_tr_b16 v[46:47], v15 offset:1024
v_mfma_f32_16x16x32_bf16 v[132:135], v[48:51], v[76:79], v[132:135]
v_perm_b32 v106, v73, v72, v37
v_perm_b32 v107, v75, v74, v37
buffer_load_dwordx4 v[2:5], v6, s[12:15], s77 offen sc0 sc1
v_mfma_f32_16x16x32_bf16 v[136:139], v[48:51], v[80:83], v[136:139]
v_perm_b32 v94, v77, v76, v36
v_perm_b32 v95, v79, v78, v36
v_mfma_f32_16x16x32_bf16 v[140:143], v[48:51], v[84:87], v[140:143]
v_perm_b32 v110, v77, v76, v37
v_perm_b32 v111, v79, v78, v37
ds_read_b64_tr_b16 v[48:49], v14 offset:2048
s_waitcnt lgkmcnt(5)
v_mfma_f32_16x16x32_bf16 v[156:159], v[52:55], v[84:87], v[156:159]
v_perm_b32 v98, v81, v80, v36
v_perm_b32 v99, v83, v82, v36
ds_read_b64_tr_b16 v[50:51], v14 offset:3072
v_mfma_f32_16x16x32_bf16 v[152:155], v[52:55], v[80:83], v[152:155]
v_perm_b32 v114, v81, v80, v37
v_perm_b32 v115, v83, v82, v37
v_mfma_f32_16x16x32_bf16 v[148:151], v[52:55], v[76:79], v[148:151]
v_perm_b32 v102, v85, v84, v36
v_perm_b32 v103, v87, v86, v36
v_mfma_f32_16x16x32_bf16 v[144:147], v[52:55], v[72:75], v[144:147]
v_perm_b32 v118, v85, v84, v37
v_perm_b32 v119, v87, v86, v37
ds_read_b64_tr_b16 v[52:53], v15 offset:2048
ds_read_b64_tr_b16 v[54:55], v15 offset:3072
s_waitcnt vmcnt(9)
s_barrier
s_waitcnt lgkmcnt(6)
v_cndmask_b32 v40, v40, v38, s[56:57]
v_cndmask_b32 v41, v41, v38, s[56:57]
v_cndmask_b32 v42, v42, v38, s[56:57]
v_cndmask_b32 v43, v43, v38, s[56:57]
s_nop 1
v_mfma_f32_16x16x32_bf16 v[160:163], v[88:91], v[40:43], v[160:163]
ds_read_b128 v[56:59], v16 offset:0
s_add_u32 m0, s98, 131072
s_add_u32 s97, s99, 262144
v_mfma_f32_16x16x32_bf16 v[164:167], v[92:95], v[40:43], v[164:167]
ds_read_b128 v[60:63], v16 offset:2048
buffer_load_dwordx4 v120, s[16:19], s97 offen offset:0 lds
v_mfma_f32_16x16x32_bf16 v[168:171], v[96:99], v[40:43], v[168:171]
ds_read_b128 v[64:67], v16 offset:4096
v_mfma_f32_16x16x32_bf16 v[172:175], v[100:103], v[40:43], v[172:175]
ds_read_b64_tr_b16 v[40:41], v8 offset:0
s_waitcnt lgkmcnt(8)
v_mfma_f32_16x16x32_bf16 v[188:191], v[100:103], v[44:47], v[188:191]
ds_read_b64_tr_b16 v[42:43], v8 offset:1792
v_mfma_f32_16x16x32_bf16 v[184:187], v[96:99], v[44:47], v[184:187]
ds_read_b128 v[68:71], v16 offset:6144
v_mfma_f32_16x16x32_bf16 v[180:183], v[92:95], v[44:47], v[180:183]
ds_read_b128 v[72:75], v17 offset:0
v_mfma_f32_16x16x32_bf16 v[176:179], v[88:91], v[44:47], v[176:179]
ds_read_b64_tr_b16 v[44:45], v9 offset:0
s_waitcnt lgkmcnt(10)
v_cndmask_b32 v48, v48, v39, s[56:57]
v_cndmask_b32 v49, v49, v39, s[56:57]
v_cndmask_b32 v50, v50, v39, s[56:57]
v_cndmask_b32 v51, v51, v39, s[56:57]
s_nop 1
v_mfma_f32_16x16x32_bf16 v[192:195], v[104:107], v[48:51], v[192:195]
ds_read_b64_tr_b16 v[46:47], v9 offset:1792
s_waitcnt vmcnt(7)
v_mfma_f32_16x16x32_bf16 v[196:199], v[108:111], v[48:51], v[196:199]
ds_read_b128 v[76:79], v17 offset:2048
v_mov_b32 v240, v252
v_mfma_f32_16x16x32_bf16 v[200:203], v[112:115], v[48:51], v[200:203]
ds_read_b128 v[80:83], v17 offset:4096
v_mov_b32 v241, v252
v_mfma_f32_16x16x32_bf16 v[204:207], v[116:119], v[48:51], v[204:207]
ds_read_b64_tr_b16 v[48:49], v8 offset:14336
v_mov_b32 v242, v252
s_waitcnt lgkmcnt(12)
v_mfma_f32_16x16x32_bf16 v[220:223], v[116:119], v[52:55], v[220:223]
ds_read_b64_tr_b16 v[50:51], v8 offset:16128
v_mov_b32 v243, v252
v_mfma_f32_16x16x32_bf16 v[216:219], v[112:115], v[52:55], v[216:219]
ds_read_b128 v[84:87], v17 offset:6144
v_mov_b32 v244, v253
v_mfma_f32_16x16x32_bf16 v[212:215], v[108:111], v[52:55], v[212:215]
v_mov_b32 v245, v253
v_mfma_f32_16x16x32_bf16 v[208:211], v[104:107], v[52:55], v[208:211]
ds_read_b64_tr_b16 v[52:53], v9 offset:14336
ds_read_b64_tr_b16 v[54:55], v9 offset:16128
v_mov_b32 v246, v253
s_waitcnt lgkmcnt(10)
v_mfma_f32_16x16x32_bf16 v[128:131], v[40:43], v[56:59], v[128:131]
v_perm_b32 v88, v57, v56, v36
v_perm_b32 v89, v59, v58, v36
v_mov_b32 v247, v253
v_mfma_f32_16x16x32_bf16 v[132:135], v[40:43], v[60:63], v[132:135]
v_perm_b32 v104, v57, v56, v37
v_perm_b32 v105, v59, v58, v37
buffer_load_dwordx4 v121, s[16:19], s97 offen offset:1024 lds
v_mov_b32 v248, v254
v_mfma_f32_16x16x32_bf16 v[136:139], v[40:43], v[64:67], v[136:139]
v_perm_b32 v92, v61, v60, v36
v_perm_b32 v93, v63, v62, v36
v_mov_b32 v249, v254
v_mfma_f32_16x16x32_bf16 v[140:143], v[40:43], v[68:71], v[140:143]
v_perm_b32 v108, v61, v60, v37
v_perm_b32 v109, v63, v62, v37
ds_read_b64_tr_b16 v[40:41], v10 offset:0
v_mov_b32 v250, v254
s_waitcnt lgkmcnt(8)
v_mfma_f32_16x16x32_bf16 v[156:159], v[44:47], v[68:71], v[156:159]
v_perm_b32 v96, v65, v64, v36
v_perm_b32 v97, v67, v66, v36
ds_read_b64_tr_b16 v[42:43], v10 offset:1024
v_mov_b32 v251, v254
v_mfma_f32_16x16x32_bf16 v[152:155], v[44:47], v[64:67], v[152:155]
v_perm_b32 v112, v65, v64, v37
v_perm_b32 v113, v67, v66, v37
v_mov_b32 v252, v255
v_mfma_f32_16x16x32_bf16 v[148:151], v[44:47], v[60:63], v[148:151]
v_perm_b32 v100, v69, v68, v36
v_perm_b32 v101, v71, v70, v36
v_mov_b32 v253, v255
v_mfma_f32_16x16x32_bf16 v[144:147], v[44:47], v[56:59], v[144:147]
v_perm_b32 v116, v69, v68, v37
v_perm_b32 v117, v71, v70, v37
ds_read_b64_tr_b16 v[44:45], v11 offset:0
v_mov_b32 v254, v255
s_waitcnt lgkmcnt(5)
v_mfma_f32_16x16x32_bf16 v[128:131], v[48:51], v[72:75], v[128:131]
v_perm_b32 v90, v73, v72, v36
v_perm_b32 v91, v75, v74, v36
ds_read_b64_tr_b16 v[46:47], v11 offset:1024
v_mfma_f32_16x16x32_bf16 v[132:135], v[48:51], v[76:79], v[132:135]
v_perm_b32 v106, v73, v72, v37
v_perm_b32 v107, v75, v74, v37
v_mfma_f32_16x16x32_bf16 v[136:139], v[48:51], v[80:83], v[136:139]
v_perm_b32 v94, v77, v76, v36
v_perm_b32 v95, v79, v78, v36
v_mfma_f32_16x16x32_bf16 v[140:143], v[48:51], v[84:87], v[140:143]
v_perm_b32 v110, v77, v76, v37
v_perm_b32 v111, v79, v78, v37
ds_read_b64_tr_b16 v[48:49], v10 offset:2048
s_waitcnt lgkmcnt(5)
v_mfma_f32_16x16x32_bf16 v[156:159], v[52:55], v[84:87], v[156:159]
v_perm_b32 v98, v81, v80, v36
v_perm_b32 v99, v83, v82, v36
ds_read_b64_tr_b16 v[50:51], v10 offset:3072
v_mfma_f32_16x16x32_bf16 v[152:155], v[52:55], v[80:83], v[152:155]
v_perm_b32 v114, v81, v80, v37
v_perm_b32 v115, v83, v82, v37
v_mfma_f32_16x16x32_bf16 v[148:151], v[52:55], v[76:79], v[148:151]
v_perm_b32 v102, v85, v84, v36
v_perm_b32 v103, v87, v86, v36
v_mfma_f32_16x16x32_bf16 v[144:147], v[52:55], v[72:75], v[144:147]
v_perm_b32 v118, v85, v84, v37
v_perm_b32 v119, v87, v86, v37
ds_read_b64_tr_b16 v[52:53], v11 offset:2048
ds_read_b64_tr_b16 v[54:55], v11 offset:3072
s_waitcnt vmcnt(2)
v_cmp_ne_u32 vcc, s3, v22
s_lshl_b32 s39, s30, 3
s_nop 0
s_lshr_b32 s39, vcc_lo, s39
s_and_b32 s39, s39, 0xff
s_cselect_b32 s27, 0, 1
v_mfma_f32_16x16x32_bf16 v[128:131], v[224:227], v[240:243], v[128:131]
s_mul_i32 s36, s29, 917504
s_mul_i32 s37, s34, 14336
v_mfma_f32_16x16x32_bf16 v[132:135], v[224:227], v[244:247], v[132:135]
s_add_u32 s36, s36, s37
s_min_u32 s37, s28, 6
v_mfma_f32_16x16x32_bf16 v[136:139], v[224:227], v[248:251], v[136:139]
s_lshl_b32 s37, s37, 11
s_lshl_b32 s38, s32, 10
v_mfma_f32_16x16x32_bf16 v[140:143], v[224:227], v[252:255], v[140:143]
s_add_u32 s37, s37, s38
v_add_u32 v26, s37, v18
v_mfma_f32_16x16x32_bf16 v[144:147], v[228:231], v[240:243], v[144:147]
v_xor_b32 v27, 2048, v26
s_add_u32 s78, s36, 229376
v_mfma_f32_16x16x32_bf16 v[148:151], v[228:231], v[244:247], v[148:151]
s_add_u32 s79, s36, 458752
s_add_u32 s37, s36, 688128
v_mfma_f32_16x16x32_bf16 v[152:155], v[228:231], v[248:251], v[152:155]
v_add_u32 v28, 32768, v26
v_add_u32 v29, 32768, v27
v_mfma_f32_16x16x32_bf16 v[156:159], v[228:231], v[252:255], v[156:159]
s_cmp_lg_u32 s27, 0
s_cbranch_scc1 LTS_l
s_waitcnt lgkmcnt(6)
v_cndmask_b32 v40, v40, v38, s[56:57]
v_cndmask_b32 v41, v41, v38, s[56:57]
v_cndmask_b32 v42, v42, v38, s[56:57]
v_cndmask_b32 v43, v43, v38, s[56:57]
s_nop 1
v_mfma_f32_16x16x32_bf16 v[160:163], v[88:91], v[40:43], v[160:163]
v_mfma_f32_16x16x32_bf16 v[164:167], v[92:95], v[40:43], v[164:167]
v_mfma_f32_16x16x32_bf16 v[168:171], v[96:99], v[40:43], v[168:171]
v_cvt_pk_bf16_f32 v128, v128, v129
v_cvt_pk_bf16_f32 v129, v130, v131
v_cvt_pk_bf16_f32 v130, v144, v145
v_cvt_pk_bf16_f32 v131, v146, v147
v_pk_max_i16 v128, v128, 0
v_mfma_f32_16x16x32_bf16 v[172:175], v[100:103], v[40:43], v[172:175]
v_pk_max_i16 v129, v129, 0
v_pk_max_i16 v130, v130, 0
v_pk_max_i16 v131, v131, 0
buffer_store_dwordx4 v[128:131], v26, s[12:15], s36 offen sc0 sc1
ds_write_b128 v26, v[128:131] offset:32768
s_waitcnt lgkmcnt(5)
v_mfma_f32_16x16x32_bf16 v[188:191], v[100:103], v[44:47], v[188:191]
v_cvt_pk_bf16_f32 v132, v132, v133
v_cvt_pk_bf16_f32 v133, v134, v135
v_cvt_pk_bf16_f32 v134, v148, v149
v_cvt_pk_bf16_f32 v135, v150, v151
v_pk_max_i16 v132, v132, 0
v_mfma_f32_16x16x32_bf16 v[184:187], v[96:99], v[44:47], v[184:187]
v_pk_max_i16 v133, v133, 0
v_pk_max_i16 v134, v134, 0
v_pk_max_i16 v135, v135, 0
buffer_store_dwordx4 v[132:135], v26, s[12:15], s78 offen sc0 sc1
ds_write_b128 v26, v[132:135] offset:47104
v_mfma_f32_16x16x32_bf16 v[180:183], v[92:95], v[44:47], v[180:183]
v_cvt_pk_bf16_f32 v136, v136, v137
v_cvt_pk_bf16_f32 v137, v138, v139
v_cvt_pk_bf16_f32 v138, v152, v153
v_cvt_pk_bf16_f32 v139, v154, v155
v_pk_max_i16 v136, v136, 0
v_mfma_f32_16x16x32_bf16 v[176:179], v[88:91], v[44:47], v[176:179]
v_pk_max_i16 v137, v137, 0
v_pk_max_i16 v138, v138, 0
v_pk_max_i16 v139, v139, 0
buffer_store_dwordx4 v[136:139], v26, s[12:15], s79 offen sc0 sc1
ds_write_b128 v28, v[136:139] offset:28672
s_waitcnt lgkmcnt(5)
v_cndmask_b32 v48, v48, v39, s[56:57]
v_cndmask_b32 v49, v49, v39, s[56:57]
v_cndmask_b32 v50, v50, v39, s[56:57]
v_cndmask_b32 v51, v51, v39, s[56:57]
s_nop 1
v_mfma_f32_16x16x32_bf16 v[192:195], v[104:107], v[48:51], v[192:195]
v_cvt_pk_bf16_f32 v140, v140, v141
v_cvt_pk_bf16_f32 v141, v142, v143
v_cvt_pk_bf16_f32 v142, v156, v157
v_cvt_pk_bf16_f32 v143, v158, v159
v_pk_max_i16 v140, v140, 0
v_mfma_f32_16x16x32_bf16 v[196:199], v[108:111], v[48:51], v[196:199]
v_pk_max_i16 v141, v141, 0
v_pk_max_i16 v142, v142, 0
v_pk_max_i16 v143, v143, 0
buffer_store_dwordx4 v[140:143], v26, s[12:15], s37 offen sc0 sc1
ds_write_b128 v28, v[140:143] offset:43008
v_mfma_f32_16x16x32_bf16 v[200:203], v[112:115], v[48:51], v[200:203]
v_mfma_f32_16x16x32_bf16 v[204:207], v[116:119], v[48:51], v[204:207]
s_waitcnt lgkmcnt(4)
v_mfma_f32_16x16x32_bf16 v[220:223], v[116:119], v[52:55], v[220:223]
buffer_load_dwordx4 v[56:59], v25, s[12:15], s76 offen offset:0 sc0 sc1
buffer_load_dwordx4 v[60:63], v25, s[12:15], s76 offen offset:64 sc0 sc1
buffer_load_dwordx4 v[64:67], v25, s[12:15], s76 offen offset:128 sc0 sc1
buffer_load_dwordx4 v[68:71], v25, s[12:15], s76 offen offset:192 sc0 sc1
s_add_u32 s76, s76, 8192
v_mfma_f32_16x16x32_bf16 v[216:219], v[112:115], v[52:55], v[216:219]
buffer_load_dwordx4 v[72:75], v25, s[12:15], s76 offen offset:0 sc0 sc1
buffer_load_dwordx4 v[76:79], v25, s[12:15], s76 offen offset:64 sc0 sc1
buffer_load_dwordx4 v[80:83], v25, s[12:15], s76 offen offset:128 sc0 sc1
buffer_load_dwordx4 v[84:87], v25, s[12:15], s76 offen offset:192 sc0 sc1
v_mfma_f32_16x16x32_bf16 v[212:215], v[108:111], v[52:55], v[212:215]
v_mfma_f32_16x16x32_bf16 v[208:211], v[104:107], v[52:55], v[208:211]
s_branch LTS_j
LTS_l:
s_waitcnt lgkmcnt(6)
v_cndmask_b32 v40, v40, v38, s[56:57]
v_cndmask_b32 v41, v41, v38, s[56:57]
v_cndmask_b32 v42, v42, v38, s[56:57]
v_cndmask_b32 v43, v43, v38, s[56:57]
s_nop 1
v_mfma_f32_16x16x32_bf16 v[160:163], v[88:91], v[40:43], v[160:163]
v_mfma_f32_16x16x32_bf16 v[164:167], v[92:95], v[40:43], v[164:167]
v_mfma_f32_16x16x32_bf16 v[168:171], v[96:99], v[40:43], v[168:171]
v_cvt_pk_bf16_f32 v128, v128, v129
v_cvt_pk_bf16_f32 v129, v130, v131
v_cvt_pk_bf16_f32 v130, v144, v145
v_cvt_pk_bf16_f32 v131, v146, v147
v_pk_max_i16 v128, v128, 0
v_mfma_f32_16x16x32_bf16 v[172:175], v[100:103], v[40:43], v[172:175]
v_pk_max_i16 v129, v129, 0
v_pk_max_i16 v130, v130, 0
v_pk_max_i16 v131, v131, 0
buffer_store_dwordx4 v[128:131], v26, s[12:15], s36 offen sc1
ds_write_b128 v26, v[128:131] offset:32768
s_waitcnt lgkmcnt(5)
v_mfma_f32_16x16x32_bf16 v[188:191], v[100:103], v[44:47], v[188:191]
v_cvt_pk_bf16_f32 v132, v132, v133
v_cvt_pk_bf16_f32 v133, v134, v135
v_cvt_pk_bf16_f32 v134, v148, v149
v_cvt_pk_bf16_f32 v135, v150, v151
v_pk_max_i16 v132, v132, 0
v_mfma_f32_16x16x32_bf16 v[184:187], v[96:99], v[44:47], v[184:187]
v_pk_max_i16 v133, v133, 0
v_pk_max_i16 v134, v134, 0
v_pk_max_i16 v135, v135, 0
buffer_store_dwordx4 v[132:135], v26, s[12:15], s78 offen sc1
ds_write_b128 v26, v[132:135] offset:47104
v_mfma_f32_16x16x32_bf16 v[180:183], v[92:95], v[44:47], v[180:183]
v_cvt_pk_bf16_f32 v136, v136, v137
v_cvt_pk_bf16_f32 v137, v138, v139
v_cvt_pk_bf16_f32 v138, v152, v153
v_cvt_pk_bf16_f32 v139, v154, v155
v_pk_max_i16 v136, v136, 0
v_mfma_f32_16x16x32_bf16 v[176:179], v[88:91], v[44:47], v[176:179]
v_pk_max_i16 v137, v137, 0
v_pk_max_i16 v138, v138, 0
v_pk_max_i16 v139, v139, 0
buffer_store_dwordx4 v[136:139], v26, s[12:15], s79 offen sc1
ds_write_b128 v28, v[136:139] offset:28672
s_waitcnt lgkmcnt(5)
v_cndmask_b32 v48, v48, v39, s[56:57]
v_cndmask_b32 v49, v49, v39, s[56:57]
v_cndmask_b32 v50, v50, v39, s[56:57]
v_cndmask_b32 v51, v51, v39, s[56:57]
s_nop 1
v_mfma_f32_16x16x32_bf16 v[192:195], v[104:107], v[48:51], v[192:195]
v_cvt_pk_bf16_f32 v140, v140, v141
v_cvt_pk_bf16_f32 v141, v142, v143
v_cvt_pk_bf16_f32 v142, v156, v157
v_cvt_pk_bf16_f32 v143, v158, v159
v_pk_max_i16 v140, v140, 0
v_mfma_f32_16x16x32_bf16 v[196:199], v[108:111], v[48:51], v[196:199]
v_pk_max_i16 v141, v141, 0
v_pk_max_i16 v142, v142, 0
v_pk_max_i16 v143, v143, 0
buffer_store_dwordx4 v[140:143], v26, s[12:15], s37 offen sc1
ds_write_b128 v28, v[140:143] offset:43008
v_mfma_f32_16x16x32_bf16 v[200:203], v[112:115], v[48:51], v[200:203]
v_mfma_f32_16x16x32_bf16 v[204:207], v[116:119], v[48:51], v[204:207]
s_waitcnt lgkmcnt(4)
v_mfma_f32_16x16x32_bf16 v[220:223], v[116:119], v[52:55], v[220:223]
buffer_load_dwordx4 v[56:59], v25, s[12:15], s76 offen offset:0 sc0 sc1
buffer_load_dwordx4 v[60:63], v25, s[12:15], s76 offen offset:64 sc0 sc1
buffer_load_dwordx4 v[64:67], v25, s[12:15], s76 offen offset:128 sc0 sc1
buffer_load_dwordx4 v[68:71], v25, s[12:15], s76 offen offset:192 sc0 sc1
s_add_u32 s76, s76, 8192
v_mfma_f32_16x16x32_bf16 v[216:219], v[112:115], v[52:55], v[216:219]
buffer_load_dwordx4 v[72:75], v25, s[12:15], s76 offen offset:0 sc0 sc1
buffer_load_dwordx4 v[76:79], v25, s[12:15], s76 offen offset:64 sc0 sc1
buffer_load_dwordx4 v[80:83], v25, s[12:15], s76 offen offset:128 sc0 sc1
buffer_load_dwordx4 v[84:87], v25, s[12:15], s76 offen offset:192 sc0 sc1
v_mfma_f32_16x16x32_bf16 v[212:215], v[108:111], v[52:55], v[212:215]
v_mfma_f32_16x16x32_bf16 v[208:211], v[104:107], v[52:55], v[208:211]
LTS_j:
s_setprio 0
v_lshlrev_b32 v127, 2, v1
v_add_u32 v127, 97792, v127
s_waitcnt lgkmcnt(0)
s_waitcnt vmcnt(12)
s_barrier
s_and_b32 s44, s28, 3
s_waitcnt vmcnt(8)
s_mov_b64 exec, 1
s_cmp_lg_u32 s27, 0
s_cbranch_scc1 LD_hl
buffer_store_dword v0, v19, s[12:15], s48 offen sc0 sc1
s_branch LD_hj
LD_hl:
buffer_store_dword v0, v19, s[12:15], s48 offen
LD_hj:
s_mov_b64 exec, -1
s_mul_i32 s36, s30, 1253376
s_and_b32 s37, s29, 1
s_lshl_b32 s38, s32, 1
s_add_u32 s37, s37, s38
s_mul_i32 s37, s37, 9216
s_add_u32 s36, s36, s37
s_lshr_b32 s37, s29, 1
s_lshl_b32 s37, s37, 10
s_add_u32 s36, s36, s37
s_add_u32 s36, s36, 16777216
v_bfe_u32 v28, v1, 4, 1
v_mul_u32_u24 v28, 626688, v28
v_lshrrev_b32 v29, 5, v1
v_lshl_add_u32 v28, v29, 9, v28
v_add_u32 v28, s36, v28
v_and_b32 v29, 15, v1
v_cmp_eq_u32 vcc, 0, v29
v_lshlrev_b32 v29, 4, v29
s_mul_i32 s37, s31, 36864
s_sub_u32 s38, 552960, s37
v_add3_u32 v20, v28, v29, s37
v_sub_u32 v29, v28, v29
v_add_u32 v29, s38, v29
v_add_u32 v22, 256, v29
v_add_u32 v21, 512, v29
v_add_u32 v29, 36864, v29
v_cndmask_b32 v21, v21, v29, vcc
v_add_u32 v29, 4294008832, v20
v_cndmask_b32 v23, v20, v29, s[56:57]
v_add_u32 v29, 294912, v20
v_cndmask_b32 v24, v21, v29, s[56:57]
v_mov_b32 v130, 1.0
v_cndmask_b32 v130, v130, v19, s[56:57]
v_mov_b32 v131, v130
s_cmp_eq_u32 s34, 0
s_cselect_b32 s37, 0xc4000000, 0
v_mov_b32 v29, s37
v_cndmask_b32 v25, v19, v29, vcc
s_lshl_b32 s39, s30, 31
s_mul_i32 s38, s30, 0x80008000
s_or_b32 s70, s29, s32
s_waitcnt vmcnt(1)
v_fmac_f32 v160, v72, v25
v_fmac_f32 v192, v72, v25
v_fmac_f32 v161, v73, v25
v_fmac_f32 v193, v73, v25
v_fmac_f32 v162, v74, v25
v_fmac_f32 v194, v74, v25
v_fmac_f32 v163, v75, v25
v_fmac_f32 v195, v75, v25
v_fmac_f32 v164, v76, v25
v_fmac_f32 v196, v76, v25
v_fmac_f32 v165, v77, v25
v_fmac_f32 v197, v77, v25
v_fmac_f32 v166, v78, v25
v_fmac_f32 v198, v78, v25
v_fmac_f32 v167, v79, v25
v_fmac_f32 v199, v79, v25
v_fmac_f32 v168, v80, v25
v_fmac_f32 v200, v80, v25
v_fmac_f32 v169, v81, v25
v_fmac_f32 v201, v81, v25
v_fmac_f32 v170, v82, v25
v_fmac_f32 v202, v82, v25
v_fmac_f32 v171, v83, v25
v_fmac_f32 v203, v83, v25
v_fmac_f32 v172, v84, v25
v_fmac_f32 v204, v84, v25
v_fmac_f32 v173, v85, v25
v_fmac_f32 v205, v85, v25
v_fmac_f32 v174, v86, v25
v_fmac_f32 v206, v86, v25
v_fmac_f32 v175, v87, v25
v_fmac_f32 v207, v87, v25
s_cmp_lg_u32 s70, 0
s_cbranch_scc1 LD_nz
v_cmp_gt_u32 s[58:59], 16, v1
v_mov_b32 v132, 0
v_mov_b32 v133, 0
v_mov_b32 v134, 0
v_mov_b32 v135, 0
v_mov_b32 v136, 0
v_mov_b32 v137, 0
v_mov_b32 v138, 0
v_mov_b32 v139, 0
v_mov_b32 v140, 0
v_mov_b32 v141, 0
v_mov_b32 v142, 0
v_mov_b32 v143, 0
v_mov_b32 v144, 0
v_mov_b32 v145, 0
v_mov_b32 v146, 0
v_mov_b32 v147, 0
v_fma_f32 v28, v200, v130, v168
v_fma_f32 v29, v204, v130, v172
v_sub_f32 v30, v168, v200
v_sub_f32 v31, v172, v204
v_mul_f32 v28, v28, v64
v_fmac_f32 v28, v29, v68
v_mul_f32 v30, v30, v64
v_fmac_f32 v30, v31, v68
v_cvt_pk_bf16_f32 v28, v28, v19
v_cvt_pk_bf16_f32 v30, v30, v19
v_cndmask_b32 v132, v19, v28, s[58:59]
v_cndmask_b32 v136, v19, v30, s[58:59]
v_add_f32 v28, v216, v184
v_add_f32 v29, v220, v188
v_sub_f32 v30, v184, v216
v_sub_f32 v31, v188, v220
v_mul_f32 v28, v28, v64
v_fmac_f32 v28, v29, v68
v_mul_f32 v30, v30, v64
v_fmac_f32 v30, v31, v68
v_cvt_pk_bf16_f32 v28, v28, v19
v_cvt_pk_bf16_f32 v30, v30, v19
v_cndmask_b32 v140, v19, v28, s[58:59]
v_cndmask_b32 v144, v19, v30, s[58:59]
s_movk_i32 s36, 8192
buffer_store_dwordx4 v[132:135], v23, s[12:15], s36 offen sc0 sc1
buffer_store_dwordx4 v[136:139], v24, s[12:15], s36 offen sc0 sc1
buffer_store_dwordx4 v[140:143], v20, s[12:15], s36 offen offset:256 sc0 sc1
buffer_store_dwordx4 v[144:147], v22, s[12:15], s36 offen sc0 sc1
LD_nz:
s_cmp_lg_u32 s34, 8
s_cbranch_scc1 LD_ns
v_mov_b32 v28, 0
v_mov_b32 v29, 0
v_mov_b32 v30, 0
v_mov_b32 v31, 0
s_mov_b64 exec, s[56:57]
buffer_store_dwordx4 v[28:31], v20, s[12:15], 0 offen sc0 sc1
buffer_store_dwordx4 v[28:31], v21, s[12:15], 0 offen sc0 sc1
s_mov_b64 exec, -1
LD_ns:
s_cmp_eq_u32 s70, 0
s_cselect_b32 s58, 0xffff, 0
s_mov_b32 s59, 0
v_mov_b32 v40, v56
v_mov_b32 v41, v57
v_mov_b32 v42, v58
v_mov_b32 v43, v59
v_mov_b32 v44, v60
v_mov_b32 v45, v61
v_mov_b32 v46, v62
v_mov_b32 v47, v63
v_mov_b32 v48, v64
v_mov_b32 v49, v65
v_mov_b32 v50, v66
v_mov_b32 v51, v67
v_mov_b32 v52, v68
v_mov_b32 v53, v69
v_mov_b32 v54, v70
v_mov_b32 v55, v71
v_cndmask_b32 v48, v48, v19, s[58:59]
v_cndmask_b32 v52, v52, v19, s[58:59]
s_cmp_eq_u32 s30, 0
s_cbranch_scc1 LD_cos
v_xor_b32 v60, s39, v60
v_xor_b32 v68, s39, v68
v_xor_b32 v61, s39, v61
v_xor_b32 v69, s39, v69
v_xor_b32 v62, s39, v62
v_xor_b32 v70, s39, v70
v_xor_b32 v63, s39, v63
v_xor_b32 v71, s39, v71
v_xor_b32 v28, s39, v64
v_cndmask_b32 v56, v56, v19, s[58:59]
v_cndmask_b32 v60, v60, v19, s[58:59]
v_cndmask_b32 v64, v64, v28, s[58:59]
v_cndmask_b32 v40, v56, v40, s[56:57]
v_cndmask_b32 v41, v57, v41, s[56:57]
v_cndmask_b32 v42, v58, v42, s[56:57]
v_cndmask_b32 v43, v59, v43, s[56:57]
v_cndmask_b32 v44, v60, v44, s[56:57]
v_cndmask_b32 v45, v61, v45, s[56:57]
v_cndmask_b32 v46, v62, v46, s[56:57]
v_cndmask_b32 v47, v63, v47, s[56:57]
v_cndmask_b32 v48, v64, v48, s[56:57]
v_cndmask_b32 v49, v65, v49, s[56:57]
v_cndmask_b32 v50, v66, v50, s[56:57]
v_cndmask_b32 v51, v67, v51, s[56:57]
v_cndmask_b32 v52, v68, v52, s[56:57]
v_cndmask_b32 v53, v69, v53, s[56:57]
v_cndmask_b32 v54, v70, v54, s[56:57]
v_cndmask_b32 v55, v71, v55, s[56:57]
s_branch LD_go
LD_cos:
v_mov_b32 v64, v48
v_mov_b32 v68, v52
LD_go:
v_pk_mul_f32 v[160:161], v[160:161], v[40:41]
v_pk_mul_f32 v[164:165], v[164:165], v[44:45]
v_pk_mul_f32 v[162:163], v[162:163], v[42:43]
v_pk_mul_f32 v[166:167], v[166:167], v[46:47]
v_pk_fma_f32 v[160:161], v[172:173], v[52:53], v[160:161]
v_pk_fma_f32 v[164:165], v[168:169], v[48:49], v[164:165]
v_pk_fma_f32 v[162:163], v[174:175], v[54:55], v[162:163]
v_pk_fma_f32 v[166:167], v[170:171], v[50:51], v[166:167]
v_pk_mul_f32 v[192:193], v[192:193], v[56:57]
v_pk_mul_f32 v[196:197], v[196:197], v[60:61]
v_pk_mul_f32 v[194:195], v[194:195], v[58:59]
v_pk_mul_f32 v[198:199], v[198:199], v[62:63]
v_pk_fma_f32 v[192:193], v[204:205], v[68:69], v[192:193]
v_pk_fma_f32 v[196:197], v[200:201], v[64:65], v[196:197]
v_pk_fma_f32 v[194:195], v[206:207], v[70:71], v[194:195]
v_pk_fma_f32 v[198:199], v[202:203], v[66:67], v[198:199]
v_pk_fma_f32 v[168:169], v[192:193], v[130:131], v[160:161]
v_pk_fma_f32 v[200:201], v[160:161], v[130:131], v[192:193] neg_lo:[0,0,1] neg_hi:[0,0,1]
v_pk_fma_f32 v[170:171], v[194:195], v[130:131], v[162:163]
v_pk_fma_f32 v[202:203], v[162:163], v[130:131], v[194:195] neg_lo:[0,0,1] neg_hi:[0,0,1]
v_pk_fma_f32 v[172:173], v[196:197], v[130:131], v[164:165]
v_pk_fma_f32 v[204:205], v[164:165], v[130:131], v[196:197] neg_lo:[0,0,1] neg_hi:[0,0,1]
v_pk_fma_f32 v[174:175], v[198:199], v[130:131], v[166:167]
v_pk_fma_f32 v[206:207], v[166:167], v[130:131], v[198:199] neg_lo:[0,0,1] neg_hi:[0,0,1]
v_pk_add_f32 v[160:161], v[168:169], v[172:173]
v_pk_add_f32 v[164:165], v[168:169], v[172:173] neg_lo:[0,1] neg_hi:[0,1]
v_pk_add_f32 v[162:163], v[170:171], v[174:175]
v_pk_add_f32 v[166:167], v[170:171], v[174:175] neg_lo:[0,1] neg_hi:[0,1]
v_pk_add_f32 v[192:193], v[200:201], v[204:205]
v_pk_add_f32 v[196:197], v[200:201], v[204:205] neg_lo:[0,1] neg_hi:[0,1]
v_pk_add_f32 v[194:195], v[202:203], v[206:207]
v_pk_add_f32 v[198:199], v[202:203], v[206:207] neg_lo:[0,1] neg_hi:[0,1]
v_cvt_pk_bf16_f32 v168, v160, v161
v_cvt_pk_bf16_f32 v169, v162, v163
v_cvt_pk_bf16_f32 v170, v164, v165
v_cvt_pk_bf16_f32 v171, v166, v167
v_cvt_pk_bf16_f32 v200, v192, v193
v_cvt_pk_bf16_f32 v201, v194, v195
v_cvt_pk_bf16_f32 v202, v196, v197
v_cvt_pk_bf16_f32 v203, v198, v199
v_xor_b32 v200, s38, v200
v_xor_b32 v201, s38, v201
v_xor_b32 v202, s38, v202
v_xor_b32 v203, s38, v203
s_nop 0
v_permlane16_swap_b32 v168, v170
v_permlane16_swap_b32 v169, v171
v_permlane16_swap_b32 v200, v202
v_permlane16_swap_b32 v201, v203
s_nop 1
buffer_store_dwordx4 v[168:171], v23, s[12:15], 0 offen sc0 sc1
buffer_store_dwordx4 v[200:203], v24, s[12:15], 0 offen sc0 sc1
v_pk_mul_f32 v[176:177], v[176:177], v[56:57]
v_pk_mul_f32 v[180:181], v[180:181], v[60:61]
v_pk_mul_f32 v[178:179], v[178:179], v[58:59]
v_pk_mul_f32 v[182:183], v[182:183], v[62:63]
v_pk_fma_f32 v[176:177], v[188:189], v[68:69], v[176:177]
v_pk_fma_f32 v[180:181], v[184:185], v[64:65], v[180:181]
v_pk_fma_f32 v[178:179], v[190:191], v[70:71], v[178:179]
v_pk_fma_f32 v[182:183], v[186:187], v[66:67], v[182:183]
v_pk_mul_f32 v[208:209], v[208:209], v[56:57]
v_pk_mul_f32 v[212:213], v[212:213], v[60:61]
v_pk_mul_f32 v[210:211], v[210:211], v[58:59]
v_pk_mul_f32 v[214:215], v[214:215], v[62:63]
v_pk_fma_f32 v[208:209], v[220:221], v[68:69], v[208:209]
v_pk_fma_f32 v[212:213], v[216:217], v[64:65], v[212:213]
v_pk_fma_f32 v[210:211], v[222:223], v[70:71], v[210:211]
v_pk_fma_f32 v[214:215], v[218:219], v[66:67], v[214:215]
v_pk_add_f32 v[184:185], v[176:177], v[208:209]
v_pk_add_f32 v[216:217], v[176:177], v[208:209] neg_lo:[0,1] neg_hi:[0,1]
v_pk_add_f32 v[186:187], v[178:179], v[210:211]
v_pk_add_f32 v[218:219], v[178:179], v[210:211] neg_lo:[0,1] neg_hi:[0,1]
v_pk_add_f32 v[188:189], v[180:181], v[212:213]
v_pk_add_f32 v[220:221], v[180:181], v[212:213] neg_lo:[0,1] neg_hi:[0,1]
v_pk_add_f32 v[190:191], v[182:183], v[214:215]
v_pk_add_f32 v[222:223], v[182:183], v[214:215] neg_lo:[0,1] neg_hi:[0,1]
v_pk_add_f32 v[176:177], v[184:185], v[188:189]
v_pk_add_f32 v[180:181], v[184:185], v[188:189] neg_lo:[0,1] neg_hi:[0,1]
v_pk_add_f32 v[178:179], v[186:187], v[190:191]
v_pk_add_f32 v[182:183], v[186:187], v[190:191] neg_lo:[0,1] neg_hi:[0,1]
v_pk_add_f32 v[208:209], v[216:217], v[220:221]
v_pk_add_f32 v[212:213], v[216:217], v[220:221] neg_lo:[0,1] neg_hi:[0,1]
v_pk_add_f32 v[210:211], v[218:219], v[222:223]
v_pk_add_f32 v[214:215], v[218:219], v[222:223] neg_lo:[0,1] neg_hi:[0,1]
v_cvt_pk_bf16_f32 v184, v176, v177
v_cvt_pk_bf16_f32 v185, v178, v179
v_cvt_pk_bf16_f32 v186, v180, v181
v_cvt_pk_bf16_f32 v187, v182, v183
v_cvt_pk_bf16_f32 v216, v208, v209
v_cvt_pk_bf16_f32 v217, v210, v211
v_cvt_pk_bf16_f32 v218, v212, v213
v_cvt_pk_bf16_f32 v219, v214, v215
v_xor_b32 v216, s38, v216
v_xor_b32 v217, s38, v217
v_xor_b32 v218, s38, v218
v_xor_b32 v219, s38, v219
s_nop 0
v_permlane16_swap_b32 v184, v186
v_permlane16_swap_b32 v185, v187
v_permlane16_swap_b32 v216, v218
v_permlane16_swap_b32 v217, v219
s_nop 1
buffer_store_dwordx4 v[184:187], v20, s[12:15], 0 offen offset:256 sc0 sc1
buffer_store_dwordx4 v[216:219], v22, s[12:15], 0 offen sc0 sc1
v_and_b32 v20, 15, v1
v_lshl_add_u32 v20, v20, 2, s35
v_bfe_u32 v21, v1, 4, 1
v_lshl_add_u32 v20, v21, 1, v20
v_lshrrev_b32 v21, 5, v1
v_cmp_eq_u32 s[60:61], 0, v20
v_cvt_f32_u32 v28, v20
v_mul_f32 v28, 0x3a000000, v28
s_bitcmp1_b32 s44, 0
s_cselect_b32 s36, 0x3e800000, 0
s_cselect_b32 s37, 0x3f400000, 0
v_mov_b32 v22, s36
v_cndmask_b32 v28, v28, v22, s[60:61]
s_lshr_b32 s38, s44, 1
v_lshl_add_u32 v22, v21, 5, s38
v_cvt_f32_u32 v22, v22
v_fma_f32 v30, v28, v22, s37
v_fmamk_f32 v128, v28, 0x0, v30
v_fmamk_f32 v129, v28, 0x40800000, v30
v_fmamk_f32 v130, v28, 0x41000000, v30
v_fmamk_f32 v131, v28, 0x41400000, v30
v_fmamk_f32 v132, v28, 0x41800000, v30
v_fmamk_f32 v133, v28, 0x41a00000, v30
v_fmamk_f32 v134, v28, 0x41c00000, v30
v_fmamk_f32 v135, v28, 0x41e00000, v30
v_fmamk_f32 v136, v28, 0x42800000, v30
v_fmamk_f32 v137, v28, 0x42880000, v30
v_fmamk_f32 v138, v28, 0x42900000, v30
v_fmamk_f32 v139, v28, 0x42980000, v30
v_fmamk_f32 v140, v28, 0x42a00000, v30
v_fmamk_f32 v141, v28, 0x42a80000, v30
v_fmamk_f32 v142, v28, 0x42b00000, v30
v_fmamk_f32 v143, v28, 0x42b80000, v30
v_fmamk_f32 v144, v28, 0x40000000, v30
v_fmamk_f32 v145, v28, 0x40c00000, v30
v_fmamk_f32 v146, v28, 0x41200000, v30
v_fmamk_f32 v147, v28, 0x41600000, v30
v_fmamk_f32 v148, v28, 0x41900000, v30
v_fmamk_f32 v149, v28, 0x41b00000, v30
v_fmamk_f32 v150, v28, 0x41d00000, v30
v_fmamk_f32 v151, v28, 0x41f00000, v30
v_fmamk_f32 v152, v28, 0x42840000, v30
v_fmamk_f32 v153, v28, 0x428c0000, v30
v_fmamk_f32 v154, v28, 0x42940000, v30
v_fmamk_f32 v155, v28, 0x429c0000, v30
v_fmamk_f32 v156, v28, 0x42a40000, v30
v_fmamk_f32 v157, v28, 0x42ac0000, v30
v_fmamk_f32 v158, v28, 0x42b40000, v30
v_fmamk_f32 v159, v28, 0x42bc0000, v30
v_mul_f32 v36, 0x42800000, v28
v_mov_b32 v32, s37
v_fmac_f32 v32, 0x44000000, v28
v_fract_f32 v128, v128
v_fract_f32 v129, v129
v_fract_f32 v130, v130
v_fract_f32 v131, v131
v_fract_f32 v132, v132
v_fract_f32 v133, v133
v_fract_f32 v134, v134
v_fract_f32 v135, v135
v_fract_f32 v136, v136
v_fract_f32 v137, v137
v_fract_f32 v138, v138
v_fract_f32 v139, v139
v_fract_f32 v140, v140
v_fract_f32 v141, v141
v_fract_f32 v142, v142
v_fract_f32 v143, v143
v_fract_f32 v144, v144
v_fract_f32 v145, v145
v_fract_f32 v146, v146
v_fract_f32 v147, v147
v_fract_f32 v148, v148
v_fract_f32 v149, v149
v_fract_f32 v150, v150
v_fract_f32 v151, v151
v_fract_f32 v152, v152
v_fract_f32 v153, v153
v_fract_f32 v154, v154
v_fract_f32 v155, v155
v_fract_f32 v156, v156
v_fract_f32 v157, v157
v_fract_f32 v158, v158
v_fract_f32 v159, v159
v_fract_f32 v36, v36
v_fract_f32 v32, v32
v_cos_f32 v128, v128
v_cos_f32 v129, v129
v_cos_f32 v130, v130
v_cos_f32 v131, v131
v_cos_f32 v132, v132
v_cos_f32 v133, v133
v_cos_f32 v134, v134
v_cos_f32 v135, v135
v_cos_f32 v136, v136
v_cos_f32 v137, v137
v_cos_f32 v138, v138
v_cos_f32 v139, v139
v_cos_f32 v140, v140
v_cos_f32 v141, v141
v_cos_f32 v142, v142
v_cos_f32 v143, v143
v_cos_f32 v144, v144
v_cos_f32 v145, v145
v_cos_f32 v146, v146
v_cos_f32 v147, v147
v_cos_f32 v148, v148
v_cos_f32 v149, v149
v_cos_f32 v150, v150
v_cos_f32 v151, v151
v_cos_f32 v152, v152
v_cos_f32 v153, v153
v_cos_f32 v154, v154
v_cos_f32 v155, v155
v_cos_f32 v156, v156
v_cos_f32 v157, v157
v_cos_f32 v158, v158
v_cos_f32 v159, v159
v_cos_f32 v36, v36
v_cos_f32 v32, v32
s_nop 0
v_add_f32 v36, v36, v36
v_mov_b32 v37, v36
v_cvt_pk_bf16_f32 v40, v128, v129
v_cvt_pk_bf16_f32 v41, v130, v131
v_cvt_pk_bf16_f32 v42, v132, v133
v_cvt_pk_bf16_f32 v43, v134, v135
v_cvt_pk_bf16_f32 v44, v144, v145
v_cvt_pk_bf16_f32 v45, v146, v147
v_cvt_pk_bf16_f32 v46, v148, v149
v_cvt_pk_bf16_f32 v47, v150, v151
v_cvt_pk_bf16_f32 v22, v32, v129
s_cmp_eq_u32 s44, 1
s_cselect_b32 s58, -1, 0
s_mov_b32 s59, 0
v_cndmask_b32 v40, v40, v22, s[58:59]
v_cvt_pk_bf16_f32 v48, v136, v137
v_cvt_pk_bf16_f32 v49, v138, v139
v_cvt_pk_bf16_f32 v50, v140, v141
v_cvt_pk_bf16_f32 v51, v142, v143
v_cvt_pk_bf16_f32 v52, v152, v153
v_cvt_pk_bf16_f32 v53, v154, v155
v_cvt_pk_bf16_f32 v54, v156, v157
v_cvt_pk_bf16_f32 v55, v158, v159
v_pk_fma_f32 v[128:129], v[136:137], v[36:37], v[128:129] neg_lo:[0,0,1] neg_hi:[0,0,1]
v_pk_fma_f32 v[130:131], v[138:139], v[36:37], v[130:131] neg_lo:[0,0,1] neg_hi:[0,0,1]
v_pk_fma_f32 v[132:133], v[140:141], v[36:37], v[132:133] neg_lo:[0,0,1] neg_hi:[0,0,1]
v_pk_fma_f32 v[134:135], v[142:143], v[36:37], v[134:135] neg_lo:[0,0,1] neg_hi:[0,0,1]
v_pk_fma_f32 v[144:145], v[152:153], v[36:37], v[144:145] neg_lo:[0,0,1] neg_hi:[0,0,1]
v_pk_fma_f32 v[146:147], v[154:155], v[36:37], v[146:147] neg_lo:[0,0,1] neg_hi:[0,0,1]
v_pk_fma_f32 v[148:149], v[156:157], v[36:37], v[148:149] neg_lo:[0,0,1] neg_hi:[0,0,1]
v_pk_fma_f32 v[150:151], v[158:159], v[36:37], v[150:151] neg_lo:[0,0,1] neg_hi:[0,0,1]
v_cvt_pk_bf16_f32 v56, v128, v129
v_cvt_pk_bf16_f32 v57, v130, v131
v_cvt_pk_bf16_f32 v58, v132, v133
v_cvt_pk_bf16_f32 v59, v134, v135
v_cvt_pk_bf16_f32 v60, v144, v145
v_cvt_pk_bf16_f32 v61, v146, v147
v_cvt_pk_bf16_f32 v62, v148, v149
v_cvt_pk_bf16_f32 v63, v150, v151
v_pk_fma_f32 v[136:137], v[128:129], v[36:37], v[136:137] neg_lo:[0,0,1] neg_hi:[0,0,1]
v_pk_fma_f32 v[138:139], v[130:131], v[36:37], v[138:139] neg_lo:[0,0,1] neg_hi:[0,0,1]
v_pk_fma_f32 v[140:141], v[132:133], v[36:37], v[140:141] neg_lo:[0,0,1] neg_hi:[0,0,1]
v_pk_fma_f32 v[142:143], v[134:135], v[36:37], v[142:143] neg_lo:[0,0,1] neg_hi:[0,0,1]
v_pk_fma_f32 v[152:153], v[144:145], v[36:37], v[152:153] neg_lo:[0,0,1] neg_hi:[0,0,1]
v_pk_fma_f32 v[154:155], v[146:147], v[36:37], v[154:155] neg_lo:[0,0,1] neg_hi:[0,0,1]
v_pk_fma_f32 v[156:157], v[148:149], v[36:37], v[156:157] neg_lo:[0,0,1] neg_hi:[0,0,1]
v_pk_fma_f32 v[158:159], v[150:151], v[36:37], v[158:159] neg_lo:[0,0,1] neg_hi:[0,0,1]
v_cvt_pk_bf16_f32 v64, v136, v137
v_cvt_pk_bf16_f32 v65, v138, v139
v_cvt_pk_bf16_f32 v66, v140, v141
v_cvt_pk_bf16_f32 v67, v142, v143
v_cvt_pk_bf16_f32 v68, v152, v153
v_cvt_pk_bf16_f32 v69, v154, v155
v_cvt_pk_bf16_f32 v70, v156, v157
v_cvt_pk_bf16_f32 v71, v158, v159
v_pk_fma_f32 v[128:129], v[136:137], v[36:37], v[128:129] neg_lo:[0,0,1] neg_hi:[0,0,1]
v_pk_fma_f32 v[130:131], v[138:139], v[36:37], v[130:131] neg_lo:[0,0,1] neg_hi:[0,0,1]
v_pk_fma_f32 v[132:133], v[140:141], v[36:37], v[132:133] neg_lo:[0,0,1] neg_hi:[0,0,1]
v_pk_fma_f32 v[134:135], v[142:143], v[36:37], v[134:135] neg_lo:[0,0,1] neg_hi:[0,0,1]
v_pk_fma_f32 v[144:145], v[152:153], v[36:37], v[144:145] neg_lo:[0,0,1] neg_hi:[0,0,1]
v_pk_fma_f32 v[146:147], v[154:155], v[36:37], v[146:147] neg_lo:[0,0,1] neg_hi:[0,0,1]
v_pk_fma_f32 v[148:149], v[156:157], v[36:37], v[148:149] neg_lo:[0,0,1] neg_hi:[0,0,1]
v_pk_fma_f32 v[150:151], v[158:159], v[36:37], v[150:151] neg_lo:[0,0,1] neg_hi:[0,0,1]
v_cvt_pk_bf16_f32 v72, v128, v129
v_cvt_pk_bf16_f32 v73, v130, v131
v_cvt_pk_bf16_f32 v74, v132, v133
v_cvt_pk_bf16_f32 v75, v134, v135
v_cvt_pk_bf16_f32 v76, v144, v145
v_cvt_pk_bf16_f32 v77, v146, v147
v_cvt_pk_bf16_f32 v78, v148, v149
v_cvt_pk_bf16_f32 v79, v150, v151
v_pk_fma_f32 v[136:137], v[128:129], v[36:37], v[136:137] neg_lo:[0,0,1] neg_hi:[0,0,1]
v_pk_fma_f32 v[138:139], v[130:131], v[36:37], v[138:139] neg_lo:[0,0,1] neg_hi:[0,0,1]
v_pk_fma_f32 v[140:141], v[132:133], v[36:37], v[140:141] neg_lo:[0,0,1] neg_hi:[0,0,1]
v_pk_fma_f32 v[142:143], v[134:135], v[36:37], v[142:143] neg_lo:[0,0,1] neg_hi:[0,0,1]
v_pk_fma_f32 v[152:153], v[144:145], v[36:37], v[152:153] neg_lo:[0,0,1] neg_hi:[0,0,1]
v_pk_fma_f32 v[154:155], v[146:147], v[36:37], v[154:155] neg_lo:[0,0,1] neg_hi:[0,0,1]
v_pk_fma_f32 v[156:157], v[148:149], v[36:37], v[156:157] neg_lo:[0,0,1] neg_hi:[0,0,1]
v_pk_fma_f32 v[158:159], v[150:151], v[36:37], v[158:159] neg_lo:[0,0,1] neg_hi:[0,0,1]
v_cvt_pk_bf16_f32 v80, v136, v137
v_cvt_pk_bf16_f32 v81, v138, v139
v_cvt_pk_bf16_f32 v82, v140, v141
v_cvt_pk_bf16_f32 v83, v142, v143
v_cvt_pk_bf16_f32 v84, v152, v153
v_cvt_pk_bf16_f32 v85, v154, v155
v_cvt_pk_bf16_f32 v86, v156, v157
v_cvt_pk_bf16_f32 v87, v158, v159
v_pk_fma_f32 v[128:129], v[136:137], v[36:37], v[128:129] neg_lo:[0,0,1] neg_hi:[0,0,1]
v_pk_fma_f32 v[130:131], v[138:139], v[36:37], v[130:131] neg_lo:[0,0,1] neg_hi:[0,0,1]
v_pk_fma_f32 v[132:133], v[140:141], v[36:37], v[132:133] neg_lo:[0,0,1] neg_hi:[0,0,1]
v_pk_fma_f32 v[134:135], v[142:143], v[36:37], v[134:135] neg_lo:[0,0,1] neg_hi:[0,0,1]
v_pk_fma_f32 v[144:145], v[152:153], v[36:37], v[144:145] neg_lo:[0,0,1] neg_hi:[0,0,1]
v_pk_fma_f32 v[146:147], v[154:155], v[36:37], v[146:147] neg_lo:[0,0,1] neg_hi:[0,0,1]
v_pk_fma_f32 v[148:149], v[156:157], v[36:37], v[148:149] neg_lo:[0,0,1] neg_hi:[0,0,1]
v_pk_fma_f32 v[150:151], v[158:159], v[36:37], v[150:151] neg_lo:[0,0,1] neg_hi:[0,0,1]
v_cvt_pk_bf16_f32 v88, v128, v129
v_cvt_pk_bf16_f32 v89, v130, v131
v_cvt_pk_bf16_f32 v90, v132, v133
v_cvt_pk_bf16_f32 v91, v134, v135
v_cvt_pk_bf16_f32 v92, v144, v145
v_cvt_pk_bf16_f32 v93, v146, v147
v_cvt_pk_bf16_f32 v94, v148, v149
v_cvt_pk_bf16_f32 v95, v150, v151
v_pk_fma_f32 v[136:137], v[128:129], v[36:37], v[136:137] neg_lo:[0,0,1] neg_hi:[0,0,1]
v_pk_fma_f32 v[138:139], v[130:131], v[36:37], v[138:139] neg_lo:[0,0,1] neg_hi:[0,0,1]
v_pk_fma_f32 v[140:141], v[132:133], v[36:37], v[140:141] neg_lo:[0,0,1] neg_hi:[0,0,1]
v_pk_fma_f32 v[142:143], v[134:135], v[36:37], v[142:143] neg_lo:[0,0,1] neg_hi:[0,0,1]
v_pk_fma_f32 v[152:153], v[144:145], v[36:37], v[152:153] neg_lo:[0,0,1] neg_hi:[0,0,1]
v_pk_fma_f32 v[154:155], v[146:147], v[36:37], v[154:155] neg_lo:[0,0,1] neg_hi:[0,0,1]
v_pk_fma_f32 v[156:157], v[148:149], v[36:37], v[156:157] neg_lo:[0,0,1] neg_hi:[0,0,1]
v_pk_fma_f32 v[158:159], v[150:151], v[36:37], v[158:159] neg_lo:[0,0,1] neg_hi:[0,0,1]
v_cvt_pk_bf16_f32 v96, v136, v137
v_cvt_pk_bf16_f32 v97, v138, v139
v_cvt_pk_bf16_f32 v98, v140, v141
v_cvt_pk_bf16_f32 v99, v142, v143
v_cvt_pk_bf16_f32 v100, v152, v153
v_cvt_pk_bf16_f32 v101, v154, v155
v_cvt_pk_bf16_f32 v102, v156, v157
v_cvt_pk_bf16_f32 v103, v158, v159
v_cvt_pk_bf16_f32 v32, v32, v32
v_mov_b32 v33, 0
v_mov_b32 v34, 0
v_mov_b32 v35, 0
s_waitcnt vmcnt(0)
s_mov_b64 exec, 1
buffer_store_dword v0, v19, s[12:15], s49 offen sc0 sc1
s_mov_b64 exec, -1
s_xor_b32 s36, s31, 0
s_lshl_b32 s36, s36, 1
s_add_u32 s36, s36, s30
s_bitcmp1_b32 s44, 1
s_cselect_b64 s[58:59], -1, 0
s_and_b32 s37, s44, 1
s_mul_i32 s66, s36, 36864
s_mul_i32 s36, s37, 1253376
s_add_u32 s66, s66, s36
s_and_b32 s36, s29, 1
s_mul_i32 s36, s36, 626688
s_add_u32 s66, s66, s36
s_lshr_b32 s36, s44, 1
s_lshl_b32 s62, s36, 10
s_add_u32 s62, s62, 34635776
s_mul_i32 s36, s36, 9216
s_add_u32 s66, s66, s36
s_add_u32 s66, s66, 16777216
s_lshl_b32 s37, s37, 4
v_and_b32 v22, 19, v1
v_bfe_u32 v23, v1, 2, 1
v_lshl_or_b32 v22, v23, 3, v22
v_bfe_u32 v23, v1, 3, 1
v_lshl_or_b32 v22, v23, 2, v22
v_xor_b32 v22, s37, v22
v_cmp_eq_u32 vcc, 0, v22
v_lshlrev_b32 v22, 4, v22
v_lshlrev_b32 v23, 9, v21
v_add_u32 v124, v23, v22
v_sub_u32 v22, v23, v22
v_add_u32 v22, 512, v22
v_add_u32 v23, 36864, v23
v_cndmask_b32 v22, v22, v23, vcc
v_cndmask_b32 v125, v22, v124, s[58:59]
v_cndmask_b32 v124, v124, v22, s[58:59]
v_bfe_u32 v22, v1, 4, 1
v_and_b32 v23, 15, v1
v_lshlrev_b32 v126, 4, v23
v_lshl_add_u32 v126, v22, 10, v126
v_lshl_add_u32 v126, v21, 9, v126
s_xor_b32 s36, s2, 1
s_lshl_b32 s68, s36, 15
s_lshl_b32 s36, s44, 11
s_add_u32 s68, s68, s36
s_add_u32 s68, s68, 25165824
s_lshl_b32 s56, 0x11111111, s44
s_mov_b32 s57, s56
s_mov_b32 s46, 0x0c0c0400
s_mov_b32 s47, 0x04000c0c
s_and_b32 s44, s28, 3
v_and_b32 v26, 15, v1
v_lshl_add_u32 v26, v26, 2, s35
v_bfe_u32 v27, v1, 4, 1
v_lshl_add_u32 v26, v27, 1, v26
v_lshrrev_b32 v27, 5, v1
v_cmp_eq_u32 s[60:61], 0, v26
s_xor_b32 s36, s31, 0
s_lshl_b32 s36, s36, 1
s_add_u32 s36, s36, s30
s_lshl_b32 s37, s36, 6
s_sub_u32 s38, 1984, s37
s_bitcmp1_b32 s44, 1
s_cselect_b32 s45, s38, s37
s_cselect_b32 s39, 3, 0
s_and_b32 s37, s44, 1
s_lshl_b32 s38, s37, 5
s_add_u32 s45, s45, s38
v_lshlrev_b32 v29, 4, v27
s_xor_b32 s36, s39, 0
s_lshl_b32 s40, s36, 13
s_add_u32 s37, s36, 1
s_lshr_b32 s37, s37, 1
s_lshl_b32 s37, s37, 10
s_bitcmp1_b32 s36, 0
s_cselect_b32 s38, -1, 1
v_mul_lo_u32 v120, v26, s38
v_add_u32 v120, s37, v120
s_lshr_b32 s36, s36, 1
s_lshl_b32 s36, s36, 9
s_sub_u32 s37, s37, s36
v_mov_b32 v28, s37
v_cndmask_b32 v120, v120, v28, s[60:61]
v_lshl_add_u32 v120, v120, 11, v29
s_xor_b32 s36, s39, 1
s_lshl_b32 s41, s36, 13
s_add_u32 s37, s36, 1
s_lshr_b32 s37, s37, 1
s_lshl_b32 s37, s37, 10
s_bitcmp1_b32 s36, 0
s_cselect_b32 s38, -1, 1
v_mul_lo_u32 v121, v26, s38
v_add_u32 v121, s37, v121
s_lshr_b32 s36, s36, 1
s_lshl_b32 s36, s36, 9
s_sub_u32 s37, s37, s36
v_mov_b32 v28, s37
v_cndmask_b32 v121, v121, v28, s[60:61]
v_lshl_add_u32 v121, v121, 11, v29
s_xor_b32 s36, s39, 2
s_lshl_b32 s42, s36, 13
s_add_u32 s37, s36, 1
s_lshr_b32 s37, s37, 1
s_lshl_b32 s37, s37, 10
s_bitcmp1_b32 s36, 0
s_cselect_b32 s38, -1, 1
v_mul_lo_u32 v122, v26, s38
v_add_u32 v122, s37, v122
s_lshr_b32 s36, s36, 1
s_lshl_b32 s36, s36, 9
s_sub_u32 s37, s37, s36
v_mov_b32 v28, s37
v_cndmask_b32 v122, v122, v28, s[60:61]
v_lshl_add_u32 v122, v122, 11, v29
s_xor_b32 s36, s39, 3
s_lshl_b32 s43, s36, 13
s_add_u32 s37, s36, 1
s_lshr_b32 s37, s37, 1
s_lshl_b32 s37, s37, 10
s_bitcmp1_b32 s36, 0
s_cselect_b32 s38, -1, 1
v_mul_lo_u32 v123, v26, s38
v_add_u32 v123, s37, v123
s_lshr_b32 s36, s36, 1
s_lshl_b32 s36, s36, 9
s_sub_u32 s37, s37, s36
v_mov_b32 v28, s37
v_cndmask_b32 v123, v123, v28, s[60:61]
v_lshl_add_u32 v123, v123, 11, v29
s_mov_b32 s69, 100000
HS_w0:
ds_read_b32 v25, v127 offset:0
s_waitcnt lgkmcnt(0)
v_cmp_gt_u32 vcc, 31, v25
s_cmp_eq_u32 vcc_lo, 0
s_cbranch_scc1 HS_x0
s_sleep 4
s_sub_u32 s69, s69, 1
s_cmp_lg_u32 s69, 0
s_cbranch_scc1 HS_w0
HS_x0:
s_mov_b32 s69, 4000
HS_f0:
buffer_load_dwordx4 v[14:17], v18, s[12:15], s62 offen sc0 sc1
HS_fc:
s_waitcnt vmcnt(0)
v_xor_b32 v14, v0, v14
v_xor_b32 v15, v0, v15
v_xor_b32 v16, v0, v16
v_xor_b32 v17, v0, v17
v_or3_b32 v14, v14, v15, v16
v_or_b32 v14, v14, v17
v_cmp_ne_u32 vcc, 0, v14
s_cbranch_vccz HS_f1
s_sub_u32 s69, s69, 1
s_cmp_lg_u32 s69, 0
s_cbranch_scc1 HS_f0
HS_f1:
s_add_u32 s36, s66, 0
buffer_load_dwordx4 v[192:195], v124, s[12:15], s36 offen offset:0
buffer_load_dwordx4 v[196:199], v125, s[12:15], s36 offen offset:0
s_add_u32 s36, s66, 18432
buffer_load_dwordx4 v[200:203], v124, s[12:15], s36 offen offset:0
buffer_load_dwordx4 v[204:207], v125, s[12:15], s36 offen offset:0
s_add_u32 s36, s66, 0
buffer_load_dwordx4 v[208:211], v124, s[12:15], s36 offen offset:1024
buffer_load_dwordx4 v[212:215], v125, s[12:15], s36 offen offset:1024
s_add_u32 s36, s66, 18432
buffer_load_dwordx4 v[216:219], v124, s[12:15], s36 offen offset:1024
buffer_load_dwordx4 v[220:223], v125, s[12:15], s36 offen offset:1024
s_add_u32 s36, s66, 0
buffer_load_dwordx4 v[224:227], v124, s[12:15], s36 offen offset:2048
buffer_load_dwordx4 v[228:231], v125, s[12:15], s36 offen offset:2048
s_add_u32 s36, s66, 18432
buffer_load_dwordx4 v[232:235], v124, s[12:15], s36 offen offset:2048
buffer_load_dwordx4 v[236:239], v125, s[12:15], s36 offen offset:2048
s_add_u32 s36, s66, 0
buffer_load_dwordx4 v[240:243], v124, s[12:15], s36 offen offset:3072
buffer_load_dwordx4 v[244:247], v125, s[12:15], s36 offen offset:3072
s_add_u32 s36, s66, 18432
buffer_load_dwordx4 v[248:251], v124, s[12:15], s36 offen offset:3072
buffer_load_dwordx4 v[252:255], v125, s[12:15], s36 offen offset:3072
s_waitcnt vmcnt(14)
v_mfma_f32_32x32x16_bf16 v[128:143], v[192:195], v[40:43], 0
v_mfma_f32_32x32x16_bf16 v[144:159], v[196:199], v[40:43], 0
s_waitcnt vmcnt(12)
v_mfma_f32_32x32x16_bf16 v[160:175], v[200:203], v[44:47], 0
v_mfma_f32_32x32x16_bf16 v[176:191], v[204:207], v[44:47], 0
s_add_u32 s36, s66, 4096
buffer_load_dwordx4 v[192:195], v124, s[12:15], s36 offen offset:0
buffer_load_dwordx4 v[196:199], v125, s[12:15], s36 offen offset:0
s_waitcnt vmcnt(12)
v_mfma_f32_32x32x16_bf16 v[128:143], v[208:211], v[48:51], v[128:143]
v_mfma_f32_32x32x16_bf16 v[144:159], v[212:215], v[48:51], v[144:159]
s_add_u32 s36, s66, 22528
buffer_load_dwordx4 v[200:203], v124, s[12:15], s36 offen offset:0
buffer_load_dwordx4 v[204:207], v125, s[12:15], s36 offen offset:0
s_waitcnt vmcnt(12)
v_mfma_f32_32x32x16_bf16 v[160:175], v[216:219], v[52:55], v[160:175]
v_mfma_f32_32x32x16_bf16 v[176:191], v[220:223], v[52:55], v[176:191]
s_add_u32 s36, s66, 4096
buffer_load_dwordx4 v[208:211], v124, s[12:15], s36 offen offset:1024
buffer_load_dwordx4 v[212:215], v125, s[12:15], s36 offen offset:1024
s_waitcnt vmcnt(12)
v_mfma_f32_32x32x16_bf16 v[128:143], v[224:227], v[56:59], v[128:143]
v_mfma_f32_32x32x16_bf16 v[144:159], v[228:231], v[56:59], v[144:159]
s_add_u32 s36, s66, 22528
buffer_load_dwordx4 v[216:219], v124, s[12:15], s36 offen offset:1024
buffer_load_dwordx4 v[220:223], v125, s[12:15], s36 offen offset:1024
s_waitcnt vmcnt(12)
v_mfma_f32_32x32x16_bf16 v[160:175], v[232:235], v[60:63], v[160:175]
v_mfma_f32_32x32x16_bf16 v[176:191], v[236:239], v[60:63], v[176:191]
s_add_u32 s36, s66, 4096
buffer_load_dwordx4 v[224:227], v124, s[12:15], s36 offen offset:2048
buffer_load_dwordx4 v[228:231], v125, s[12:15], s36 offen offset:2048
s_waitcnt vmcnt(12)
v_mfma_f32_32x32x16_bf16 v[128:143], v[240:243], v[64:67], v[128:143]
v_mfma_f32_32x32x16_bf16 v[144:159], v[244:247], v[64:67], v[144:159]
s_add_u32 s36, s66, 22528
buffer_load_dwordx4 v[232:235], v124, s[12:15], s36 offen offset:2048
buffer_load_dwordx4 v[236:239], v125, s[12:15], s36 offen offset:2048
s_waitcnt vmcnt(12)
v_mfma_f32_32x32x16_bf16 v[160:175], v[248:251], v[68:71], v[160:175]
v_mfma_f32_32x32x16_bf16 v[176:191], v[252:255], v[68:71], v[176:191]
s_add_u32 s36, s66, 4096
buffer_load_dwordx4 v[240:243], v124, s[12:15], s36 offen offset:3072
buffer_load_dwordx4 v[244:247], v125, s[12:15], s36 offen offset:3072
s_waitcnt vmcnt(12)
v_mfma_f32_32x32x16_bf16 v[128:143], v[192:195], v[72:75], v[128:143]
v_mfma_f32_32x32x16_bf16 v[144:159], v[196:199], v[72:75], v[144:159]
s_add_u32 s36, s66, 22528
buffer_load_dwordx4 v[248:251], v124, s[12:15], s36 offen offset:3072
buffer_load_dwordx4 v[252:255], v125, s[12:15], s36 offen offset:3072
s_waitcnt vmcnt(12)
v_mfma_f32_32x32x16_bf16 v[160:175], v[200:203], v[76:79], v[160:175]
v_mfma_f32_32x32x16_bf16 v[176:191], v[204:207], v[76:79], v[176:191]
s_add_u32 s36, s66, 8192
buffer_load_dwordx4 v[6:9], v124, s[12:15], s36 offen
buffer_load_dwordx4 v[10:13], v125, s[12:15], s36 offen
s_waitcnt vmcnt(12)
v_mfma_f32_32x32x16_bf16 v[128:143], v[208:211], v[80:83], v[128:143]
v_mfma_f32_32x32x16_bf16 v[144:159], v[212:215], v[80:83], v[144:159]
s_waitcnt vmcnt(10)
v_mfma_f32_32x32x16_bf16 v[160:175], v[216:219], v[84:87], v[160:175]
v_mfma_f32_32x32x16_bf16 v[176:191], v[220:223], v[84:87], v[176:191]
s_waitcnt vmcnt(8)
v_mfma_f32_32x32x16_bf16 v[128:143], v[224:227], v[88:91], v[128:143]
v_mfma_f32_32x32x16_bf16 v[144:159], v[228:231], v[88:91], v[144:159]
s_waitcnt vmcnt(6)
v_mfma_f32_32x32x16_bf16 v[160:175], v[232:235], v[92:95], v[160:175]
v_mfma_f32_32x32x16_bf16 v[176:191], v[236:239], v[92:95], v[176:191]
s_waitcnt vmcnt(4)
v_mfma_f32_32x32x16_bf16 v[128:143], v[240:243], v[96:99], v[128:143]
v_mfma_f32_32x32x16_bf16 v[144:159], v[244:247], v[96:99], v[144:159]
s_waitcnt vmcnt(2)
v_mfma_f32_32x32x16_bf16 v[160:175], v[248:251], v[100:103], v[160:175]
v_mfma_f32_32x32x16_bf16 v[176:191], v[252:255], v[100:103], v[176:191]
s_waitcnt vmcnt(0)
s_and_b32 s36, s29, 1
s_or_b32 s36, s36, s44
s_cmp_lg_u32 s36, 0
s_cbranch_scc1 HS_ng
v_mfma_f32_32x32x16_bf16 v[128:143], v[6:9], v[32:35], v[128:143]
v_mfma_f32_32x32x16_bf16 v[144:159], v[10:13], v[32:35], v[144:159]
HS_ng:
s_xor_b32 s36, s44, 1
s_mul_i32 s36, s36, 6144
s_add_u32 s36, s36, 65536
v_add_u32 v26, s36, v18
s_xor_b32 s36, s44, 2
s_mul_i32 s36, s36, 6144
s_add_u32 s36, s36, 67584
v_add_u32 v27, s36, v18
s_xor_b32 s36, s44, 3
s_mul_i32 s36, s36, 6144
s_add_u32 s36, s36, 69632
v_add_u32 v28, s36, v18
s_mul_i32 s36, s44, 6144
s_add_u32 s36, s36, 65536
v_add_u32 v29, s36, v18
s_mov_b32 s69, 100000
HS_w1:
ds_read_b32 v25, v127 offset:256
s_waitcnt lgkmcnt(0)
v_cmp_gt_u32 vcc, 1, v25
s_and_b32 vcc_lo, vcc_lo, 0x33333333
s_cmp_eq_u32 vcc_lo, 0
s_cbranch_scc1 HS_x1
s_sleep 1
s_sub_u32 s69, s69, 1
s_cmp_lg_u32 s69, 0
s_cbranch_scc1 HS_w1
HS_x1:
ds_read_b128 v[104:107], v27 offset:0
ds_read_b128 v[108:111], v27 offset:1024
ds_read_b128 v[112:115], v28 offset:0
ds_read_b128 v[116:119], v28 offset:1024
s_waitcnt lgkmcnt(0)
v_lshlrev_b32 v192, 16, v104
v_and_b32 v193, 0xffff0000, v104
v_lshlrev_b32 v194, 16, v105
v_and_b32 v195, 0xffff0000, v105
v_lshlrev_b32 v196, 16, v106
v_and_b32 v197, 0xffff0000, v106
v_lshlrev_b32 v198, 16, v107
v_and_b32 v199, 0xffff0000, v107
v_lshlrev_b32 v200, 16, v108
v_and_b32 v201, 0xffff0000, v108
v_lshlrev_b32 v202, 16, v109
v_and_b32 v203, 0xffff0000, v109
v_lshlrev_b32 v204, 16, v110
v_and_b32 v205, 0xffff0000, v110
v_lshlrev_b32 v206, 16, v111
v_and_b32 v207, 0xffff0000, v111
v_lshlrev_b32 v208, 16, v112
v_and_b32 v209, 0xffff0000, v112
v_lshlrev_b32 v210, 16, v113
v_and_b32 v211, 0xffff0000, v113
v_lshlrev_b32 v212, 16, v114
v_and_b32 v213, 0xffff0000, v114
v_lshlrev_b32 v214, 16, v115
v_and_b32 v215, 0xffff0000, v115
v_lshlrev_b32 v216, 16, v116
v_and_b32 v217, 0xffff0000, v116
v_lshlrev_b32 v218, 16, v117
v_and_b32 v219, 0xffff0000, v117
v_lshlrev_b32 v220, 16, v118
v_and_b32 v221, 0xffff0000, v118
v_lshlrev_b32 v222, 16, v119
v_and_b32 v223, 0xffff0000, v119
v_pk_add_f32 v[136:137], v[136:137], v[168:169]
v_pk_add_f32 v[138:139], v[138:139], v[170:171]
v_pk_add_f32 v[140:141], v[140:141], v[172:173]
v_pk_add_f32 v[142:143], v[142:143], v[174:175]
ds_write_b128 v26, v[136:139] offset:0
ds_write_b128 v26, v[140:143] offset:1024
v_pk_add_f32 v[144:145], v[144:145], v[176:177]
v_pk_add_f32 v[146:147], v[146:147], v[178:179]
v_pk_add_f32 v[148:149], v[148:149], v[180:181]
v_pk_add_f32 v[150:151], v[150:151], v[182:183]
ds_write_b128 v27, v[144:147] offset:0
ds_write_b128 v27, v[148:151] offset:1024
v_pk_add_f32 v[152:153], v[152:153], v[184:185]
v_pk_add_f32 v[154:155], v[154:155], v[186:187]
v_pk_add_f32 v[156:157], v[156:157], v[188:189]
v_pk_add_f32 v[158:159], v[158:159], v[190:191]
ds_write_b128 v28, v[152:155] offset:0
ds_write_b128 v28, v[156:159] offset:1024
v_pk_add_f32 v[128:129], v[128:129], v[160:161]
v_pk_add_f32 v[130:131], v[130:131], v[162:163]
v_pk_add_f32 v[132:133], v[132:133], v[164:165]
v_pk_add_f32 v[134:135], v[134:135], v[166:167]
v_mov_b32 v22, 2
s_mov_b64 exec, s[56:57]
ds_write_b32 v127, v22 offset:256
s_mov_b64 exec, -1
s_lshl_b32 s36, s44, 31
s_lshl_b32 s37, s44, 30
s_and_b32 s37, s37, 0x80000000
s_mov_b32 s70, 1.0
s_xor_b32 s76, s36, 1.0
s_xor_b32 s74, s37, 1.0
s_xor_b32 s72, s74, s36
s_mov_b32 s71, s70
s_mov_b32 s73, s72
s_mov_b32 s75, s74
s_mov_b32 s77, s76
s_mov_b32 s69, 100000
HS_w2:
ds_read_b32 v25, v127 offset:256
s_waitcnt lgkmcnt(0)
v_cmp_gt_u32 vcc, 2, v25
s_cmp_eq_u32 vcc_lo, 0
s_cbranch_scc1 HS_x2
s_sleep 1
s_sub_u32 s69, s69, 1
s_cmp_lg_u32 s69, 0
s_cbranch_scc1 HS_w2
HS_x2:
ds_read_b128 v[136:139], v29 offset:0
ds_read_b128 v[140:143], v29 offset:1024
ds_read_b128 v[144:147], v29 offset:2048
ds_read_b128 v[148:151], v29 offset:3072
ds_read_b128 v[152:155], v29 offset:4096
ds_read_b128 v[156:159], v29 offset:5120
s_waitcnt lgkmcnt(4)
v_pk_add_f32 v[160:161], v[128:129], v[136:137]
v_pk_add_f32 v[168:169], v[128:129], v[136:137] neg_lo:[0,1] neg_hi:[0,1]
v_pk_add_f32 v[162:163], v[130:131], v[138:139]
v_pk_add_f32 v[170:171], v[130:131], v[138:139] neg_lo:[0,1] neg_hi:[0,1]
v_pk_add_f32 v[164:165], v[132:133], v[140:141]
v_pk_add_f32 v[172:173], v[132:133], v[140:141] neg_lo:[0,1] neg_hi:[0,1]
v_pk_add_f32 v[166:167], v[134:135], v[142:143]
v_pk_add_f32 v[174:175], v[134:135], v[142:143] neg_lo:[0,1] neg_hi:[0,1]
s_waitcnt lgkmcnt(0)
v_pk_add_f32 v[176:177], v[144:145], v[152:153]
v_pk_add_f32 v[184:185], v[144:145], v[152:153] neg_lo:[0,1] neg_hi:[0,1]
v_pk_add_f32 v[178:179], v[146:147], v[154:155]
v_pk_add_f32 v[186:187], v[146:147], v[154:155] neg_lo:[0,1] neg_hi:[0,1]
v_pk_add_f32 v[180:181], v[148:149], v[156:157]
v_pk_add_f32 v[188:189], v[148:149], v[156:157] neg_lo:[0,1] neg_hi:[0,1]
v_pk_add_f32 v[182:183], v[150:151], v[158:159]
v_pk_add_f32 v[190:191], v[150:151], v[158:159] neg_lo:[0,1] neg_hi:[0,1]
v_pk_add_f32 v[128:129], v[160:161], v[176:177]
v_pk_add_f32 v[130:131], v[162:163], v[178:179]
v_pk_add_f32 v[132:133], v[164:165], v[180:181]
v_pk_add_f32 v[134:135], v[166:167], v[182:183]
v_pk_add_f32 v[136:137], v[168:169], v[184:185] neg_lo:[0,1] neg_hi:[0,1]
v_pk_add_f32 v[138:139], v[170:171], v[186:187] neg_lo:[0,1] neg_hi:[0,1]
v_pk_add_f32 v[140:141], v[172:173], v[188:189] neg_lo:[0,1] neg_hi:[0,1]
v_pk_add_f32 v[142:143], v[174:175], v[190:191] neg_lo:[0,1] neg_hi:[0,1]
v_pk_add_f32 v[144:145], v[160:161], v[176:177] neg_lo:[0,1] neg_hi:[0,1]
v_pk_add_f32 v[146:147], v[162:163], v[178:179] neg_lo:[0,1] neg_hi:[0,1]
v_pk_add_f32 v[148:149], v[164:165], v[180:181] neg_lo:[0,1] neg_hi:[0,1]
v_pk_add_f32 v[150:151], v[166:167], v[182:183] neg_lo:[0,1] neg_hi:[0,1]
v_pk_add_f32 v[152:153], v[168:169], v[184:185]
v_pk_add_f32 v[154:155], v[170:171], v[186:187]
v_pk_add_f32 v[156:157], v[172:173], v[188:189]
v_pk_add_f32 v[158:159], v[174:175], v[190:191]
s_cmp_lg_u32 s35, 0
s_cbranch_scc1 HS_ns
s_lshl_b32 s36, s44, 6
s_add_u32 s36, s36, 90112
v_lshrrev_b32 v22, 1, v1
v_add_u32 v22, s36, v22
s_mov_b64 exec, s[60:61]
ds_read_b128 v[160:163], v22
ds_read_b128 v[164:167], v22 offset:32
v_mul_f32 v128, s70, v128
v_mul_f32 v129, s70, v129
v_mul_f32 v130, s70, v130
v_mul_f32 v131, s70, v131
v_mul_f32 v132, s70, v132
v_mul_f32 v133, s70, v133
v_mul_f32 v134, s70, v134
v_mul_f32 v135, s70, v135
v_mul_f32 v136, s72, v136
v_mul_f32 v137, s72, v137
v_mul_f32 v138, s72, v138
v_mul_f32 v139, s72, v139
v_mul_f32 v140, s72, v140
v_mul_f32 v141, s72, v141
v_mul_f32 v142, s72, v142
v_mul_f32 v143, s72, v143
v_mul_f32 v144, s74, v144
v_mul_f32 v145, s74, v145
v_mul_f32 v146, s74, v146
v_mul_f32 v147, s74, v147
v_mul_f32 v148, s74, v148
v_mul_f32 v149, s74, v149
v_mul_f32 v150, s74, v150
v_mul_f32 v151, s74, v151
v_mul_f32 v152, s76, v152
v_mul_f32 v153, s76, v153
v_mul_f32 v154, s76, v154
v_mul_f32 v155, s76, v155
v_mul_f32 v156, s76, v156
v_mul_f32 v157, s76, v157
v_mul_f32 v158, s76, v158
v_mul_f32 v159, s76, v159
v_add_f32 v168, v128, v152
v_add_f32 v176, v136, v144
v_sub_f32 v184, v128, v152
v_add_f32 v169, v129, v153
v_add_f32 v177, v137, v145
v_sub_f32 v185, v129, v153
v_add_f32 v170, v130, v154
v_add_f32 v178, v138, v146
v_sub_f32 v186, v130, v154
v_add_f32 v171, v131, v155
v_add_f32 v179, v139, v147
v_sub_f32 v187, v131, v155
v_add_f32 v172, v132, v156
v_add_f32 v180, v140, v148
v_sub_f32 v188, v132, v156
v_add_f32 v173, v133, v157
v_add_f32 v181, v141, v149
v_sub_f32 v189, v133, v157
v_add_f32 v174, v134, v158
v_add_f32 v182, v142, v150
v_sub_f32 v190, v134, v158
v_add_f32 v175, v135, v159
v_add_f32 v183, v143, v151
v_sub_f32 v191, v135, v159
s_waitcnt lgkmcnt(0)
s_cmp_ge_u32 s44, 2
s_cbranch_scc1 HS_sr
v_mul_f32 v128, 0.5, v168
v_mul_f32 v136, 0.5, v176
v_fma_f32 v144, 0.5, v184, v160
v_fma_f32 v152, -0.5, v184, v160
v_mul_f32 v129, 0.5, v169
v_mul_f32 v137, 0.5, v177
v_fma_f32 v145, 0.5, v185, v161
v_fma_f32 v153, -0.5, v185, v161
v_mul_f32 v130, 0.5, v170
v_mul_f32 v138, 0.5, v178
v_fma_f32 v146, 0.5, v186, v162
v_fma_f32 v154, -0.5, v186, v162
v_mul_f32 v131, 0.5, v171
v_mul_f32 v139, 0.5, v179
v_fma_f32 v147, 0.5, v187, v163
v_fma_f32 v155, -0.5, v187, v163
v_mul_f32 v132, 0.5, v172
v_mul_f32 v140, 0.5, v180
v_fma_f32 v148, 0.5, v188, v164
v_fma_f32 v156, -0.5, v188, v164
v_mul_f32 v133, 0.5, v173
v_mul_f32 v141, 0.5, v181
v_fma_f32 v149, 0.5, v189, v165
v_fma_f32 v157, -0.5, v189, v165
v_mul_f32 v134, 0.5, v174
v_mul_f32 v142, 0.5, v182
v_fma_f32 v150, 0.5, v190, v166
v_fma_f32 v158, -0.5, v190, v166
v_mul_f32 v135, 0.5, v175
v_mul_f32 v143, 0.5, v183
v_fma_f32 v151, 0.5, v191, v167
v_fma_f32 v159, -0.5, v191, v167
s_branch HS_sj
HS_sr:
v_mul_f32 v152, 0.5, v168
v_mul_f32 v144, 0.5, v176
v_fma_f32 v128, 0.5, v184, v160
v_fma_f32 v136, -0.5, v184, v160
v_mul_f32 v153, 0.5, v169
v_mul_f32 v145, 0.5, v177
v_fma_f32 v129, 0.5, v185, v161
v_fma_f32 v137, -0.5, v185, v161
v_mul_f32 v154, 0.5, v170
v_mul_f32 v146, 0.5, v178
v_fma_f32 v130, 0.5, v186, v162
v_fma_f32 v138, -0.5, v186, v162
v_mul_f32 v155, 0.5, v171
v_mul_f32 v147, 0.5, v179
v_fma_f32 v131, 0.5, v187, v163
v_fma_f32 v139, -0.5, v187, v163
v_mul_f32 v156, 0.5, v172
v_mul_f32 v148, 0.5, v180
v_fma_f32 v132, 0.5, v188, v164
v_fma_f32 v140, -0.5, v188, v164
v_mul_f32 v157, 0.5, v173
v_mul_f32 v149, 0.5, v181
v_fma_f32 v133, 0.5, v189, v165
v_fma_f32 v141, -0.5, v189, v165
v_mul_f32 v158, 0.5, v174
v_mul_f32 v150, 0.5, v182
v_fma_f32 v134, 0.5, v190, v166
v_fma_f32 v142, -0.5, v190, v166
v_mul_f32 v159, 0.5, v175
v_mul_f32 v151, 0.5, v183
v_fma_f32 v135, 0.5, v191, v167
v_fma_f32 v143, -0.5, v191, v167
HS_sj:
v_mul_f32 v128, s70, v128
v_mul_f32 v129, s70, v129
v_mul_f32 v130, s70, v130
v_mul_f32 v131, s70, v131
v_mul_f32 v132, s70, v132
v_mul_f32 v133, s70, v133
v_mul_f32 v134, s70, v134
v_mul_f32 v135, s70, v135
v_mul_f32 v136, s72, v136
v_mul_f32 v137, s72, v137
v_mul_f32 v138, s72, v138
v_mul_f32 v139, s72, v139
v_mul_f32 v140, s72, v140
v_mul_f32 v141, s72, v141
v_mul_f32 v142, s72, v142
v_mul_f32 v143, s72, v143
v_mul_f32 v144, s74, v144
v_mul_f32 v145, s74, v145
v_mul_f32 v146, s74, v146
v_mul_f32 v147, s74, v147
v_mul_f32 v148, s74, v148
v_mul_f32 v149, s74, v149
v_mul_f32 v150, s74, v150
v_mul_f32 v151, s74, v151
v_mul_f32 v152, s76, v152
v_mul_f32 v153, s76, v153
v_mul_f32 v154, s76, v154
v_mul_f32 v155, s76, v155
v_mul_f32 v156, s76, v156
v_mul_f32 v157, s76, v157
v_mul_f32 v158, s76, v158
v_mul_f32 v159, s76, v159
s_mov_b64 exec, -1
HS_ns:
v_pk_fma_f32 v[128:129], v[128:129], s[70:71], v[192:193]
v_pk_fma_f32 v[130:131], v[130:131], s[70:71], v[194:195]
v_pk_fma_f32 v[132:133], v[132:133], s[70:71], v[196:197]
v_pk_fma_f32 v[134:135], v[134:135], s[70:71], v[198:199]
v_pk_fma_f32 v[136:137], v[136:137], s[72:73], v[200:201]
v_pk_fma_f32 v[138:139], v[138:139], s[72:73], v[202:203]
v_pk_fma_f32 v[140:141], v[140:141], s[72:73], v[204:205]
v_pk_fma_f32 v[142:143], v[142:143], s[72:73], v[206:207]
v_pk_fma_f32 v[144:145], v[144:145], s[74:75], v[208:209]
v_pk_fma_f32 v[146:147], v[146:147], s[74:75], v[210:211]
v_pk_fma_f32 v[148:149], v[148:149], s[74:75], v[212:213]
v_pk_fma_f32 v[150:151], v[150:151], s[74:75], v[214:215]
v_pk_fma_f32 v[152:153], v[152:153], s[76:77], v[216:217]
v_pk_fma_f32 v[154:155], v[154:155], s[76:77], v[218:219]
v_pk_fma_f32 v[156:157], v[156:157], s[76:77], v[220:221]
v_pk_fma_f32 v[158:159], v[158:159], s[76:77], v[222:223]
s_cmp_lt_u32 s40, 16384
s_cselect_b32 s36, 0, 65536
s_add_u32 s36, s36, s40
s_add_u32 s36, s36, 16384
s_lshl_b32 s37, s44, 11
s_add_u32 s36, s36, s37
v_add_u32 v26, s36, v126
v_mov_b32 v40, v5
v_mov_b32 v41, v5
s_add_u32 s40, s40, s68
s_cmp_lt_u32 s41, 16384
s_cselect_b32 s36, 0, 65536
s_add_u32 s36, s36, s41
s_add_u32 s36, s36, 16384
s_lshl_b32 s37, s44, 11
s_add_u32 s36, s36, s37
v_add_u32 v27, s36, v126
v_mov_b32 v42, v4
v_mov_b32 v43, v4
s_add_u32 s41, s41, s68
s_cmp_lt_u32 s42, 16384
s_cselect_b32 s36, 0, 65536
s_add_u32 s36, s36, s42
s_add_u32 s36, s36, 16384
s_lshl_b32 s37, s44, 11
s_add_u32 s36, s36, s37
v_add_u32 v28, s36, v126
v_mov_b32 v44, v3
v_mov_b32 v45, v3
s_add_u32 s42, s42, s68
s_cmp_lt_u32 s43, 16384
s_cselect_b32 s36, 0, 65536
s_add_u32 s36, s36, s43
s_add_u32 s36, s36, 16384
s_lshl_b32 s37, s44, 11
s_add_u32 s36, s36, s37
v_add_u32 v29, s36, v126
v_mov_b32 v46, v2
v_mov_b32 v47, v2
s_add_u32 s43, s43, s68
s_mov_b32 s69, 100000
HS_w3:
ds_read_b32 v25, v127 offset:0
s_waitcnt lgkmcnt(0)
v_cmp_gt_u32 vcc, 47, v25
s_cmp_eq_u32 vcc_lo, 0
s_cbranch_scc1 HS_x3
s_sleep 2
s_sub_u32 s69, s69, 1
s_cmp_lg_u32 s69, 0
s_cbranch_scc1 HS_w3
HS_x3:
s_mov_b32 s69, 4000
HS_p0:
buffer_load_dwordx4 v[192:195], v126, s[12:15], s40 offen offset:0 sc0 sc1
buffer_load_dwordx4 v[196:199], v126, s[12:15], s40 offen offset:256 sc0 sc1
buffer_load_dwordx4 v[200:203], v126, s[12:15], s41 offen offset:0 sc0 sc1
buffer_load_dwordx4 v[204:207], v126, s[12:15], s41 offen offset:256 sc0 sc1
buffer_load_dwordx4 v[208:211], v126, s[12:15], s42 offen offset:0 sc0 sc1
buffer_load_dwordx4 v[212:215], v126, s[12:15], s42 offen offset:256 sc0 sc1
buffer_load_dwordx4 v[216:219], v126, s[12:15], s43 offen offset:0 sc0 sc1
buffer_load_dwordx4 v[220:223], v126, s[12:15], s43 offen offset:256 sc0 sc1
s_waitcnt vmcnt(6)
v_perm_b32 v48, v193, v192, s46
v_perm_b32 v49, v195, v194, s47
v_bitop3_b32 v48, v48, v49, v0 bitop3:0x56
v_pk_fma_f32 v[160:161], v[192:193], v[40:41], v[128:129]
v_pk_fma_f32 v[162:163], v[194:195], v[40:41], v[130:131]
v_perm_b32 v50, v197, v196, s46
v_perm_b32 v51, v199, v198, s47
v_bitop3_b32 v50, v50, v51, v0 bitop3:0x56
v_pk_fma_f32 v[164:165], v[196:197], v[40:41], v[132:133]
v_pk_fma_f32 v[166:167], v[198:199], v[40:41], v[134:135]
s_waitcnt vmcnt(4)
v_perm_b32 v52, v201, v200, s46
v_perm_b32 v53, v203, v202, s47
v_bitop3_b32 v52, v52, v53, v0 bitop3:0x56
v_pk_fma_f32 v[168:169], v[200:201], v[42:43], v[136:137]
v_pk_fma_f32 v[170:171], v[202:203], v[42:43], v[138:139]
v_perm_b32 v54, v205, v204, s46
v_perm_b32 v55, v207, v206, s47
v_bitop3_b32 v54, v54, v55, v0 bitop3:0x56
v_pk_fma_f32 v[172:173], v[204:205], v[42:43], v[140:141]
v_pk_fma_f32 v[174:175], v[206:207], v[42:43], v[142:143]
s_waitcnt vmcnt(2)
v_perm_b32 v56, v209, v208, s46
v_perm_b32 v57, v211, v210, s47
v_bitop3_b32 v56, v56, v57, v0 bitop3:0x56
v_pk_fma_f32 v[176:177], v[208:209], v[44:45], v[144:145]
v_pk_fma_f32 v[178:179], v[210:211], v[44:45], v[146:147]
v_perm_b32 v58, v213, v212, s46
v_perm_b32 v59, v215, v214, s47
v_bitop3_b32 v58, v58, v59, v0 bitop3:0x56
v_pk_fma_f32 v[180:181], v[212:213], v[44:45], v[148:149]
v_pk_fma_f32 v[182:183], v[214:215], v[44:45], v[150:151]
s_waitcnt vmcnt(0)
v_perm_b32 v60, v217, v216, s46
v_perm_b32 v61, v219, v218, s47
v_bitop3_b32 v60, v60, v61, v0 bitop3:0x56
v_pk_fma_f32 v[184:185], v[216:217], v[46:47], v[152:153]
v_pk_fma_f32 v[186:187], v[218:219], v[46:47], v[154:155]
v_perm_b32 v62, v221, v220, s46
v_perm_b32 v63, v223, v222, s47
v_bitop3_b32 v62, v62, v63, v0 bitop3:0x56
v_pk_fma_f32 v[188:189], v[220:221], v[46:47], v[156:157]
v_pk_fma_f32 v[190:191], v[222:223], v[46:47], v[158:159]
v_or3_b32 v48, v48, v50, v52
v_or3_b32 v54, v54, v56, v58
v_or3_b32 v48, v48, v60, v62
v_or_b32 v48, v48, v54
v_cmp_ne_u32 vcc, 0, v48
s_cbranch_vccz HS_p1
s_sub_u32 s69, s69, 1
s_cmp_lg_u32 s69, 0
s_cbranch_scc1 HS_p0
HS_p1:
s_add_u32 s36, s44, 100
s_mov_b32 s69, 100000
HS_w4:
ds_read_b32 v25, v127 offset:0
s_waitcnt lgkmcnt(0)
v_cmp_gt_u32 vcc, s36, v25
s_cmp_eq_u32 vcc_lo, 0
s_cbranch_scc1 HS_x4
s_sub_u32 s69, s69, 1
s_cmp_lg_u32 s69, 0
s_cbranch_scc1 HS_w4
HS_x4:
ds_read_b128 v[192:195], v26 offset:0
ds_read_b128 v[196:199], v26 offset:256
ds_read_b128 v[200:203], v27 offset:0
ds_read_b128 v[204:207], v27 offset:256
ds_read_b128 v[208:211], v28 offset:0
ds_read_b128 v[212:215], v28 offset:256
ds_read_b128 v[216:219], v29 offset:0
ds_read_b128 v[220:223], v29 offset:256
s_waitcnt lgkmcnt(6)
v_pk_fma_f32 v[160:161], v[192:193], v[40:41], v[160:161]
v_pk_fma_f32 v[162:163], v[194:195], v[40:41], v[162:163]
v_pk_fma_f32 v[164:165], v[196:197], v[40:41], v[164:165]
v_pk_fma_f32 v[166:167], v[198:199], v[40:41], v[166:167]
v_cvt_pk_bf16_f32 v128, v160, v161
v_cvt_pk_bf16_f32 v129, v162, v163
v_cvt_pk_bf16_f32 v130, v164, v165
v_cvt_pk_bf16_f32 v131, v166, v167
buffer_store_dwordx4 v[128:131], v120, s[20:23], s45 offen
s_waitcnt lgkmcnt(4)
v_pk_fma_f32 v[168:169], v[200:201], v[42:43], v[168:169]
v_pk_fma_f32 v[170:171], v[202:203], v[42:43], v[170:171]
v_pk_fma_f32 v[172:173], v[204:205], v[42:43], v[172:173]
v_pk_fma_f32 v[174:175], v[206:207], v[42:43], v[174:175]
v_cvt_pk_bf16_f32 v132, v168, v169
v_cvt_pk_bf16_f32 v133, v170, v171
v_cvt_pk_bf16_f32 v134, v172, v173
v_cvt_pk_bf16_f32 v135, v174, v175
buffer_store_dwordx4 v[132:135], v121, s[20:23], s45 offen
s_waitcnt lgkmcnt(2)
v_pk_fma_f32 v[176:177], v[208:209], v[44:45], v[176:177]
v_pk_fma_f32 v[178:179], v[210:211], v[44:45], v[178:179]
v_pk_fma_f32 v[180:181], v[212:213], v[44:45], v[180:181]
v_pk_fma_f32 v[182:183], v[214:215], v[44:45], v[182:183]
v_cvt_pk_bf16_f32 v136, v176, v177
v_cvt_pk_bf16_f32 v137, v178, v179
v_cvt_pk_bf16_f32 v138, v180, v181
v_cvt_pk_bf16_f32 v139, v182, v183
buffer_store_dwordx4 v[136:139], v122, s[20:23], s45 offen
s_waitcnt lgkmcnt(0)
v_pk_fma_f32 v[184:185], v[216:217], v[46:47], v[184:185]
v_pk_fma_f32 v[186:187], v[218:219], v[46:47], v[186:187]
v_pk_fma_f32 v[188:189], v[220:221], v[46:47], v[188:189]
v_pk_fma_f32 v[190:191], v[222:223], v[46:47], v[190:191]
v_cvt_pk_bf16_f32 v140, v184, v185
v_cvt_pk_bf16_f32 v141, v186, v187
v_cvt_pk_bf16_f32 v142, v188, v189
v_cvt_pk_bf16_f32 v143, v190, v191
buffer_store_dwordx4 v[140:143], v123, s[20:23], s45 offen
s_endpgm
L_nh:
s_waitcnt vmcnt(13)
s_barrier
v_bfe_u32 v6, v1, 4, 1
v_lshl_add_u32 v6, v6, 8, v24
s_lshl_b32 s77, s29, 9
s_add_u32 s77, s77, 33570816
s_waitcnt lgkmcnt(6)
v_mfma_f32_16x16x32_bf16 v[128:131], v[40:43], v[72:75], v[128:131]
s_add_u32 m0, s98, 114688
s_add_u32 s97, s99, 0
v_mfma_f32_16x16x32_bf16 v[132:135], v[40:43], v[76:79], v[132:135]
ds_read_b128 v[56:59], v16 offset:32768
buffer_load_dwordx4 v120, s[16:19], s97 offen offset:0 lds
v_mfma_f32_16x16x32_bf16 v[136:139], v[40:43], v[80:83], v[136:139]
v_mfma_f32_16x16x32_bf16 v[140:143], v[40:43], v[84:87], v[140:143]
ds_read_b128 v[60:63], v16 offset:34816
ds_read_b64_tr_b16 v[40:41], v12 offset:0
s_movk_i32 s63, 10
s_add_u32 s64, s64, s64
s_cbranch_scc1 L_xs
L_xr10:
s_waitcnt lgkmcnt(7)
v_mfma_f32_16x16x32_bf16 v[156:159], v[44:47], v[84:87], v[156:159]
ds_read_b64_tr_b16 v[42:43], v12 offset:1792
v_mfma_f32_16x16x32_bf16 v[152:155], v[44:47], v[80:83], v[152:155]
ds_read_b128 v[64:67], v16 offset:36864
v_mfma_f32_16x16x32_bf16 v[148:151], v[44:47], v[76:79], v[148:151]
v_mfma_f32_16x16x32_bf16 v[144:147], v[44:47], v[72:75], v[144:147]
ds_read_b128 v[68:71], v16 offset:38912
ds_read_b64_tr_b16 v[44:45], v13 offset:0
s_waitcnt lgkmcnt(9)
v_mfma_f32_16x16x32_bf16 v[160:163], v[48:51], v[72:75], v[160:163]
ds_read_b64_tr_b16 v[46:47], v13 offset:1792
v_mfma_f32_16x16x32_bf16 v[164:167], v[48:51], v[76:79], v[164:167]
buffer_load_dwordx4 v121, s[16:19], s97 offen offset:1024 lds
v_mfma_f32_16x16x32_bf16 v[168:171], v[48:51], v[80:83], v[168:171]
v_mfma_f32_16x16x32_bf16 v[172:175], v[48:51], v[84:87], v[172:175]
ds_read_b64_tr_b16 v[48:49], v14 offset:0
s_waitcnt lgkmcnt(9)
v_mfma_f32_16x16x32_bf16 v[188:191], v[52:55], v[84:87], v[188:191]
ds_read_b64_tr_b16 v[50:51], v14 offset:1792
v_mfma_f32_16x16x32_bf16 v[184:187], v[52:55], v[80:83], v[184:187]
v_mfma_f32_16x16x32_bf16 v[180:183], v[52:55], v[76:79], v[180:183]
v_mfma_f32_16x16x32_bf16 v[176:179], v[52:55], v[72:75], v[176:179]
ds_read_b64_tr_b16 v[52:53], v15 offset:0
ds_read_b64_tr_b16 v[54:55], v15 offset:1792
s_waitcnt lgkmcnt(6)
v_mfma_f32_16x16x32_bf16 v[128:131], v[40:43], v[56:59], v[128:131]
v_mfma_f32_16x16x32_bf16 v[132:135], v[40:43], v[60:63], v[132:135]
ds_read_b128 v[72:75], v17 offset:32768
buffer_load_dword v22, v21, s[12:15], s26 offen offset:32 sc0 sc1
v_mfma_f32_16x16x32_bf16 v[136:139], v[40:43], v[64:67], v[136:139]
v_mfma_f32_16x16x32_bf16 v[140:143], v[40:43], v[68:71], v[140:143]
ds_read_b128 v[76:79], v17 offset:34816
ds_read_b64_tr_b16 v[40:41], v12 offset:14336
s_waitcnt lgkmcnt(7)
v_mfma_f32_16x16x32_bf16 v[156:159], v[44:47], v[68:71], v[156:159]
ds_read_b64_tr_b16 v[42:43], v12 offset:16128
v_mfma_f32_16x16x32_bf16 v[152:155], v[44:47], v[64:67], v[152:155]
ds_read_b128 v[80:83], v17 offset:36864
v_mfma_f32_16x16x32_bf16 v[148:151], v[44:47], v[60:63], v[148:151]
v_mfma_f32_16x16x32_bf16 v[144:147], v[44:47], v[56:59], v[144:147]
ds_read_b128 v[84:87], v17 offset:38912
ds_read_b64_tr_b16 v[44:45], v13 offset:14336
s_waitcnt lgkmcnt(9)
v_mfma_f32_16x16x32_bf16 v[160:163], v[48:51], v[56:59], v[160:163]
ds_read_b64_tr_b16 v[46:47], v13 offset:16128
v_mfma_f32_16x16x32_bf16 v[164:167], v[48:51], v[60:63], v[164:167]
buffer_load_dwordx4 v[2:5], v6, s[12:15], s77 offen sc0 sc1
v_mfma_f32_16x16x32_bf16 v[168:171], v[48:51], v[64:67], v[168:171]
v_mfma_f32_16x16x32_bf16 v[172:175], v[48:51], v[68:71], v[172:175]
ds_read_b64_tr_b16 v[48:49], v14 offset:14336
s_waitcnt lgkmcnt(9)
v_mfma_f32_16x16x32_bf16 v[188:191], v[52:55], v[68:71], v[188:191]
ds_read_b64_tr_b16 v[50:51], v14 offset:16128
v_mfma_f32_16x16x32_bf16 v[184:187], v[52:55], v[64:67], v[184:187]
v_mfma_f32_16x16x32_bf16 v[180:183], v[52:55], v[60:63], v[180:183]
v_mfma_f32_16x16x32_bf16 v[176:179], v[52:55], v[56:59], v[176:179]
ds_read_b64_tr_b16 v[52:53], v15 offset:14336
ds_read_b64_tr_b16 v[54:55], v15 offset:16128
s_waitcnt vmcnt(11)
s_barrier
s_waitcnt lgkmcnt(6)
v_mfma_f32_16x16x32_bf16 v[128:131], v[40:43], v[72:75], v[128:131]
s_add_u32 m0, s98, 131072
s_add_u32 s97, s99, 262144
v_mfma_f32_16x16x32_bf16 v[132:135], v[40:43], v[76:79], v[132:135]
ds_read_b128 v[56:59], v16 offset:0
buffer_load_dwordx4 v120, s[16:19], s97 offen offset:0 lds
v_mfma_f32_16x16x32_bf16 v[136:139], v[40:43], v[80:83], v[136:139]
v_mfma_f32_16x16x32_bf16 v[140:143], v[40:43], v[84:87], v[140:143]
ds_read_b128 v[60:63], v16 offset:2048
ds_read_b64_tr_b16 v[40:41], v8 offset:0
s_movk_i32 s63, 11
s_add_u32 s64, s64, s64
s_cbranch_scc1 L_xs
L_xr11:
s_waitcnt lgkmcnt(7)
v_mfma_f32_16x16x32_bf16 v[156:159], v[44:47], v[84:87], v[156:159]
ds_read_b64_tr_b16 v[42:43], v8 offset:1792
v_mfma_f32_16x16x32_bf16 v[152:155], v[44:47], v[80:83], v[152:155]
ds_read_b128 v[64:67], v16 offset:4096
v_mfma_f32_16x16x32_bf16 v[148:151], v[44:47], v[76:79], v[148:151]
v_mfma_f32_16x16x32_bf16 v[144:147], v[44:47], v[72:75], v[144:147]
ds_read_b128 v[68:71], v16 offset:6144
ds_read_b64_tr_b16 v[44:45], v9 offset:0
s_waitcnt lgkmcnt(9)
v_mfma_f32_16x16x32_bf16 v[160:163], v[48:51], v[72:75], v[160:163]
ds_read_b64_tr_b16 v[46:47], v9 offset:1792
s_waitcnt vmcnt(7)
v_mfma_f32_16x16x32_bf16 v[164:167], v[48:51], v[76:79], v[164:167]
v_mov_b32 v240, v252
v_mfma_f32_16x16x32_bf16 v[168:171], v[48:51], v[80:83], v[168:171]
v_mov_b32 v241, v252
v_mfma_f32_16x16x32_bf16 v[172:175], v[48:51], v[84:87], v[172:175]
ds_read_b64_tr_b16 v[48:49], v10 offset:0
v_mov_b32 v242, v252
s_waitcnt lgkmcnt(9)
v_mfma_f32_16x16x32_bf16 v[188:191], v[52:55], v[84:87], v[188:191]
ds_read_b64_tr_b16 v[50:51], v10 offset:1792
v_mov_b32 v243, v252
v_mfma_f32_16x16x32_bf16 v[184:187], v[52:55], v[80:83], v[184:187]
v_mov_b32 v244, v253
v_mfma_f32_16x16x32_bf16 v[180:183], v[52:55], v[76:79], v[180:183]
v_mov_b32 v245, v253
v_mfma_f32_16x16x32_bf16 v[176:179], v[52:55], v[72:75], v[176:179]
ds_read_b64_tr_b16 v[52:53], v11 offset:0
ds_read_b64_tr_b16 v[54:55], v11 offset:1792
v_mov_b32 v246, v253
s_waitcnt lgkmcnt(6)
v_mfma_f32_16x16x32_bf16 v[128:131], v[40:43], v[56:59], v[128:131]
v_mov_b32 v247, v253
v_mfma_f32_16x16x32_bf16 v[132:135], v[40:43], v[60:63], v[132:135]
ds_read_b128 v[72:75], v17 offset:0
buffer_load_dwordx4 v121, s[16:19], s97 offen offset:1024 lds
v_mov_b32 v248, v254
v_mfma_f32_16x16x32_bf16 v[136:139], v[40:43], v[64:67], v[136:139]
v_mov_b32 v249, v254
v_mfma_f32_16x16x32_bf16 v[140:143], v[40:43], v[68:71], v[140:143]
ds_read_b128 v[76:79], v17 offset:2048
ds_read_b64_tr_b16 v[40:41], v8 offset:14336
v_mov_b32 v250, v254
s_waitcnt lgkmcnt(7)
v_mfma_f32_16x16x32_bf16 v[156:159], v[44:47], v[68:71], v[156:159]
ds_read_b64_tr_b16 v[42:43], v8 offset:16128
v_mov_b32 v251, v254
v_mfma_f32_16x16x32_bf16 v[152:155], v[44:47], v[64:67], v[152:155]
ds_read_b128 v[80:83], v17 offset:4096
v_mov_b32 v252, v255
v_mfma_f32_16x16x32_bf16 v[148:151], v[44:47], v[60:63], v[148:151]
v_mov_b32 v253, v255
v_mfma_f32_16x16x32_bf16 v[144:147], v[44:47], v[56:59], v[144:147]
ds_read_b128 v[84:87], v17 offset:6144
ds_read_b64_tr_b16 v[44:45], v9 offset:14336
v_mov_b32 v254, v255
s_waitcnt lgkmcnt(9)
v_mfma_f32_16x16x32_bf16 v[160:163], v[48:51], v[56:59], v[160:163]
ds_read_b64_tr_b16 v[46:47], v9 offset:16128
v_mfma_f32_16x16x32_bf16 v[164:167], v[48:51], v[60:63], v[164:167]
v_mfma_f32_16x16x32_bf16 v[168:171], v[48:51], v[64:67], v[168:171]
v_mfma_f32_16x16x32_bf16 v[172:175], v[48:51], v[68:71], v[172:175]
ds_read_b64_tr_b16 v[48:49], v10 offset:14336
s_waitcnt lgkmcnt(9)
v_mfma_f32_16x16x32_bf16 v[188:191], v[52:55], v[68:71], v[188:191]
ds_read_b64_tr_b16 v[50:51], v10 offset:16128
v_mfma_f32_16x16x32_bf16 v[184:187], v[52:55], v[64:67], v[184:187]
v_mfma_f32_16x16x32_bf16 v[180:183], v[52:55], v[60:63], v[180:183]
v_mfma_f32_16x16x32_bf16 v[176:179], v[52:55], v[56:59], v[176:179]
ds_read_b64_tr_b16 v[52:53], v11 offset:14336
ds_read_b64_tr_b16 v[54:55], v11 offset:16128
s_waitcnt vmcnt(2)
v_cmp_ne_u32 vcc, s3, v22
s_lshl_b32 s39, s30, 3
s_nop 0
s_lshr_b32 s39, vcc_lo, s39
s_and_b32 s39, s39, 0xff
s_cselect_b32 s27, 0, 1
v_mfma_f32_16x16x32_bf16 v[128:131], v[224:227], v[240:243], v[128:131]
s_mul_i32 s36, s29, 917504
v_mfma_f32_16x16x32_bf16 v[132:135], v[224:227], v[244:247], v[132:135]
s_mul_i32 s37, s34, 14336
v_mfma_f32_16x16x32_bf16 v[136:139], v[224:227], v[248:251], v[136:139]
s_add_u32 s36, s36, s37
v_mfma_f32_16x16x32_bf16 v[140:143], v[224:227], v[252:255], v[140:143]
s_min_u32 s37, s28, 6
v_mfma_f32_16x16x32_bf16 v[144:147], v[228:231], v[240:243], v[144:147]
s_lshl_b32 s37, s37, 11
v_mfma_f32_16x16x32_bf16 v[148:151], v[228:231], v[244:247], v[148:151]
s_lshl_b32 s38, s32, 10
v_mfma_f32_16x16x32_bf16 v[152:155], v[228:231], v[248:251], v[152:155]
s_add_u32 s37, s37, s38
v_mfma_f32_16x16x32_bf16 v[156:159], v[228:231], v[252:255], v[156:159]
v_add_u32 v26, s37, v18
v_mfma_f32_16x16x32_bf16 v[160:163], v[232:235], v[240:243], v[160:163]
v_xor_b32 v27, 2048, v26
v_mfma_f32_16x16x32_bf16 v[164:167], v[232:235], v[244:247], v[164:167]
s_add_u32 s78, s36, 229376
v_mfma_f32_16x16x32_bf16 v[168:171], v[232:235], v[248:251], v[168:171]
s_add_u32 s79, s36, 458752
v_mfma_f32_16x16x32_bf16 v[172:175], v[232:235], v[252:255], v[172:175]
s_add_u32 s37, s36, 688128
v_mfma_f32_16x16x32_bf16 v[176:179], v[236:239], v[240:243], v[176:179]
v_add_u32 v28, 32768, v26
v_mfma_f32_16x16x32_bf16 v[180:183], v[236:239], v[244:247], v[180:183]
v_add_u32 v29, 32768, v27
v_mfma_f32_16x16x32_bf16 v[184:187], v[236:239], v[248:251], v[184:187]
v_mfma_f32_16x16x32_bf16 v[188:191], v[236:239], v[252:255], v[188:191]
s_cmp_lg_u32 s27, 0
s_cbranch_scc1 LTH_l
s_waitcnt lgkmcnt(6)
v_mfma_f32_16x16x32_bf16 v[128:131], v[40:43], v[72:75], v[128:131]
v_mfma_f32_16x16x32_bf16 v[132:135], v[40:43], v[76:79], v[132:135]
v_mfma_f32_16x16x32_bf16 v[136:139], v[40:43], v[80:83], v[136:139]
v_mfma_f32_16x16x32_bf16 v[140:143], v[40:43], v[84:87], v[140:143]
s_waitcnt lgkmcnt(4)
v_mfma_f32_16x16x32_bf16 v[156:159], v[44:47], v[84:87], v[156:159]
v_mfma_f32_16x16x32_bf16 v[152:155], v[44:47], v[80:83], v[152:155]
v_mfma_f32_16x16x32_bf16 v[148:151], v[44:47], v[76:79], v[148:151]
v_cvt_pk_bf16_f32 v140, v140, v141
v_cvt_pk_bf16_f32 v141, v142, v143
v_cvt_pk_bf16_f32 v142, v156, v157
v_cvt_pk_bf16_f32 v143, v158, v159
v_pk_max_i16 v140, v140, 0
v_mfma_f32_16x16x32_bf16 v[144:147], v[44:47], v[72:75], v[144:147]
v_pk_max_i16 v141, v141, 0
v_pk_max_i16 v142, v142, 0
v_pk_max_i16 v143, v143, 0
buffer_store_dwordx4 v[140:143], v26, s[12:15], s37 offen sc0 sc1
ds_write_b128 v28, v[140:143] offset:43008
s_waitcnt lgkmcnt(3)
v_mfma_f32_16x16x32_bf16 v[160:163], v[48:51], v[72:75], v[160:163]
v_cvt_pk_bf16_f32 v136, v136, v137
v_cvt_pk_bf16_f32 v137, v138, v139
v_cvt_pk_bf16_f32 v138, v152, v153
v_cvt_pk_bf16_f32 v139, v154, v155
v_pk_max_i16 v136, v136, 0
v_mfma_f32_16x16x32_bf16 v[164:167], v[48:51], v[76:79], v[164:167]
v_pk_max_i16 v137, v137, 0
v_pk_max_i16 v138, v138, 0
v_pk_max_i16 v139, v139, 0
buffer_store_dwordx4 v[136:139], v26, s[12:15], s79 offen sc0 sc1
ds_write_b128 v28, v[136:139] offset:28672
v_mfma_f32_16x16x32_bf16 v[168:171], v[48:51], v[80:83], v[168:171]
v_cvt_pk_bf16_f32 v132, v132, v133
v_cvt_pk_bf16_f32 v133, v134, v135
v_cvt_pk_bf16_f32 v134, v148, v149
v_cvt_pk_bf16_f32 v135, v150, v151
v_pk_max_i16 v132, v132, 0
v_mfma_f32_16x16x32_bf16 v[172:175], v[48:51], v[84:87], v[172:175]
v_pk_max_i16 v133, v133, 0
v_pk_max_i16 v134, v134, 0
v_pk_max_i16 v135, v135, 0
buffer_store_dwordx4 v[132:135], v26, s[12:15], s78 offen sc0 sc1
ds_write_b128 v26, v[132:135] offset:47104
s_waitcnt lgkmcnt(3)
v_mfma_f32_16x16x32_bf16 v[188:191], v[52:55], v[84:87], v[188:191]
v_cvt_pk_bf16_f32 v128, v128, v129
v_cvt_pk_bf16_f32 v129, v130, v131
v_cvt_pk_bf16_f32 v130, v144, v145
v_cvt_pk_bf16_f32 v131, v146, v147
v_pk_max_i16 v128, v128, 0
v_mfma_f32_16x16x32_bf16 v[184:187], v[52:55], v[80:83], v[184:187]
v_pk_max_i16 v129, v129, 0
v_pk_max_i16 v130, v130, 0
v_pk_max_i16 v131, v131, 0
buffer_store_dwordx4 v[128:131], v26, s[12:15], s36 offen sc0 sc1
ds_write_b128 v26, v[128:131] offset:32768
v_mfma_f32_16x16x32_bf16 v[180:183], v[52:55], v[76:79], v[180:183]
v_mfma_f32_16x16x32_bf16 v[176:179], v[52:55], v[72:75], v[176:179]
v_cvt_pk_bf16_f32 v172, v172, v173
v_cvt_pk_bf16_f32 v173, v174, v175
v_cvt_pk_bf16_f32 v174, v188, v189
v_cvt_pk_bf16_f32 v175, v190, v191
v_pk_max_i16 v172, v172, 0
v_pk_max_i16 v173, v173, 0
v_pk_max_i16 v174, v174, 0
v_pk_max_i16 v175, v175, 0
buffer_store_dwordx4 v[172:175], v27, s[12:15], s37 offen sc0 sc1
ds_write_b128 v29, v[172:175] offset:43008
v_cvt_pk_bf16_f32 v168, v168, v169
v_cvt_pk_bf16_f32 v169, v170, v171
v_cvt_pk_bf16_f32 v170, v184, v185
v_cvt_pk_bf16_f32 v171, v186, v187
v_pk_max_i16 v168, v168, 0
v_pk_max_i16 v169, v169, 0
v_pk_max_i16 v170, v170, 0
v_pk_max_i16 v171, v171, 0
buffer_store_dwordx4 v[168:171], v27, s[12:15], s79 offen sc0 sc1
ds_write_b128 v29, v[168:171] offset:28672
v_cvt_pk_bf16_f32 v164, v164, v165
v_cvt_pk_bf16_f32 v165, v166, v167
v_cvt_pk_bf16_f32 v166, v180, v181
v_cvt_pk_bf16_f32 v167, v182, v183
v_pk_max_i16 v164, v164, 0
v_pk_max_i16 v165, v165, 0
v_pk_max_i16 v166, v166, 0
v_pk_max_i16 v167, v167, 0
buffer_store_dwordx4 v[164:167], v27, s[12:15], s78 offen sc0 sc1
ds_write_b128 v27, v[164:167] offset:47104
v_cvt_pk_bf16_f32 v160, v160, v161
v_cvt_pk_bf16_f32 v161, v162, v163
v_cvt_pk_bf16_f32 v162, v176, v177
v_cvt_pk_bf16_f32 v163, v178, v179
v_pk_max_i16 v160, v160, 0
v_pk_max_i16 v161, v161, 0
v_pk_max_i16 v162, v162, 0
v_pk_max_i16 v163, v163, 0
buffer_store_dwordx4 v[160:163], v27, s[12:15], s36 offen sc0 sc1
ds_write_b128 v27, v[160:163] offset:32768
s_branch LTH_j
LTH_l:
s_waitcnt lgkmcnt(6)
v_mfma_f32_16x16x32_bf16 v[128:131], v[40:43], v[72:75], v[128:131]
v_mfma_f32_16x16x32_bf16 v[132:135], v[40:43], v[76:79], v[132:135]
v_mfma_f32_16x16x32_bf16 v[136:139], v[40:43], v[80:83], v[136:139]
v_mfma_f32_16x16x32_bf16 v[140:143], v[40:43], v[84:87], v[140:143]
s_waitcnt lgkmcnt(4)
v_mfma_f32_16x16x32_bf16 v[156:159], v[44:47], v[84:87], v[156:159]
v_mfma_f32_16x16x32_bf16 v[152:155], v[44:47], v[80:83], v[152:155]
v_mfma_f32_16x16x32_bf16 v[148:151], v[44:47], v[76:79], v[148:151]
v_cvt_pk_bf16_f32 v140, v140, v141
v_cvt_pk_bf16_f32 v141, v142, v143
v_cvt_pk_bf16_f32 v142, v156, v157
v_cvt_pk_bf16_f32 v143, v158, v159
v_pk_max_i16 v140, v140, 0
v_mfma_f32_16x16x32_bf16 v[144:147], v[44:47], v[72:75], v[144:147]
v_pk_max_i16 v141, v141, 0
v_pk_max_i16 v142, v142, 0
v_pk_max_i16 v143, v143, 0
buffer_store_dwordx4 v[140:143], v26, s[12:15], s37 offen sc1
ds_write_b128 v28, v[140:143] offset:43008
s_waitcnt lgkmcnt(3)
v_mfma_f32_16x16x32_bf16 v[160:163], v[48:51], v[72:75], v[160:163]
v_cvt_pk_bf16_f32 v136, v136, v137
v_cvt_pk_bf16_f32 v137, v138, v139
v_cvt_pk_bf16_f32 v138, v152, v153
v_cvt_pk_bf16_f32 v139, v154, v155
v_pk_max_i16 v136, v136, 0
v_mfma_f32_16x16x32_bf16 v[164:167], v[48:51], v[76:79], v[164:167]
v_pk_max_i16 v137, v137, 0
v_pk_max_i16 v138, v138, 0
v_pk_max_i16 v139, v139, 0
buffer_store_dwordx4 v[136:139], v26, s[12:15], s79 offen sc1
ds_write_b128 v28, v[136:139] offset:28672
v_mfma_f32_16x16x32_bf16 v[168:171], v[48:51], v[80:83], v[168:171]
v_cvt_pk_bf16_f32 v132, v132, v133
v_cvt_pk_bf16_f32 v133, v134, v135
v_cvt_pk_bf16_f32 v134, v148, v149
v_cvt_pk_bf16_f32 v135, v150, v151
v_pk_max_i16 v132, v132, 0
v_mfma_f32_16x16x32_bf16 v[172:175], v[48:51], v[84:87], v[172:175]
v_pk_max_i16 v133, v133, 0
v_pk_max_i16 v134, v134, 0
v_pk_max_i16 v135, v135, 0
buffer_store_dwordx4 v[132:135], v26, s[12:15], s78 offen sc1
ds_write_b128 v26, v[132:135] offset:47104
s_waitcnt lgkmcnt(3)
v_mfma_f32_16x16x32_bf16 v[188:191], v[52:55], v[84:87], v[188:191]
v_cvt_pk_bf16_f32 v128, v128, v129
v_cvt_pk_bf16_f32 v129, v130, v131
v_cvt_pk_bf16_f32 v130, v144, v145
v_cvt_pk_bf16_f32 v131, v146, v147
v_pk_max_i16 v128, v128, 0
v_mfma_f32_16x16x32_bf16 v[184:187], v[52:55], v[80:83], v[184:187]
v_pk_max_i16 v129, v129, 0
v_pk_max_i16 v130, v130, 0
v_pk_max_i16 v131, v131, 0
buffer_store_dwordx4 v[128:131], v26, s[12:15], s36 offen sc1
ds_write_b128 v26, v[128:131] offset:32768
v_mfma_f32_16x16x32_bf16 v[180:183], v[52:55], v[76:79], v[180:183]
v_mfma_f32_16x16x32_bf16 v[176:179], v[52:55], v[72:75], v[176:179]
v_cvt_pk_bf16_f32 v172, v172, v173
v_cvt_pk_bf16_f32 v173, v174, v175
v_cvt_pk_bf16_f32 v174, v188, v189
v_cvt_pk_bf16_f32 v175, v190, v191
v_pk_max_i16 v172, v172, 0
v_pk_max_i16 v173, v173, 0
v_pk_max_i16 v174, v174, 0
v_pk_max_i16 v175, v175, 0
buffer_store_dwordx4 v[172:175], v27, s[12:15], s37 offen sc1
ds_write_b128 v29, v[172:175] offset:43008
v_cvt_pk_bf16_f32 v168, v168, v169
v_cvt_pk_bf16_f32 v169, v170, v171
v_cvt_pk_bf16_f32 v170, v184, v185
v_cvt_pk_bf16_f32 v171, v186, v187
v_pk_max_i16 v168, v168, 0
v_pk_max_i16 v169, v169, 0
v_pk_max_i16 v170, v170, 0
v_pk_max_i16 v171, v171, 0
buffer_store_dwordx4 v[168:171], v27, s[12:15], s79 offen sc1
ds_write_b128 v29, v[168:171] offset:28672
v_cvt_pk_bf16_f32 v164, v164, v165
v_cvt_pk_bf16_f32 v165, v166, v167
v_cvt_pk_bf16_f32 v166, v180, v181
v_cvt_pk_bf16_f32 v167, v182, v183
v_pk_max_i16 v164, v164, 0
v_pk_max_i16 v165, v165, 0
v_pk_max_i16 v166, v166, 0
v_pk_max_i16 v167, v167, 0
buffer_store_dwordx4 v[164:167], v27, s[12:15], s78 offen sc1
ds_write_b128 v27, v[164:167] offset:47104
v_cvt_pk_bf16_f32 v160, v160, v161
v_cvt_pk_bf16_f32 v161, v162, v163
v_cvt_pk_bf16_f32 v162, v176, v177
v_cvt_pk_bf16_f32 v163, v178, v179
v_pk_max_i16 v160, v160, 0
v_pk_max_i16 v161, v161, 0
v_pk_max_i16 v162, v162, 0
v_pk_max_i16 v163, v163, 0
buffer_store_dwordx4 v[160:163], v27, s[12:15], s36 offen sc1
ds_write_b128 v27, v[160:163] offset:32768
LTH_j:
s_setprio 0
v_lshlrev_b32 v127, 2, v1
v_add_u32 v127, 97792, v127
v_cmp_lt_u32 vcc, 31, v1
v_mov_b32 v126, 3
s_nop 0
v_cndmask_b32 v126, v19, v126, vcc
ds_write_b32 v127, v126
ds_write_b32 v127, v19 offset:256
s_waitcnt lgkmcnt(0)
s_waitcnt vmcnt(8)
s_barrier
s_and_b32 s44, s28, 3
v_lshrrev_b32 v20, 3, v1
v_cmp_le_u32 vcc, s31, v20
s_nop 1
v_addc_co_u32 v20, vcc, 0, v20, vcc
v_and_b32 v20, 7, v20
v_and_b32 v21, 7, v1
v_lshlrev_b32 v21, 2, v21
v_lshl_add_u32 v20, v20, 7, v21
s_lshl_b32 s36, s29, 1
s_add_u32 s36, s36, s30
s_lshl_b32 s62, s36, 10
s_add_u32 s62, s62, 34603008
s_mov_b32 s58, 252249347
s_mov_b32 s59, 4280228115
s_mov_b32 s69, 4000
s_cmp_lg_u32 s27, 0
s_cbranch_scc1 HN_e1
buffer_load_dword v23, v20, s[12:15], s62 offen sc0 sc1
s_branch HN_e2
HN_e1:
buffer_load_dword v23, v20, s[12:15], s62 offen sc1
HN_e2:
s_waitcnt vmcnt(1)
s_mov_b64 exec, 1
s_cmp_lg_u32 s27, 0
s_cbranch_scc1 HN_hl
buffer_store_dword v0, v19, s[12:15], s48 offen sc0 sc1
s_branch HN_hj
HN_hl:
buffer_store_dword v0, v19, s[12:15], s48 offen
HN_hj:
s_mov_b64 exec, -1
s_waitcnt vmcnt(1)
s_cmp_lg_u32 s28, 4
s_cbranch_scc1 HN_gx
s_cmp_lg_u32 s27, 0
s_cbranch_scc1 HN_g1c
s_branch HN_g0c
s_cmp_lg_u32 s27, 0
s_cbranch_scc1 HN_g1
HN_g0:
HN_g0l:
buffer_load_dword v23, v20, s[12:15], s62 offen sc0 sc1
s_waitcnt vmcnt(0)
HN_g0c:
v_cmp_ne_u32 vcc, v0, v23
s_sub_u32 s69, s69, 1
s_cmp_eq_u32 s69, 0
s_cselect_b64 vcc, 0, vcc
s_ff1_i32_b64 s36, vcc
s_min_u32 s36, s36, 56
s_and_b32 s36, s36, 56
s_lshr_b64 s[38:39], s[58:59], s36
s_and_b32 s38, s38, 255
v_mov_b32 v22, s38
s_mov_b32 exec_lo, 0
ds_write_b32 v127, v22
s_mov_b32 exec_lo, -1
s_cmp_ge_u32 s36, 56
s_cbranch_scc1 HN_gy
s_branch HN_g0l
HN_g1:
HN_g1l:
buffer_load_dword v23, v20, s[12:15], s62 offen sc1
s_waitcnt vmcnt(0)
HN_g1c:
v_cmp_ne_u32 vcc, v0, v23
s_sub_u32 s69, s69, 1
s_cmp_eq_u32 s69, 0
s_cselect_b64 vcc, 0, vcc
s_ff1_i32_b64 s36, vcc
s_min_u32 s36, s36, 56
s_and_b32 s36, s36, 56
s_lshr_b64 s[38:39], s[58:59], s36
s_and_b32 s38, s38, 255
v_mov_b32 v22, s38
s_mov_b32 exec_lo, 0
ds_write_b32 v127, v22
s_mov_b32 exec_lo, -1
s_cmp_ge_u32 s36, 56
s_cbranch_scc1 HN_gy
s_branch HN_g1l
HN_gy:
s_waitcnt vmcnt(0)
HN_gz:
s_and_b32 s44, s28, 3
HN_gx:
v_and_b32 v20, 15, v1
v_lshl_add_u32 v20, v20, 2, s35
v_bfe_u32 v21, v1, 4, 1
v_lshl_add_u32 v20, v21, 1, v20
v_lshrrev_b32 v21, 5, v1
v_cmp_eq_u32 s[60:61], 0, v20
v_cvt_f32_u32 v28, v20
v_mul_f32 v28, 0x3a000000, v28
s_bitcmp1_b32 s44, 0
s_cselect_b32 s36, 0x3e800000, 0
s_cselect_b32 s37, 0x3f400000, 0
v_mov_b32 v22, s36
v_cndmask_b32 v28, v28, v22, s[60:61]
s_lshr_b32 s38, s44, 1
v_lshl_add_u32 v22, v21, 5, s38
v_cvt_f32_u32 v22, v22
v_fma_f32 v30, v28, v22, s37
v_fmamk_f32 v128, v28, 0x0, v30
v_fmamk_f32 v129, v28, 0x40800000, v30
v_fmamk_f32 v130, v28, 0x41000000, v30
v_fmamk_f32 v131, v28, 0x41400000, v30
v_fmamk_f32 v132, v28, 0x41800000, v30
v_fmamk_f32 v133, v28, 0x41a00000, v30
v_fmamk_f32 v134, v28, 0x41c00000, v30
v_fmamk_f32 v135, v28, 0x41e00000, v30
v_fmamk_f32 v136, v28, 0x42800000, v30
v_fmamk_f32 v137, v28, 0x42880000, v30
v_fmamk_f32 v138, v28, 0x42900000, v30
v_fmamk_f32 v139, v28, 0x42980000, v30
v_fmamk_f32 v140, v28, 0x42a00000, v30
v_fmamk_f32 v141, v28, 0x42a80000, v30
v_fmamk_f32 v142, v28, 0x42b00000, v30
v_fmamk_f32 v143, v28, 0x42b80000, v30
v_fmamk_f32 v144, v28, 0x40000000, v30
v_fmamk_f32 v145, v28, 0x40c00000, v30
v_fmamk_f32 v146, v28, 0x41200000, v30
v_fmamk_f32 v147, v28, 0x41600000, v30
v_fmamk_f32 v148, v28, 0x41900000, v30
v_fmamk_f32 v149, v28, 0x41b00000, v30
v_fmamk_f32 v150, v28, 0x41d00000, v30
v_fmamk_f32 v151, v28, 0x41f00000, v30
v_fmamk_f32 v152, v28, 0x42840000, v30
v_fmamk_f32 v153, v28, 0x428c0000, v30
v_fmamk_f32 v154, v28, 0x42940000, v30
v_fmamk_f32 v155, v28, 0x429c0000, v30
v_fmamk_f32 v156, v28, 0x42a40000, v30
v_fmamk_f32 v157, v28, 0x42ac0000, v30
v_fmamk_f32 v158, v28, 0x42b40000, v30
v_fmamk_f32 v159, v28, 0x42bc0000, v30
v_mul_f32 v36, 0x42800000, v28
v_mov_b32 v32, s37
v_fmac_f32 v32, 0x44000000, v28
v_fract_f32 v128, v128
v_fract_f32 v129, v129
v_fract_f32 v130, v130
v_fract_f32 v131, v131
v_fract_f32 v132, v132
v_fract_f32 v133, v133
v_fract_f32 v134, v134
v_fract_f32 v135, v135
v_fract_f32 v136, v136
v_fract_f32 v137, v137
v_fract_f32 v138, v138
v_fract_f32 v139, v139
v_fract_f32 v140, v140
v_fract_f32 v141, v141
v_fract_f32 v142, v142
v_fract_f32 v143, v143
v_fract_f32 v144, v144
v_fract_f32 v145, v145
v_fract_f32 v146, v146
v_fract_f32 v147, v147
v_fract_f32 v148, v148
v_fract_f32 v149, v149
v_fract_f32 v150, v150
v_fract_f32 v151, v151
v_fract_f32 v152, v152
v_fract_f32 v153, v153
v_fract_f32 v154, v154
v_fract_f32 v155, v155
v_fract_f32 v156, v156
v_fract_f32 v157, v157
v_fract_f32 v158, v158
v_fract_f32 v159, v159
v_fract_f32 v36, v36
v_fract_f32 v32, v32
v_cos_f32 v128, v128
v_cos_f32 v129, v129
v_cos_f32 v130, v130
v_cos_f32 v131, v131
v_cos_f32 v132, v132
v_cos_f32 v133, v133
v_cos_f32 v134, v134
v_cos_f32 v135, v135
v_cos_f32 v136, v136
v_cos_f32 v137, v137
v_cos_f32 v138, v138
v_cos_f32 v139, v139
v_cos_f32 v140, v140
v_cos_f32 v141, v141
v_cos_f32 v142, v142
v_cos_f32 v143, v143
v_cos_f32 v144, v144
v_cos_f32 v145, v145
v_cos_f32 v146, v146
v_cos_f32 v147, v147
v_cos_f32 v148, v148
v_cos_f32 v149, v149
v_cos_f32 v150, v150
v_cos_f32 v151, v151
v_cos_f32 v152, v152
v_cos_f32 v153, v153
v_cos_f32 v154, v154
v_cos_f32 v155, v155
v_cos_f32 v156, v156
v_cos_f32 v157, v157
v_cos_f32 v158, v158
v_cos_f32 v159, v159
v_cos_f32 v36, v36
v_cos_f32 v32, v32
s_nop 0
v_add_f32 v36, v36, v36
v_mov_b32 v37, v36
v_cvt_pk_bf16_f32 v40, v128, v129
v_cvt_pk_bf16_f32 v41, v130, v131
v_cvt_pk_bf16_f32 v42, v132, v133
v_cvt_pk_bf16_f32 v43, v134, v135
v_cvt_pk_bf16_f32 v44, v144, v145
v_cvt_pk_bf16_f32 v45, v146, v147
v_cvt_pk_bf16_f32 v46, v148, v149
v_cvt_pk_bf16_f32 v47, v150, v151
v_cvt_pk_bf16_f32 v22, v32, v129
s_cmp_eq_u32 s44, 1
s_cselect_b32 s58, -1, 0
s_mov_b32 s59, 0
v_cndmask_b32 v40, v40, v22, s[58:59]
v_cvt_pk_bf16_f32 v48, v136, v137
v_cvt_pk_bf16_f32 v49, v138, v139
v_cvt_pk_bf16_f32 v50, v140, v141
v_cvt_pk_bf16_f32 v51, v142, v143
v_cvt_pk_bf16_f32 v52, v152, v153
v_cvt_pk_bf16_f32 v53, v154, v155
v_cvt_pk_bf16_f32 v54, v156, v157
v_cvt_pk_bf16_f32 v55, v158, v159
v_pk_fma_f32 v[128:129], v[136:137], v[36:37], v[128:129] neg_lo:[0,0,1] neg_hi:[0,0,1]
v_pk_fma_f32 v[130:131], v[138:139], v[36:37], v[130:131] neg_lo:[0,0,1] neg_hi:[0,0,1]
v_pk_fma_f32 v[132:133], v[140:141], v[36:37], v[132:133] neg_lo:[0,0,1] neg_hi:[0,0,1]
v_pk_fma_f32 v[134:135], v[142:143], v[36:37], v[134:135] neg_lo:[0,0,1] neg_hi:[0,0,1]
v_pk_fma_f32 v[144:145], v[152:153], v[36:37], v[144:145] neg_lo:[0,0,1] neg_hi:[0,0,1]
v_pk_fma_f32 v[146:147], v[154:155], v[36:37], v[146:147] neg_lo:[0,0,1] neg_hi:[0,0,1]
v_pk_fma_f32 v[148:149], v[156:157], v[36:37], v[148:149] neg_lo:[0,0,1] neg_hi:[0,0,1]
v_pk_fma_f32 v[150:151], v[158:159], v[36:37], v[150:151] neg_lo:[0,0,1] neg_hi:[0,0,1]
v_cvt_pk_bf16_f32 v56, v128, v129
v_cvt_pk_bf16_f32 v57, v130, v131
v_cvt_pk_bf16_f32 v58, v132, v133
v_cvt_pk_bf16_f32 v59, v134, v135
v_cvt_pk_bf16_f32 v60, v144, v145
v_cvt_pk_bf16_f32 v61, v146, v147
v_cvt_pk_bf16_f32 v62, v148, v149
v_cvt_pk_bf16_f32 v63, v150, v151
v_pk_fma_f32 v[136:137], v[128:129], v[36:37], v[136:137] neg_lo:[0,0,1] neg_hi:[0,0,1]
v_pk_fma_f32 v[138:139], v[130:131], v[36:37], v[138:139] neg_lo:[0,0,1] neg_hi:[0,0,1]
v_pk_fma_f32 v[140:141], v[132:133], v[36:37], v[140:141] neg_lo:[0,0,1] neg_hi:[0,0,1]
v_pk_fma_f32 v[142:143], v[134:135], v[36:37], v[142:143] neg_lo:[0,0,1] neg_hi:[0,0,1]
v_pk_fma_f32 v[152:153], v[144:145], v[36:37], v[152:153] neg_lo:[0,0,1] neg_hi:[0,0,1]
v_pk_fma_f32 v[154:155], v[146:147], v[36:37], v[154:155] neg_lo:[0,0,1] neg_hi:[0,0,1]
v_pk_fma_f32 v[156:157], v[148:149], v[36:37], v[156:157] neg_lo:[0,0,1] neg_hi:[0,0,1]
v_pk_fma_f32 v[158:159], v[150:151], v[36:37], v[158:159] neg_lo:[0,0,1] neg_hi:[0,0,1]
v_cvt_pk_bf16_f32 v64, v136, v137
v_cvt_pk_bf16_f32 v65, v138, v139
v_cvt_pk_bf16_f32 v66, v140, v141
v_cvt_pk_bf16_f32 v67, v142, v143
v_cvt_pk_bf16_f32 v68, v152, v153
v_cvt_pk_bf16_f32 v69, v154, v155
v_cvt_pk_bf16_f32 v70, v156, v157
v_cvt_pk_bf16_f32 v71, v158, v159
v_pk_fma_f32 v[128:129], v[136:137], v[36:37], v[128:129] neg_lo:[0,0,1] neg_hi:[0,0,1]
v_pk_fma_f32 v[130:131], v[138:139], v[36:37], v[130:131] neg_lo:[0,0,1] neg_hi:[0,0,1]
v_pk_fma_f32 v[132:133], v[140:141], v[36:37], v[132:133] neg_lo:[0,0,1] neg_hi:[0,0,1]
v_pk_fma_f32 v[134:135], v[142:143], v[36:37], v[134:135] neg_lo:[0,0,1] neg_hi:[0,0,1]
v_pk_fma_f32 v[144:145], v[152:153], v[36:37], v[144:145] neg_lo:[0,0,1] neg_hi:[0,0,1]
v_pk_fma_f32 v[146:147], v[154:155], v[36:37], v[146:147] neg_lo:[0,0,1] neg_hi:[0,0,1]
v_pk_fma_f32 v[148:149], v[156:157], v[36:37], v[148:149] neg_lo:[0,0,1] neg_hi:[0,0,1]
v_pk_fma_f32 v[150:151], v[158:159], v[36:37], v[150:151] neg_lo:[0,0,1] neg_hi:[0,0,1]
v_cvt_pk_bf16_f32 v72, v128, v129
v_cvt_pk_bf16_f32 v73, v130, v131
v_cvt_pk_bf16_f32 v74, v132, v133
v_cvt_pk_bf16_f32 v75, v134, v135
v_cvt_pk_bf16_f32 v76, v144, v145
v_cvt_pk_bf16_f32 v77, v146, v147
v_cvt_pk_bf16_f32 v78, v148, v149
v_cvt_pk_bf16_f32 v79, v150, v151
v_pk_fma_f32 v[136:137], v[128:129], v[36:37], v[136:137] neg_lo:[0,0,1] neg_hi:[0,0,1]
v_pk_fma_f32 v[138:139], v[130:131], v[36:37], v[138:139] neg_lo:[0,0,1] neg_hi:[0,0,1]
v_pk_fma_f32 v[140:141], v[132:133], v[36:37], v[140:141] neg_lo:[0,0,1] neg_hi:[0,0,1]
v_pk_fma_f32 v[142:143], v[134:135], v[36:37], v[142:143] neg_lo:[0,0,1] neg_hi:[0,0,1]
v_pk_fma_f32 v[152:153], v[144:145], v[36:37], v[152:153] neg_lo:[0,0,1] neg_hi:[0,0,1]
v_pk_fma_f32 v[154:155], v[146:147], v[36:37], v[154:155] neg_lo:[0,0,1] neg_hi:[0,0,1]
v_pk_fma_f32 v[156:157], v[148:149], v[36:37], v[156:157] neg_lo:[0,0,1] neg_hi:[0,0,1]
v_pk_fma_f32 v[158:159], v[150:151], v[36:37], v[158:159] neg_lo:[0,0,1] neg_hi:[0,0,1]
v_cvt_pk_bf16_f32 v80, v136, v137
v_cvt_pk_bf16_f32 v81, v138, v139
v_cvt_pk_bf16_f32 v82, v140, v141
v_cvt_pk_bf16_f32 v83, v142, v143
v_cvt_pk_bf16_f32 v84, v152, v153
v_cvt_pk_bf16_f32 v85, v154, v155
v_cvt_pk_bf16_f32 v86, v156, v157
v_cvt_pk_bf16_f32 v87, v158, v159
v_pk_fma_f32 v[128:129], v[136:137], v[36:37], v[128:129] neg_lo:[0,0,1] neg_hi:[0,0,1]
v_pk_fma_f32 v[130:131], v[138:139], v[36:37], v[130:131] neg_lo:[0,0,1] neg_hi:[0,0,1]
v_pk_fma_f32 v[132:133], v[140:141], v[36:37], v[132:133] neg_lo:[0,0,1] neg_hi:[0,0,1]
v_pk_fma_f32 v[134:135], v[142:143], v[36:37], v[134:135] neg_lo:[0,0,1] neg_hi:[0,0,1]
v_pk_fma_f32 v[144:145], v[152:153], v[36:37], v[144:145] neg_lo:[0,0,1] neg_hi:[0,0,1]
v_pk_fma_f32 v[146:147], v[154:155], v[36:37], v[146:147] neg_lo:[0,0,1] neg_hi:[0,0,1]
v_pk_fma_f32 v[148:149], v[156:157], v[36:37], v[148:149] neg_lo:[0,0,1] neg_hi:[0,0,1]
v_pk_fma_f32 v[150:151], v[158:159], v[36:37], v[150:151] neg_lo:[0,0,1] neg_hi:[0,0,1]
v_cvt_pk_bf16_f32 v88, v128, v129
v_cvt_pk_bf16_f32 v89, v130, v131
v_cvt_pk_bf16_f32 v90, v132, v133
v_cvt_pk_bf16_f32 v91, v134, v135
v_cvt_pk_bf16_f32 v92, v144, v145
v_cvt_pk_bf16_f32 v93, v146, v147
v_cvt_pk_bf16_f32 v94, v148, v149
v_cvt_pk_bf16_f32 v95, v150, v151
v_pk_fma_f32 v[136:137], v[128:129], v[36:37], v[136:137] neg_lo:[0,0,1] neg_hi:[0,0,1]
v_pk_fma_f32 v[138:139], v[130:131], v[36:37], v[138:139] neg_lo:[0,0,1] neg_hi:[0,0,1]
v_pk_fma_f32 v[140:141], v[132:133], v[36:37], v[140:141] neg_lo:[0,0,1] neg_hi:[0,0,1]
v_pk_fma_f32 v[142:143], v[134:135], v[36:37], v[142:143] neg_lo:[0,0,1] neg_hi:[0,0,1]
v_pk_fma_f32 v[152:153], v[144:145], v[36:37], v[152:153] neg_lo:[0,0,1] neg_hi:[0,0,1]
v_pk_fma_f32 v[154:155], v[146:147], v[36:37], v[154:155] neg_lo:[0,0,1] neg_hi:[0,0,1]
v_pk_fma_f32 v[156:157], v[148:149], v[36:37], v[156:157] neg_lo:[0,0,1] neg_hi:[0,0,1]
v_pk_fma_f32 v[158:159], v[150:151], v[36:37], v[158:159] neg_lo:[0,0,1] neg_hi:[0,0,1]
v_cvt_pk_bf16_f32 v96, v136, v137
v_cvt_pk_bf16_f32 v97, v138, v139
v_cvt_pk_bf16_f32 v98, v140, v141
v_cvt_pk_bf16_f32 v99, v142, v143
v_cvt_pk_bf16_f32 v100, v152, v153
v_cvt_pk_bf16_f32 v101, v154, v155
v_cvt_pk_bf16_f32 v102, v156, v157
v_cvt_pk_bf16_f32 v103, v158, v159
v_cvt_pk_bf16_f32 v32, v32, v32
v_mov_b32 v33, 0
v_mov_b32 v34, 0
v_mov_b32 v35, 0
s_xor_b32 s36, s31, 0
s_lshl_b32 s36, s36, 1
s_add_u32 s36, s36, s30
s_bitcmp1_b32 s44, 1
s_cselect_b64 s[58:59], -1, 0
s_and_b32 s37, s44, 1
s_mul_i32 s66, s36, 36864
s_mul_i32 s36, s37, 1253376
s_add_u32 s66, s66, s36
s_and_b32 s36, s29, 1
s_mul_i32 s36, s36, 626688
s_add_u32 s66, s66, s36
s_lshr_b32 s36, s44, 1
s_lshl_b32 s62, s36, 10
s_add_u32 s62, s62, 34635776
s_mul_i32 s36, s36, 9216
s_add_u32 s66, s66, s36
s_add_u32 s66, s66, 16777216
s_lshl_b32 s37, s37, 4
v_and_b32 v22, 19, v1
v_bfe_u32 v23, v1, 2, 1
v_lshl_or_b32 v22, v23, 3, v22
v_bfe_u32 v23, v1, 3, 1
v_lshl_or_b32 v22, v23, 2, v22
v_xor_b32 v22, s37, v22
v_cmp_eq_u32 vcc, 0, v22
v_lshlrev_b32 v22, 4, v22
v_lshlrev_b32 v23, 9, v21
v_add_u32 v124, v23, v22
v_sub_u32 v22, v23, v22
v_add_u32 v22, 512, v22
v_add_u32 v23, 36864, v23
v_cndmask_b32 v22, v22, v23, vcc
v_cndmask_b32 v125, v22, v124, s[58:59]
v_cndmask_b32 v124, v124, v22, s[58:59]
v_bfe_u32 v22, v1, 4, 1
v_and_b32 v23, 15, v1
v_lshlrev_b32 v126, 4, v23
v_lshl_add_u32 v126, v22, 10, v126
v_lshl_add_u32 v126, v21, 9, v126
s_xor_b32 s36, s2, 1
s_lshl_b32 s68, s36, 15
s_lshl_b32 s36, s44, 11
s_add_u32 s68, s68, s36
s_add_u32 s68, s68, 25165824
s_lshl_b32 s56, 0x11111111, s44
s_mov_b32 s57, s56
s_mov_b32 s46, 0x0c0c0400
s_mov_b32 s47, 0x04000c0c
s_and_b32 s44, s28, 3
v_and_b32 v26, 15, v1
v_lshl_add_u32 v26, v26, 2, s35
v_bfe_u32 v27, v1, 4, 1
v_lshl_add_u32 v26, v27, 1, v26
v_lshrrev_b32 v27, 5, v1
v_cmp_eq_u32 s[60:61], 0, v26
s_xor_b32 s36, s31, 0
s_lshl_b32 s36, s36, 1
s_add_u32 s36, s36, s30
s_lshl_b32 s37, s36, 6
s_sub_u32 s38, 1984, s37
s_bitcmp1_b32 s44, 1
s_cselect_b32 s45, s38, s37
s_cselect_b32 s39, 3, 0
s_and_b32 s37, s44, 1
s_lshl_b32 s38, s37, 5
s_add_u32 s45, s45, s38
v_lshlrev_b32 v29, 4, v27
s_xor_b32 s36, s39, 0
s_lshl_b32 s40, s36, 13
s_add_u32 s37, s36, 1
s_lshr_b32 s37, s37, 1
s_lshl_b32 s37, s37, 10
s_bitcmp1_b32 s36, 0
s_cselect_b32 s38, -1, 1
v_mul_lo_u32 v120, v26, s38
v_add_u32 v120, s37, v120
s_lshr_b32 s36, s36, 1
s_lshl_b32 s36, s36, 9
s_sub_u32 s37, s37, s36
v_mov_b32 v28, s37
v_cndmask_b32 v120, v120, v28, s[60:61]
v_lshl_add_u32 v120, v120, 11, v29
s_xor_b32 s36, s39, 1
s_lshl_b32 s41, s36, 13
s_add_u32 s37, s36, 1
s_lshr_b32 s37, s37, 1
s_lshl_b32 s37, s37, 10
s_bitcmp1_b32 s36, 0
s_cselect_b32 s38, -1, 1
v_mul_lo_u32 v121, v26, s38
v_add_u32 v121, s37, v121
s_lshr_b32 s36, s36, 1
s_lshl_b32 s36, s36, 9
s_sub_u32 s37, s37, s36
v_mov_b32 v28, s37
v_cndmask_b32 v121, v121, v28, s[60:61]
v_lshl_add_u32 v121, v121, 11, v29
s_xor_b32 s36, s39, 2
s_lshl_b32 s42, s36, 13
s_add_u32 s37, s36, 1
s_lshr_b32 s37, s37, 1
s_lshl_b32 s37, s37, 10
s_bitcmp1_b32 s36, 0
s_cselect_b32 s38, -1, 1
v_mul_lo_u32 v122, v26, s38
v_add_u32 v122, s37, v122
s_lshr_b32 s36, s36, 1
s_lshl_b32 s36, s36, 9
s_sub_u32 s37, s37, s36
v_mov_b32 v28, s37
v_cndmask_b32 v122, v122, v28, s[60:61]
v_lshl_add_u32 v122, v122, 11, v29
s_xor_b32 s36, s39, 3
s_lshl_b32 s43, s36, 13
s_add_u32 s37, s36, 1
s_lshr_b32 s37, s37, 1
s_lshl_b32 s37, s37, 10
s_bitcmp1_b32 s36, 0
s_cselect_b32 s38, -1, 1
v_mul_lo_u32 v123, v26, s38
v_add_u32 v123, s37, v123
s_lshr_b32 s36, s36, 1
s_lshl_b32 s36, s36, 9
s_sub_u32 s37, s37, s36
v_mov_b32 v28, s37
v_cndmask_b32 v123, v123, v28, s[60:61]
v_lshl_add_u32 v123, v123, 11, v29
s_mov_b32 s69, 100000
HN_w0:
ds_read_b32 v25, v127 offset:0
s_waitcnt lgkmcnt(0)
v_cmp_gt_u32 vcc, 31, v25
s_cmp_eq_u32 vcc_lo, 0
s_cbranch_scc1 HN_x0
s_sleep 4
s_sub_u32 s69, s69, 1
s_cmp_lg_u32 s69, 0
s_cbranch_scc1 HN_w0
HN_x0:
s_mul_i32 s36, s44, 6144
s_add_u32 s36, s36, 67584
v_add_u32 v26, s36, v18
s_xor_b32 s36, s44, 1
s_mul_i32 s36, s36, 6144
s_add_u32 s36, s36, 69632
v_add_u32 v27, s36, v18
ds_write_b128 v26, v[208:211] offset:0
ds_write_b128 v26, v[212:215] offset:1024
ds_write_b128 v27, v[216:219] offset:0
ds_write_b128 v27, v[220:223] offset:1024
v_mov_b32 v22, 1
s_mov_b64 exec, s[56:57]
ds_write_b32 v127, v22 offset:256
s_mov_b64 exec, -1
s_waitcnt lgkmcnt(0)
s_mov_b32 s69, 4000
HN_f0:
buffer_load_dwordx4 v[14:17], v18, s[12:15], s62 offen sc0 sc1
HN_fc:
s_waitcnt vmcnt(0)
v_xor_b32 v14, v0, v14
v_xor_b32 v15, v0, v15
v_xor_b32 v16, v0, v16
v_xor_b32 v17, v0, v17
v_or3_b32 v14, v14, v15, v16
v_or_b32 v14, v14, v17
v_cmp_ne_u32 vcc, 0, v14
s_cbranch_vccz HN_f1
s_sub_u32 s69, s69, 1
s_cmp_lg_u32 s69, 0
s_cbranch_scc1 HN_f0
HN_f1:
s_add_u32 s36, s66, 0
buffer_load_dwordx4 v[192:195], v124, s[12:15], s36 offen offset:0
buffer_load_dwordx4 v[196:199], v125, s[12:15], s36 offen offset:0
s_add_u32 s36, s66, 18432
buffer_load_dwordx4 v[200:203], v124, s[12:15], s36 offen offset:0
buffer_load_dwordx4 v[204:207], v125, s[12:15], s36 offen offset:0
s_add_u32 s36, s66, 0
buffer_load_dwordx4 v[208:211], v124, s[12:15], s36 offen offset:1024
buffer_load_dwordx4 v[212:215], v125, s[12:15], s36 offen offset:1024
s_add_u32 s36, s66, 18432
buffer_load_dwordx4 v[216:219], v124, s[12:15], s36 offen offset:1024
buffer_load_dwordx4 v[220:223], v125, s[12:15], s36 offen offset:1024
s_add_u32 s36, s66, 0
buffer_load_dwordx4 v[224:227], v124, s[12:15], s36 offen offset:2048
buffer_load_dwordx4 v[228:231], v125, s[12:15], s36 offen offset:2048
s_add_u32 s36, s66, 18432
buffer_load_dwordx4 v[232:235], v124, s[12:15], s36 offen offset:2048
buffer_load_dwordx4 v[236:239], v125, s[12:15], s36 offen offset:2048
s_add_u32 s36, s66, 0
buffer_load_dwordx4 v[240:243], v124, s[12:15], s36 offen offset:3072
buffer_load_dwordx4 v[244:247], v125, s[12:15], s36 offen offset:3072
s_add_u32 s36, s66, 18432
buffer_load_dwordx4 v[248:251], v124, s[12:15], s36 offen offset:3072
buffer_load_dwordx4 v[252:255], v125, s[12:15], s36 offen offset:3072
s_waitcnt vmcnt(14)
v_mfma_f32_32x32x16_bf16 v[128:143], v[192:195], v[40:43], 0
v_mfma_f32_32x32x16_bf16 v[144:159], v[196:199], v[40:43], 0
s_waitcnt vmcnt(12)
v_mfma_f32_32x32x16_bf16 v[160:175], v[200:203], v[44:47], 0
v_mfma_f32_32x32x16_bf16 v[176:191], v[204:207], v[44:47], 0
s_add_u32 s36, s66, 4096
buffer_load_dwordx4 v[192:195], v124, s[12:15], s36 offen offset:0
buffer_load_dwordx4 v[196:199], v125, s[12:15], s36 offen offset:0
s_waitcnt vmcnt(12)
v_mfma_f32_32x32x16_bf16 v[128:143], v[208:211], v[48:51], v[128:143]
v_mfma_f32_32x32x16_bf16 v[144:159], v[212:215], v[48:51], v[144:159]
s_add_u32 s36, s66, 22528
buffer_load_dwordx4 v[200:203], v124, s[12:15], s36 offen offset:0
buffer_load_dwordx4 v[204:207], v125, s[12:15], s36 offen offset:0
s_waitcnt vmcnt(12)
v_mfma_f32_32x32x16_bf16 v[160:175], v[216:219], v[52:55], v[160:175]
v_mfma_f32_32x32x16_bf16 v[176:191], v[220:223], v[52:55], v[176:191]
s_add_u32 s36, s66, 4096
buffer_load_dwordx4 v[208:211], v124, s[12:15], s36 offen offset:1024
buffer_load_dwordx4 v[212:215], v125, s[12:15], s36 offen offset:1024
s_waitcnt vmcnt(12)
v_mfma_f32_32x32x16_bf16 v[128:143], v[224:227], v[56:59], v[128:143]
v_mfma_f32_32x32x16_bf16 v[144:159], v[228:231], v[56:59], v[144:159]
s_add_u32 s36, s66, 22528
buffer_load_dwordx4 v[216:219], v124, s[12:15], s36 offen offset:1024
buffer_load_dwordx4 v[220:223], v125, s[12:15], s36 offen offset:1024
s_waitcnt vmcnt(12)
v_mfma_f32_32x32x16_bf16 v[160:175], v[232:235], v[60:63], v[160:175]
v_mfma_f32_32x32x16_bf16 v[176:191], v[236:239], v[60:63], v[176:191]
s_add_u32 s36, s66, 4096
buffer_load_dwordx4 v[224:227], v124, s[12:15], s36 offen offset:2048
buffer_load_dwordx4 v[228:231], v125, s[12:15], s36 offen offset:2048
s_waitcnt vmcnt(12)
v_mfma_f32_32x32x16_bf16 v[128:143], v[240:243], v[64:67], v[128:143]
v_mfma_f32_32x32x16_bf16 v[144:159], v[244:247], v[64:67], v[144:159]
s_add_u32 s36, s66, 22528
buffer_load_dwordx4 v[232:235], v124, s[12:15], s36 offen offset:2048
buffer_load_dwordx4 v[236:239], v125, s[12:15], s36 offen offset:2048
s_waitcnt vmcnt(12)
v_mfma_f32_32x32x16_bf16 v[160:175], v[248:251], v[68:71], v[160:175]
v_mfma_f32_32x32x16_bf16 v[176:191], v[252:255], v[68:71], v[176:191]
s_add_u32 s36, s66, 4096
buffer_load_dwordx4 v[240:243], v124, s[12:15], s36 offen offset:3072
buffer_load_dwordx4 v[244:247], v125, s[12:15], s36 offen offset:3072
s_waitcnt vmcnt(12)
v_mfma_f32_32x32x16_bf16 v[128:143], v[192:195], v[72:75], v[128:143]
v_mfma_f32_32x32x16_bf16 v[144:159], v[196:199], v[72:75], v[144:159]
s_add_u32 s36, s66, 22528
buffer_load_dwordx4 v[248:251], v124, s[12:15], s36 offen offset:3072
buffer_load_dwordx4 v[252:255], v125, s[12:15], s36 offen offset:3072
s_waitcnt vmcnt(12)
v_mfma_f32_32x32x16_bf16 v[160:175], v[200:203], v[76:79], v[160:175]
v_mfma_f32_32x32x16_bf16 v[176:191], v[204:207], v[76:79], v[176:191]
s_add_u32 s36, s66, 8192
buffer_load_dwordx4 v[6:9], v124, s[12:15], s36 offen
buffer_load_dwordx4 v[10:13], v125, s[12:15], s36 offen
s_waitcnt vmcnt(12)
v_mfma_f32_32x32x16_bf16 v[128:143], v[208:211], v[80:83], v[128:143]
v_mfma_f32_32x32x16_bf16 v[144:159], v[212:215], v[80:83], v[144:159]
s_waitcnt vmcnt(10)
v_mfma_f32_32x32x16_bf16 v[160:175], v[216:219], v[84:87], v[160:175]
v_mfma_f32_32x32x16_bf16 v[176:191], v[220:223], v[84:87], v[176:191]
s_waitcnt vmcnt(8)
v_mfma_f32_32x32x16_bf16 v[128:143], v[224:227], v[88:91], v[128:143]
v_mfma_f32_32x32x16_bf16 v[144:159], v[228:231], v[88:91], v[144:159]
s_waitcnt vmcnt(6)
v_mfma_f32_32x32x16_bf16 v[160:175], v[232:235], v[92:95], v[160:175]
v_mfma_f32_32x32x16_bf16 v[176:191], v[236:239], v[92:95], v[176:191]
s_waitcnt vmcnt(4)
v_mfma_f32_32x32x16_bf16 v[128:143], v[240:243], v[96:99], v[128:143]
v_mfma_f32_32x32x16_bf16 v[144:159], v[244:247], v[96:99], v[144:159]
s_waitcnt vmcnt(2)
v_mfma_f32_32x32x16_bf16 v[160:175], v[248:251], v[100:103], v[160:175]
v_mfma_f32_32x32x16_bf16 v[176:191], v[252:255], v[100:103], v[176:191]
s_waitcnt vmcnt(0)
s_and_b32 s36, s29, 1
s_or_b32 s36, s36, s44
s_cmp_lg_u32 s36, 0
s_cbranch_scc1 HN_ng
v_mfma_f32_32x32x16_bf16 v[128:143], v[6:9], v[32:35], v[128:143]
v_mfma_f32_32x32x16_bf16 v[144:159], v[10:13], v[32:35], v[144:159]
HN_ng:
s_xor_b32 s36, s44, 1
s_mul_i32 s36, s36, 6144
s_add_u32 s36, s36, 65536
v_add_u32 v26, s36, v18
s_xor_b32 s36, s44, 2
s_mul_i32 s36, s36, 6144
s_add_u32 s36, s36, 67584
v_add_u32 v27, s36, v18
s_xor_b32 s36, s44, 3
s_mul_i32 s36, s36, 6144
s_add_u32 s36, s36, 69632
v_add_u32 v28, s36, v18
s_mul_i32 s36, s44, 6144
s_add_u32 s36, s36, 65536
v_add_u32 v29, s36, v18
v_lshlrev_b32 v192, 16, v104
v_and_b32 v193, 0xffff0000, v104
v_lshlrev_b32 v194, 16, v105
v_and_b32 v195, 0xffff0000, v105
v_lshlrev_b32 v196, 16, v106
v_and_b32 v197, 0xffff0000, v106
v_lshlrev_b32 v198, 16, v107
v_and_b32 v199, 0xffff0000, v107
v_lshlrev_b32 v200, 16, v108
v_and_b32 v201, 0xffff0000, v108
v_lshlrev_b32 v202, 16, v109
v_and_b32 v203, 0xffff0000, v109
v_lshlrev_b32 v204, 16, v110
v_and_b32 v205, 0xffff0000, v110
v_lshlrev_b32 v206, 16, v111
v_and_b32 v207, 0xffff0000, v111
v_lshlrev_b32 v208, 16, v112
v_and_b32 v209, 0xffff0000, v112
v_lshlrev_b32 v210, 16, v113
v_and_b32 v211, 0xffff0000, v113
v_lshlrev_b32 v212, 16, v114
v_and_b32 v213, 0xffff0000, v114
v_lshlrev_b32 v214, 16, v115
v_and_b32 v215, 0xffff0000, v115
v_lshlrev_b32 v216, 16, v116
v_and_b32 v217, 0xffff0000, v116
v_lshlrev_b32 v218, 16, v117
v_and_b32 v219, 0xffff0000, v117
v_lshlrev_b32 v220, 16, v118
v_and_b32 v221, 0xffff0000, v118
v_lshlrev_b32 v222, 16, v119
v_and_b32 v223, 0xffff0000, v119
s_or_b32 s36, s35, s44
s_cmp_lg_u32 s36, 0
s_cbranch_scc1 HN_nd
v_lshrrev_b32 v22, 1, v1
v_add_u32 v22, 90112, v22
s_mov_b64 exec, s[60:61]
v_sub_f32 v40, v128, v160
v_sub_f32 v41, v129, v161
v_sub_f32 v42, v130, v162
v_sub_f32 v43, v131, v163
v_sub_f32 v44, v132, v164
v_sub_f32 v45, v133, v165
v_sub_f32 v46, v134, v166
v_sub_f32 v47, v135, v167
v_sub_f32 v48, v136, v168
v_sub_f32 v49, v137, v169
v_sub_f32 v50, v138, v170
v_sub_f32 v51, v139, v171
v_sub_f32 v52, v140, v172
v_sub_f32 v53, v141, v173
v_sub_f32 v54, v142, v174
v_sub_f32 v55, v143, v175
v_sub_f32 v56, v144, v176
v_sub_f32 v57, v145, v177
v_sub_f32 v58, v146, v178
v_sub_f32 v59, v147, v179
v_sub_f32 v60, v148, v180
v_sub_f32 v61, v149, v181
v_sub_f32 v62, v150, v182
v_sub_f32 v63, v151, v183
v_sub_f32 v64, v152, v184
v_sub_f32 v65, v153, v185
v_sub_f32 v66, v154, v186
v_sub_f32 v67, v155, v187
v_sub_f32 v68, v156, v188
v_sub_f32 v69, v157, v189
v_sub_f32 v70, v158, v190
v_sub_f32 v71, v159, v191
ds_write_b128 v22, v[40:43] offset:0
ds_write_b128 v22, v[44:47] offset:32
ds_write_b128 v22, v[48:51] offset:64
ds_write_b128 v22, v[52:55] offset:96
ds_write_b128 v22, v[56:59] offset:128
ds_write_b128 v22, v[60:63] offset:160
ds_write_b128 v22, v[64:67] offset:192
ds_write_b128 v22, v[68:71] offset:224
s_mov_b64 exec, -1
HN_nd:
v_pk_add_f32 v[136:137], v[136:137], v[168:169]
v_pk_add_f32 v[138:139], v[138:139], v[170:171]
v_pk_add_f32 v[140:141], v[140:141], v[172:173]
v_pk_add_f32 v[142:143], v[142:143], v[174:175]
ds_write_b128 v26, v[136:139] offset:0
ds_write_b128 v26, v[140:143] offset:1024
v_pk_add_f32 v[144:145], v[144:145], v[176:177]
v_pk_add_f32 v[146:147], v[146:147], v[178:179]
v_pk_add_f32 v[148:149], v[148:149], v[180:181]
v_pk_add_f32 v[150:151], v[150:151], v[182:183]
ds_write_b128 v27, v[144:147] offset:0
ds_write_b128 v27, v[148:151] offset:1024
v_pk_add_f32 v[152:153], v[152:153], v[184:185]
v_pk_add_f32 v[154:155], v[154:155], v[186:187]
v_pk_add_f32 v[156:157], v[156:157], v[188:189]
v_pk_add_f32 v[158:159], v[158:159], v[190:191]
ds_write_b128 v28, v[152:155] offset:0
ds_write_b128 v28, v[156:159] offset:1024
v_pk_add_f32 v[128:129], v[128:129], v[160:161]
v_pk_add_f32 v[130:131], v[130:131], v[162:163]
v_pk_add_f32 v[132:133], v[132:133], v[164:165]
v_pk_add_f32 v[134:135], v[134:135], v[166:167]
v_mov_b32 v22, 2
s_mov_b64 exec, s[56:57]
ds_write_b32 v127, v22 offset:256
s_mov_b64 exec, -1
s_lshl_b32 s36, s44, 31
s_lshl_b32 s37, s44, 30
s_and_b32 s37, s37, 0x80000000
s_mov_b32 s70, 1.0
s_xor_b32 s76, s36, 1.0
s_xor_b32 s74, s37, 1.0
s_xor_b32 s72, s74, s36
s_mov_b32 s71, s70
s_mov_b32 s73, s72
s_mov_b32 s75, s74
s_mov_b32 s77, s76
s_mov_b32 s69, 100000
HN_w1:
ds_read_b32 v25, v127 offset:256
s_waitcnt lgkmcnt(0)
v_cmp_gt_u32 vcc, 2, v25
s_cmp_eq_u32 vcc_lo, 0
s_cbranch_scc1 HN_x1
s_sleep 1
s_sub_u32 s69, s69, 1
s_cmp_lg_u32 s69, 0
s_cbranch_scc1 HN_w1
HN_x1:
ds_read_b128 v[136:139], v29 offset:0
ds_read_b128 v[140:143], v29 offset:1024
ds_read_b128 v[144:147], v29 offset:2048
ds_read_b128 v[148:151], v29 offset:3072
ds_read_b128 v[152:155], v29 offset:4096
ds_read_b128 v[156:159], v29 offset:5120
s_waitcnt lgkmcnt(4)
v_pk_add_f32 v[160:161], v[128:129], v[136:137]
v_pk_add_f32 v[168:169], v[128:129], v[136:137] neg_lo:[0,1] neg_hi:[0,1]
v_pk_add_f32 v[162:163], v[130:131], v[138:139]
v_pk_add_f32 v[170:171], v[130:131], v[138:139] neg_lo:[0,1] neg_hi:[0,1]
v_pk_add_f32 v[164:165], v[132:133], v[140:141]
v_pk_add_f32 v[172:173], v[132:133], v[140:141] neg_lo:[0,1] neg_hi:[0,1]
v_pk_add_f32 v[166:167], v[134:135], v[142:143]
v_pk_add_f32 v[174:175], v[134:135], v[142:143] neg_lo:[0,1] neg_hi:[0,1]
s_waitcnt lgkmcnt(0)
v_pk_add_f32 v[176:177], v[144:145], v[152:153]
v_pk_add_f32 v[184:185], v[144:145], v[152:153] neg_lo:[0,1] neg_hi:[0,1]
v_pk_add_f32 v[178:179], v[146:147], v[154:155]
v_pk_add_f32 v[186:187], v[146:147], v[154:155] neg_lo:[0,1] neg_hi:[0,1]
v_pk_add_f32 v[180:181], v[148:149], v[156:157]
v_pk_add_f32 v[188:189], v[148:149], v[156:157] neg_lo:[0,1] neg_hi:[0,1]
v_pk_add_f32 v[182:183], v[150:151], v[158:159]
v_pk_add_f32 v[190:191], v[150:151], v[158:159] neg_lo:[0,1] neg_hi:[0,1]
v_pk_add_f32 v[128:129], v[160:161], v[176:177]
v_pk_add_f32 v[130:131], v[162:163], v[178:179]
v_pk_add_f32 v[132:133], v[164:165], v[180:181]
v_pk_add_f32 v[134:135], v[166:167], v[182:183]
v_pk_add_f32 v[136:137], v[168:169], v[184:185] neg_lo:[0,1] neg_hi:[0,1]
v_pk_add_f32 v[138:139], v[170:171], v[186:187] neg_lo:[0,1] neg_hi:[0,1]
v_pk_add_f32 v[140:141], v[172:173], v[188:189] neg_lo:[0,1] neg_hi:[0,1]
v_pk_add_f32 v[142:143], v[174:175], v[190:191] neg_lo:[0,1] neg_hi:[0,1]
v_pk_add_f32 v[144:145], v[160:161], v[176:177] neg_lo:[0,1] neg_hi:[0,1]
v_pk_add_f32 v[146:147], v[162:163], v[178:179] neg_lo:[0,1] neg_hi:[0,1]
v_pk_add_f32 v[148:149], v[164:165], v[180:181] neg_lo:[0,1] neg_hi:[0,1]
v_pk_add_f32 v[150:151], v[166:167], v[182:183] neg_lo:[0,1] neg_hi:[0,1]
v_pk_add_f32 v[152:153], v[168:169], v[184:185]
v_pk_add_f32 v[154:155], v[170:171], v[186:187]
v_pk_add_f32 v[156:157], v[172:173], v[188:189]
v_pk_add_f32 v[158:159], v[174:175], v[190:191]
s_cmp_lg_u32 s35, 0
s_cbranch_scc1 HN_ns
s_lshl_b32 s36, s44, 6
s_add_u32 s36, s36, 90112
v_lshrrev_b32 v22, 1, v1
v_add_u32 v22, s36, v22
s_mov_b64 exec, s[60:61]
ds_read_b128 v[160:163], v22
ds_read_b128 v[164:167], v22 offset:32
v_mul_f32 v128, s70, v128
v_mul_f32 v129, s70, v129
v_mul_f32 v130, s70, v130
v_mul_f32 v131, s70, v131
v_mul_f32 v132, s70, v132
v_mul_f32 v133, s70, v133
v_mul_f32 v134, s70, v134
v_mul_f32 v135, s70, v135
v_mul_f32 v136, s72, v136
v_mul_f32 v137, s72, v137
v_mul_f32 v138, s72, v138
v_mul_f32 v139, s72, v139
v_mul_f32 v140, s72, v140
v_mul_f32 v141, s72, v141
v_mul_f32 v142, s72, v142
v_mul_f32 v143, s72, v143
v_mul_f32 v144, s74, v144
v_mul_f32 v145, s74, v145
v_mul_f32 v146, s74, v146
v_mul_f32 v147, s74, v147
v_mul_f32 v148, s74, v148
v_mul_f32 v149, s74, v149
v_mul_f32 v150, s74, v150
v_mul_f32 v151, s74, v151
v_mul_f32 v152, s76, v152
v_mul_f32 v153, s76, v153
v_mul_f32 v154, s76, v154
v_mul_f32 v155, s76, v155
v_mul_f32 v156, s76, v156
v_mul_f32 v157, s76, v157
v_mul_f32 v158, s76, v158
v_mul_f32 v159, s76, v159
v_add_f32 v168, v128, v152
v_add_f32 v176, v136, v144
v_sub_f32 v184, v128, v152
v_add_f32 v169, v129, v153
v_add_f32 v177, v137, v145
v_sub_f32 v185, v129, v153
v_add_f32 v170, v130, v154
v_add_f32 v178, v138, v146
v_sub_f32 v186, v130, v154
v_add_f32 v171, v131, v155
v_add_f32 v179, v139, v147
v_sub_f32 v187, v131, v155
v_add_f32 v172, v132, v156
v_add_f32 v180, v140, v148
v_sub_f32 v188, v132, v156
v_add_f32 v173, v133, v157
v_add_f32 v181, v141, v149
v_sub_f32 v189, v133, v157
v_add_f32 v174, v134, v158
v_add_f32 v182, v142, v150
v_sub_f32 v190, v134, v158
v_add_f32 v175, v135, v159
v_add_f32 v183, v143, v151
v_sub_f32 v191, v135, v159
s_waitcnt lgkmcnt(0)
s_cmp_ge_u32 s44, 2
s_cbranch_scc1 HN_sr
v_mul_f32 v128, 0.5, v168
v_mul_f32 v136, 0.5, v176
v_fma_f32 v144, 0.5, v184, v160
v_fma_f32 v152, -0.5, v184, v160
v_mul_f32 v129, 0.5, v169
v_mul_f32 v137, 0.5, v177
v_fma_f32 v145, 0.5, v185, v161
v_fma_f32 v153, -0.5, v185, v161
v_mul_f32 v130, 0.5, v170
v_mul_f32 v138, 0.5, v178
v_fma_f32 v146, 0.5, v186, v162
v_fma_f32 v154, -0.5, v186, v162
v_mul_f32 v131, 0.5, v171
v_mul_f32 v139, 0.5, v179
v_fma_f32 v147, 0.5, v187, v163
v_fma_f32 v155, -0.5, v187, v163
v_mul_f32 v132, 0.5, v172
v_mul_f32 v140, 0.5, v180
v_fma_f32 v148, 0.5, v188, v164
v_fma_f32 v156, -0.5, v188, v164
v_mul_f32 v133, 0.5, v173
v_mul_f32 v141, 0.5, v181
v_fma_f32 v149, 0.5, v189, v165
v_fma_f32 v157, -0.5, v189, v165
v_mul_f32 v134, 0.5, v174
v_mul_f32 v142, 0.5, v182
v_fma_f32 v150, 0.5, v190, v166
v_fma_f32 v158, -0.5, v190, v166
v_mul_f32 v135, 0.5, v175
v_mul_f32 v143, 0.5, v183
v_fma_f32 v151, 0.5, v191, v167
v_fma_f32 v159, -0.5, v191, v167
s_branch HN_sj
HN_sr:
v_mul_f32 v152, 0.5, v168
v_mul_f32 v144, 0.5, v176
v_fma_f32 v128, 0.5, v184, v160
v_fma_f32 v136, -0.5, v184, v160
v_mul_f32 v153, 0.5, v169
v_mul_f32 v145, 0.5, v177
v_fma_f32 v129, 0.5, v185, v161
v_fma_f32 v137, -0.5, v185, v161
v_mul_f32 v154, 0.5, v170
v_mul_f32 v146, 0.5, v178
v_fma_f32 v130, 0.5, v186, v162
v_fma_f32 v138, -0.5, v186, v162
v_mul_f32 v155, 0.5, v171
v_mul_f32 v147, 0.5, v179
v_fma_f32 v131, 0.5, v187, v163
v_fma_f32 v139, -0.5, v187, v163
v_mul_f32 v156, 0.5, v172
v_mul_f32 v148, 0.5, v180
v_fma_f32 v132, 0.5, v188, v164
v_fma_f32 v140, -0.5, v188, v164
v_mul_f32 v157, 0.5, v173
v_mul_f32 v149, 0.5, v181
v_fma_f32 v133, 0.5, v189, v165
v_fma_f32 v141, -0.5, v189, v165
v_mul_f32 v158, 0.5, v174
v_mul_f32 v150, 0.5, v182
v_fma_f32 v134, 0.5, v190, v166
v_fma_f32 v142, -0.5, v190, v166
v_mul_f32 v159, 0.5, v175
v_mul_f32 v151, 0.5, v183
v_fma_f32 v135, 0.5, v191, v167
v_fma_f32 v143, -0.5, v191, v167
HN_sj:
v_mul_f32 v128, s70, v128
v_mul_f32 v129, s70, v129
v_mul_f32 v130, s70, v130
v_mul_f32 v131, s70, v131
v_mul_f32 v132, s70, v132
v_mul_f32 v133, s70, v133
v_mul_f32 v134, s70, v134
v_mul_f32 v135, s70, v135
v_mul_f32 v136, s72, v136
v_mul_f32 v137, s72, v137
v_mul_f32 v138, s72, v138
v_mul_f32 v139, s72, v139
v_mul_f32 v140, s72, v140
v_mul_f32 v141, s72, v141
v_mul_f32 v142, s72, v142
v_mul_f32 v143, s72, v143
v_mul_f32 v144, s74, v144
v_mul_f32 v145, s74, v145
v_mul_f32 v146, s74, v146
v_mul_f32 v147, s74, v147
v_mul_f32 v148, s74, v148
v_mul_f32 v149, s74, v149
v_mul_f32 v150, s74, v150
v_mul_f32 v151, s74, v151
v_mul_f32 v152, s76, v152
v_mul_f32 v153, s76, v153
v_mul_f32 v154, s76, v154
v_mul_f32 v155, s76, v155
v_mul_f32 v156, s76, v156
v_mul_f32 v157, s76, v157
v_mul_f32 v158, s76, v158
v_mul_f32 v159, s76, v159
s_mov_b64 exec, -1
HN_ns:
v_pk_fma_f32 v[128:129], v[128:129], s[70:71], v[192:193]
v_pk_fma_f32 v[130:131], v[130:131], s[70:71], v[194:195]
v_pk_fma_f32 v[132:133], v[132:133], s[70:71], v[196:197]
v_pk_fma_f32 v[134:135], v[134:135], s[70:71], v[198:199]
v_pk_fma_f32 v[136:137], v[136:137], s[72:73], v[200:201]
v_pk_fma_f32 v[138:139], v[138:139], s[72:73], v[202:203]
v_pk_fma_f32 v[140:141], v[140:141], s[72:73], v[204:205]
v_pk_fma_f32 v[142:143], v[142:143], s[72:73], v[206:207]
v_pk_fma_f32 v[144:145], v[144:145], s[74:75], v[208:209]
v_pk_fma_f32 v[146:147], v[146:147], s[74:75], v[210:211]
v_pk_fma_f32 v[148:149], v[148:149], s[74:75], v[212:213]
v_pk_fma_f32 v[150:151], v[150:151], s[74:75], v[214:215]
v_pk_fma_f32 v[152:153], v[152:153], s[76:77], v[216:217]
v_pk_fma_f32 v[154:155], v[154:155], s[76:77], v[218:219]
v_pk_fma_f32 v[156:157], v[156:157], s[76:77], v[220:221]
v_pk_fma_f32 v[158:159], v[158:159], s[76:77], v[222:223]
s_cmp_lt_u32 s40, 16384
s_cselect_b32 s36, 0, 65536
s_add_u32 s36, s36, s40
s_add_u32 s36, s36, 16384
s_lshl_b32 s37, s44, 11
s_add_u32 s36, s36, s37
v_add_u32 v26, s36, v126
v_mov_b32 v40, v2
v_mov_b32 v41, v2
s_add_u32 s40, s40, s68
s_cmp_lt_u32 s41, 16384
s_cselect_b32 s36, 0, 65536
s_add_u32 s36, s36, s41
s_add_u32 s36, s36, 16384
s_lshl_b32 s37, s44, 11
s_add_u32 s36, s36, s37
v_add_u32 v27, s36, v126
v_mov_b32 v42, v3
v_mov_b32 v43, v3
s_add_u32 s41, s41, s68
s_cmp_lt_u32 s42, 16384
s_cselect_b32 s36, 0, 65536
s_add_u32 s36, s36, s42
s_add_u32 s36, s36, 16384
s_lshl_b32 s37, s44, 11
s_add_u32 s36, s36, s37
v_add_u32 v28, s36, v126
v_mov_b32 v44, v4
v_mov_b32 v45, v4
s_add_u32 s42, s42, s68
s_cmp_lt_u32 s43, 16384
s_cselect_b32 s36, 0, 65536
s_add_u32 s36, s36, s43
s_add_u32 s36, s36, 16384
s_lshl_b32 s37, s44, 11
s_add_u32 s36, s36, s37
v_add_u32 v29, s36, v126
v_mov_b32 v46, v5
v_mov_b32 v47, v5
s_add_u32 s43, s43, s68
s_mov_b32 s69, 100000
HN_w2:
ds_read_b32 v25, v127 offset:0
s_waitcnt lgkmcnt(0)
v_cmp_gt_u32 vcc, 47, v25
s_cmp_eq_u32 vcc_lo, 0
s_cbranch_scc1 HN_x2
s_sleep 2
s_sub_u32 s69, s69, 1
s_cmp_lg_u32 s69, 0
s_cbranch_scc1 HN_w2
HN_x2:
s_mov_b32 s69, 4000
HN_p0:
buffer_load_dwordx4 v[192:195], v126, s[12:15], s40 offen offset:0 sc0 sc1
buffer_load_dwordx4 v[196:199], v126, s[12:15], s40 offen offset:256 sc0 sc1
buffer_load_dwordx4 v[200:203], v126, s[12:15], s41 offen offset:0 sc0 sc1
buffer_load_dwordx4 v[204:207], v126, s[12:15], s41 offen offset:256 sc0 sc1
buffer_load_dwordx4 v[208:211], v126, s[12:15], s42 offen offset:0 sc0 sc1
buffer_load_dwordx4 v[212:215], v126, s[12:15], s42 offen offset:256 sc0 sc1
buffer_load_dwordx4 v[216:219], v126, s[12:15], s43 offen offset:0 sc0 sc1
buffer_load_dwordx4 v[220:223], v126, s[12:15], s43 offen offset:256 sc0 sc1
s_waitcnt vmcnt(6)
v_perm_b32 v48, v193, v192, s46
v_perm_b32 v49, v195, v194, s47
v_bitop3_b32 v48, v48, v49, v0 bitop3:0x56
v_pk_fma_f32 v[160:161], v[192:193], v[40:41], v[128:129]
v_pk_fma_f32 v[162:163], v[194:195], v[40:41], v[130:131]
v_perm_b32 v50, v197, v196, s46
v_perm_b32 v51, v199, v198, s47
v_bitop3_b32 v50, v50, v51, v0 bitop3:0x56
v_pk_fma_f32 v[164:165], v[196:197], v[40:41], v[132:133]
v_pk_fma_f32 v[166:167], v[198:199], v[40:41], v[134:135]
s_waitcnt vmcnt(4)
v_perm_b32 v52, v201, v200, s46
v_perm_b32 v53, v203, v202, s47
v_bitop3_b32 v52, v52, v53, v0 bitop3:0x56
v_pk_fma_f32 v[168:169], v[200:201], v[42:43], v[136:137]
v_pk_fma_f32 v[170:171], v[202:203], v[42:43], v[138:139]
v_perm_b32 v54, v205, v204, s46
v_perm_b32 v55, v207, v206, s47
v_bitop3_b32 v54, v54, v55, v0 bitop3:0x56
v_pk_fma_f32 v[172:173], v[204:205], v[42:43], v[140:141]
v_pk_fma_f32 v[174:175], v[206:207], v[42:43], v[142:143]
s_waitcnt vmcnt(2)
v_perm_b32 v56, v209, v208, s46
v_perm_b32 v57, v211, v210, s47
v_bitop3_b32 v56, v56, v57, v0 bitop3:0x56
v_pk_fma_f32 v[176:177], v[208:209], v[44:45], v[144:145]
v_pk_fma_f32 v[178:179], v[210:211], v[44:45], v[146:147]
v_perm_b32 v58, v213, v212, s46
v_perm_b32 v59, v215, v214, s47
v_bitop3_b32 v58, v58, v59, v0 bitop3:0x56
v_pk_fma_f32 v[180:181], v[212:213], v[44:45], v[148:149]
v_pk_fma_f32 v[182:183], v[214:215], v[44:45], v[150:151]
s_waitcnt vmcnt(0)
v_perm_b32 v60, v217, v216, s46
v_perm_b32 v61, v219, v218, s47
v_bitop3_b32 v60, v60, v61, v0 bitop3:0x56
v_pk_fma_f32 v[184:185], v[216:217], v[46:47], v[152:153]
v_pk_fma_f32 v[186:187], v[218:219], v[46:47], v[154:155]
v_perm_b32 v62, v221, v220, s46
v_perm_b32 v63, v223, v222, s47
v_bitop3_b32 v62, v62, v63, v0 bitop3:0x56
v_pk_fma_f32 v[188:189], v[220:221], v[46:47], v[156:157]
v_pk_fma_f32 v[190:191], v[222:223], v[46:47], v[158:159]
v_or3_b32 v48, v48, v50, v52
v_or3_b32 v54, v54, v56, v58
v_or3_b32 v48, v48, v60, v62
v_or_b32 v48, v48, v54
v_cmp_ne_u32 vcc, 0, v48
s_cbranch_vccz HN_p1
s_sub_u32 s69, s69, 1
s_cmp_lg_u32 s69, 0
s_cbranch_scc1 HN_p0
HN_p1:
s_add_u32 s36, s44, 100
s_mov_b32 s69, 100000
HN_w3:
ds_read_b32 v25, v127 offset:0
s_waitcnt lgkmcnt(0)
v_cmp_gt_u32 vcc, s36, v25
s_cmp_eq_u32 vcc_lo, 0
s_cbranch_scc1 HN_x3
s_sub_u32 s69, s69, 1
s_cmp_lg_u32 s69, 0
s_cbranch_scc1 HN_w3
HN_x3:
ds_read_b128 v[192:195], v26 offset:0
ds_read_b128 v[196:199], v26 offset:256
ds_read_b128 v[200:203], v27 offset:0
ds_read_b128 v[204:207], v27 offset:256
ds_read_b128 v[208:211], v28 offset:0
ds_read_b128 v[212:215], v28 offset:256
ds_read_b128 v[216:219], v29 offset:0
ds_read_b128 v[220:223], v29 offset:256
s_waitcnt lgkmcnt(6)
v_pk_fma_f32 v[160:161], v[192:193], v[40:41], v[160:161]
v_pk_fma_f32 v[162:163], v[194:195], v[40:41], v[162:163]
v_pk_fma_f32 v[164:165], v[196:197], v[40:41], v[164:165]
v_pk_fma_f32 v[166:167], v[198:199], v[40:41], v[166:167]
v_cvt_pk_bf16_f32 v128, v160, v161
v_cvt_pk_bf16_f32 v129, v162, v163
v_cvt_pk_bf16_f32 v130, v164, v165
v_cvt_pk_bf16_f32 v131, v166, v167
buffer_store_dwordx4 v[128:131], v120, s[20:23], s45 offen
s_waitcnt lgkmcnt(4)
v_pk_fma_f32 v[168:169], v[200:201], v[42:43], v[168:169]
v_pk_fma_f32 v[170:171], v[202:203], v[42:43], v[170:171]
v_pk_fma_f32 v[172:173], v[204:205], v[42:43], v[172:173]
v_pk_fma_f32 v[174:175], v[206:207], v[42:43], v[174:175]
v_cvt_pk_bf16_f32 v132, v168, v169
v_cvt_pk_bf16_f32 v133, v170, v171
v_cvt_pk_bf16_f32 v134, v172, v173
v_cvt_pk_bf16_f32 v135, v174, v175
buffer_store_dwordx4 v[132:135], v121, s[20:23], s45 offen
s_waitcnt lgkmcnt(2)
v_pk_fma_f32 v[176:177], v[208:209], v[44:45], v[176:177]
v_pk_fma_f32 v[178:179], v[210:211], v[44:45], v[178:179]
v_pk_fma_f32 v[180:181], v[212:213], v[44:45], v[180:181]
v_pk_fma_f32 v[182:183], v[214:215], v[44:45], v[182:183]
v_cvt_pk_bf16_f32 v136, v176, v177
v_cvt_pk_bf16_f32 v137, v178, v179
v_cvt_pk_bf16_f32 v138, v180, v181
v_cvt_pk_bf16_f32 v139, v182, v183
buffer_store_dwordx4 v[136:139], v122, s[20:23], s45 offen
s_waitcnt lgkmcnt(0)
v_pk_fma_f32 v[184:185], v[216:217], v[46:47], v[184:185]
v_pk_fma_f32 v[186:187], v[218:219], v[46:47], v[186:187]
v_pk_fma_f32 v[188:189], v[220:221], v[46:47], v[188:189]
v_pk_fma_f32 v[190:191], v[222:223], v[46:47], v[190:191]
v_cvt_pk_bf16_f32 v140, v184, v185
v_cvt_pk_bf16_f32 v141, v186, v187
v_cvt_pk_bf16_f32 v142, v188, v189
v_cvt_pk_bf16_f32 v143, v190, v191
buffer_store_dwordx4 v[140:143], v123, s[20:23], s45 offen
s_cmp_lg_u32 s28, 4
s_cbranch_scc1 HN_tb
s_cmp_lg_u32 s2, 0
s_cbranch_scc1 HN_tb
s_mov_b32 s36, 34637824
s_mov_b64 exec, 1
buffer_store_dword v0, v19, s[12:15], s36 offen sc0 sc1
s_mov_b64 exec, -1
HN_tb:
s_endpgm
.p2align 6
L_xs:
s_xor_b32 s65, s65, 1
s_cbranch_scc0 L_xs1
ds_read_b128 v[104:107], v192 offset:0
ds_read_b128 v[108:111], v192 offset:2048
ds_read_b128 v[112:115], v192 offset:4096
ds_read_b128 v[116:119], v192 offset:6144
s_branch L_xs2
L_xs1:
ds_read_b128 v[208:211], v193 offset:6144
ds_read_b128 v[212:215], v193 offset:4096
ds_read_b128 v[216:219], v193 offset:2048
ds_read_b128 v[220:223], v193 offset:0
L_xs2:
s_cmp_eq_u32 s63, 11
s_cbranch_scc1 L_xr11
s_cmp_eq_u32 s63, 10
s_cbranch_scc1 L_xr10
s_cmp_eq_u32 s63, 9
s_cbranch_scc1 L_xr9
s_cmp_eq_u32 s63, 8
s_cbranch_scc1 L_xr8
s_cmp_eq_u32 s63, 7
s_cbranch_scc1 L_xr7
s_cmp_eq_u32 s63, 6
s_cbranch_scc1 L_xr6
s_cmp_eq_u32 s63, 5
s_cbranch_scc1 L_xr5
s_cmp_eq_u32 s63, 4
s_cbranch_scc1 L_xr4
s_cmp_eq_u32 s63, 3
s_cbranch_scc1 L_xr3
s_cmp_eq_u32 s63, 2
s_cbranch_scc1 L_xr2
s_cmp_eq_u32 s63, 1
s_cbranch_scc1 L_xr1
s_branch L_xr0
L_end:
s_endpgm
.section .rodata,"a"
.p2align 6
.amdhsa_kernel parallel_sum__spectral_fnet__dense_activation_relu__prompt_kernel
  .amdhsa_next_free_vgpr 256
  .amdhsa_next_free_sgpr 102
  .amdhsa_accum_offset 256
  .amdhsa_group_segment_fixed_size 0
  .amdhsa_kernarg_size 88
  .amdhsa_user_sgpr_count 2
  .amdhsa_user_sgpr_kernarg_segment_ptr 1
  .amdhsa_system_sgpr_workgroup_id_x 1
.end_amdhsa_kernel
```
